```python
import torch

def _softmax(x, axis=-1):
    return torch.softmax(x, dim=axis)

def _gelu(x):
    return torch.nn.functional.gelu(x, approximate='tanh')

def _silu(x):
    return torch.nn.functional.silu(x)

def _sigmoid(x):
    return torch.sigmoid(x)

def _layernorm(x, axis=-1, eps=1e-05):
    m = x.mean(dim=axis, keepdim=True)
    v = x.var(dim=axis, keepdim=True, unbiased=False)
    return (x - m) / torch.sqrt(v + eps)

def _scatter_add(tgt, idx, src, axis=0):
    return tgt.clone().index_add_(axis, idx, src)

def _segment_sum(src, seg, n):
    out = torch.zeros((n,) + src.shape[1:], dtype=src.dtype)
    return out.index_add_(0, seg, src)

def _pad(x, pw):
    flat = tuple((v for pair in reversed(pw) for v in pair))
    return torch.nn.functional.pad(x, flat)
kernel_name = 'gated_mix__memory_aug_recurrent_mem_tr__ssm_conv_h3__prompt'

def setup_inputs():

    _w = lambda a: (lambda t: t.to(torch.bfloat16) if t.is_floating_point() else t)(torch.as_tensor(a))

    def _A_setup():
        B, S, Dm = (1, 2048, 640)
        H, Dh = (32, 192)
        M, seg = (8, 32)
        seg = min(seg, S)
        S = S // seg * seg
        return {'x': _w((lambda *s: torch.randn(*s, dtype=torch.bfloat16) * 0.05)(B, S, Dm)), 'mem0': _w((lambda *s: torch.randn(*s, dtype=torch.bfloat16) * 0.4)(B, M, Dm)), 'Wq': _w((lambda *s: torch.randn(*s, dtype=torch.bfloat16) * 6.4)(Dm, H, Dh) * Dm ** (-0.5)), 'Wk': _w((lambda *s: torch.randn(*s, dtype=torch.bfloat16) * 6.4)(Dm, H, Dh) * Dm ** (-0.5)), 'Wv': _w((lambda *s: torch.randn(*s, dtype=torch.bfloat16) * 0.4)(Dm, H, Dh) * Dm ** (-0.5)), 'Wo': _w((lambda *s: torch.randn(*s, dtype=torch.bfloat16) * 0.4)(H, Dh, Dm) * (H * Dh) ** (-0.5)), 'seg_len': seg}
    _A_in = _A_setup()

    def _B_setup():
        B, S, D = (1, 2048, 640)
        ks = 4
        return {'q': _w((lambda *s: torch.randn(*s, dtype=torch.bfloat16) * 0.05)(B, S, D)), 'k': _w((lambda *s: torch.randn(*s, dtype=torch.bfloat16) * 0.4)(B, S, D)), 'v': _w((lambda *s: torch.randn(*s, dtype=torch.bfloat16) * 0.4)(B, S, D)), 'shift_k': _w((lambda *s: torch.randn(*s, dtype=torch.bfloat16) * 0.4)(D, ks) * 0.5), 'ssm_k': _w((lambda *s: torch.randn(*s, dtype=torch.bfloat16) * 0.4)(D, S) * (1.0 / S ** 0.5)), 'ssm_D': _w((lambda *s: torch.randn(*s, dtype=torch.bfloat16) * 0.4)(D))}
    _B_in = _B_setup()
    return {'A_x': _A_in['x'], 'A_mem0': _A_in['mem0'], 'A_Wq': _A_in['Wq'], 'A_Wk': _A_in['Wk'], 'A_Wv': _A_in['Wv'], 'A_Wo': _A_in['Wo'], 'A_seg_len': _A_in['seg_len'], 'B_q': _B_in['q'], 'B_k': _B_in['k'], 'B_v': _B_in['v'], 'B_shift_k': _B_in['shift_k'], 'B_ssm_k': _B_in['ssm_k'], 'B_ssm_D': _B_in['ssm_D'], 'gate_w': _w((lambda *s: torch.randn(*s, dtype=torch.bfloat16) * 0.05)(640) * 16.0)}

def reference(A_x, A_mem0, A_Wq, A_Wk, A_Wv, A_Wo, A_seg_len, B_q, B_k, B_v, B_shift_k, B_ssm_k, B_ssm_D, gate_w):

    def _A_ref(x, mem0, Wq, Wk, Wv, Wo, seg_len):
        B, S, Dm = x.shape
        H, Dh = (Wq.shape[1], Wq.shape[2])
        M = mem0.shape[1]
        scale = Dh ** (-0.5)
        n_seg = S // seg_len
        L = M + seg_len
        idx = torch.arange(L)
        mask = (idx[:, None] < M) | (idx[:, None] >= idx[None, :])
        mem = mem0
        outs = []
        for s in range(n_seg):
            xs = x[:, s * seg_len:(s + 1) * seg_len, :].clone()
            h = torch.concatenate([mem, xs], axis=1)
            q = torch.einsum('btd,dhe->bhte', h, Wq)
            k = torch.einsum('btd,dhe->bhte', h, Wk)
            v = torch.einsum('btd,dhe->bhte', h, Wv)
            scores = torch.einsum('bhqe,bhke->bhqk', q, k) * scale
            scores = torch.where(mask[None, None], scores, -1000000000.0)
            p = _softmax(scores, axis=-1)
            o = torch.einsum('bhqk,bhke->bhqe', p, v)
            o = torch.einsum('bhte,hed->btd', o, Wo)
            mem = o[:, :M, :].clone()
            outs.append(o[:, M:, :])
        return torch.concatenate(outs, axis=1)

    def _B_ref(q, k, v, shift_k, ssm_k, ssm_D):
        B, S, D = q.shape
        ks = shift_k.shape[-1]
        k_pad = _pad(k, ((0, 0), (ks - 1, 0), (0, 0)))
        k_shift = torch.zeros_like(k)
        for t in range(ks):
            k_shift = k_shift + k_pad[:, t:t + S, :] * shift_k[:, ks - 1 - t][None, None, :]
        kv = k_shift * v
        L = 2 * S
        kv_pad = _pad(kv, ((0, 0), (0, S), (0, 0)))
        kf_pad = _pad(ssm_k, ((0, 0), (0, S)))
        kv_f = (lambda x, axes=(-2, -1): torch.fft.rfft2(x.float(), dim=axes))(kv_pad[:, None, :, :], axes=(1, 2))
        kf_f = (lambda x, axes=(-2, -1): torch.fft.rfft2(x.float(), dim=axes))(kf_pad[:, None, :], axes=(1, 2))
        kf_f = (lambda x, *d: x.permute(*d))(kf_f, 1, 2, 0)
        y_f = kv_f * kf_f[None, :, :, :]
        y = (lambda x, s, axes=(-2, -1): torch.fft.irfft2(x, s=s, dim=axes).to(torch.bfloat16))(y_f, (1, L), axes=(1, 2))[:, 0, :S, :]
        y = y + kv * ssm_D[None, None, :]
        return q * y
    x = A_x
    g = _sigmoid((x * gate_w).sum(-1, keepdims=True))
    a = _A_ref(x, A_mem0, A_Wq, A_Wk, A_Wv, A_Wo, A_seg_len)
    b = _B_ref(x, B_k, B_v, B_shift_k, B_ssm_k, B_ssm_D)
    return g * a + (1 - g) * b
```

```asm
; @launch grid=(256,1,1) block=(256,1,1) lds=163840
.amdgcn_target "amdgcn-amd-amdhsa--gfx950"
.text
.globl gated_mix__memory_aug_recurrent_mem_tr__ssm_conv_h3__prompt_kernel
.p2align 8
.type gated_mix__memory_aug_recurrent_mem_tr__ssm_conv_h3__prompt_kernel,@function
gated_mix__memory_aug_recurrent_mem_tr__ssm_conv_h3__prompt_kernel:
    s_cmp_ge_u32 s2, 256
    s_cbranch_scc1 L_end
    s_load_dwordx2 s[4:5], s[0:1], 128
    s_load_dwordx2 s[8:9], s[0:1], 0
    s_load_dwordx2 s[16:17], s[0:1], 120
    v_lshrrev_b32 v1, 6, v0
    s_and_b32 s20, s2, 7
    v_readfirstlane_b32 s22, v1
    v_and_b32 v0, 63, v0
    s_lshr_b32 s21, s2, 3
    s_getreg_b32 s25, hwreg(HW_REG_XCC_ID)
    s_mov_b32 s23, 400000
    s_waitcnt lgkmcnt(0)
    s_and_b32 s5, s5, 0xffff
    s_mov_b32 s6, 268435456
    s_mov_b32 s7, 0x20000
    s_and_b32 s9, s9, 0xffff
    s_mov_b32 s10, 2621440
    s_mov_b32 s11, 0x20000
    s_and_b32 s17, s17, 0xffff
    s_mov_b32 s18, 256
    s_mov_b32 s19, 0x20000
    s_cmp_lg_u32 s22, 0
    s_cbranch_scc1 L_nocensus_1
    s_mul_i32 s26, s25, 6
    s_lshl_b64 s[28:29], 1, s26
    s_cmp_lt_u32 s25, 8
    s_cselect_b64 s[28:29], s[28:29], 0
    s_add_u32 s29, s29, 0x1000000
    v_mov_b32 v2, s28
    v_mov_b32 v3, s29
    s_lshl_b32 s26, s20, 3
    v_mov_b32 v4, s26
    s_mov_b64 exec, 1
    buffer_atomic_add_x2 v[2:3], v4, s[16:19], 0 offen offset:64
    s_mov_b64 exec, -1
L_nocensus_1:
    s_cmp_lt_u32 s21, 18
    s_cbranch_scc1 L_s1
    s_cmp_lt_u32 s21, 28
    s_cbranch_scc1 L_s2
    s_branch L_init
L_fail:
    v_mov_b32 v1, s29
    s_lshl_b32 s29, s29, 2
    s_add_u32 s29, s29, 160
    v_mov_b32 v2, s29
    v_mov_b32 v1, s24
    v_add_u32 v1, 1000, v1
    buffer_store_dword v1, v2, s[16:19], 0 offen
L_end:
    s_endpgm
L_init:
    v_mov_b32 v4, -1
    v_mov_b32 v5, -1
    v_mov_b32 v6, -1
    v_mov_b32 v7, -1
    s_load_dwordx2 s[12:13], s[0:1], 8
    s_lshl_b32 s26, s22, 6
    v_add_u32 v9, s26, v0
    v_lshlrev_b32 v1, 4, v9
    s_waitcnt lgkmcnt(0)
    s_and_b32 s13, s13, 0xffff
    s_mov_b32 s14, 10240
    s_mov_b32 s15, 0x20000
    s_cmp_lg_u32 s21, 31
    s_cbranch_scc1 L_ig_2
    v_add_u32 v36, 0, v9
    v_lshrrev_b32 v3, 6, v36
    v_and_b32 v8, 7, v36
    v_bfe_u32 v16, v36, 3, 1
    v_bfe_u32 v10, v36, 4, 2
    v_mul_u32_u24 v8, 1280, v8
    v_lshl_add_u32 v8, v3, 7, v8
    v_lshl_add_u32 v8, v10, 5, v8
    v_lshl_add_u32 v8, v16, 2, v8
    v_cmp_gt_u32 vcc, 640, v36
    v_mov_b32 v11, 536870912
    v_lshlrev_b32 v36, 4, v36
    v_cndmask_b32 v8, v11, v8, vcc
    v_cndmask_b32 v36, v11, v36, vcc
    buffer_load_dword v24, v8, s[12:15], 0 offen offset:0
    buffer_load_dword v25, v8, s[12:15], 0 offen offset:8
    buffer_load_dword v26, v8, s[12:15], 0 offen offset:16
    buffer_load_dword v27, v8, s[12:15], 0 offen offset:24
    v_add_u32 v37, 256, v9
    v_lshrrev_b32 v3, 6, v37
    v_and_b32 v8, 7, v37
    v_bfe_u32 v16, v37, 3, 1
    v_bfe_u32 v10, v37, 4, 2
    v_mul_u32_u24 v8, 1280, v8
    v_lshl_add_u32 v8, v3, 7, v8
    v_lshl_add_u32 v8, v10, 5, v8
    v_lshl_add_u32 v8, v16, 2, v8
    v_cmp_gt_u32 vcc, 640, v37
    v_mov_b32 v11, 536870912
    v_lshlrev_b32 v37, 4, v37
    v_cndmask_b32 v8, v11, v8, vcc
    v_cndmask_b32 v37, v11, v37, vcc
    buffer_load_dword v28, v8, s[12:15], 0 offen offset:0
    buffer_load_dword v29, v8, s[12:15], 0 offen offset:8
    buffer_load_dword v30, v8, s[12:15], 0 offen offset:16
    buffer_load_dword v31, v8, s[12:15], 0 offen offset:24
    v_add_u32 v38, 512, v9
    v_lshrrev_b32 v3, 6, v38
    v_and_b32 v8, 7, v38
    v_bfe_u32 v16, v38, 3, 1
    v_bfe_u32 v10, v38, 4, 2
    v_mul_u32_u24 v8, 1280, v8
    v_lshl_add_u32 v8, v3, 7, v8
    v_lshl_add_u32 v8, v10, 5, v8
    v_lshl_add_u32 v8, v16, 2, v8
    v_cmp_gt_u32 vcc, 640, v38
    v_mov_b32 v11, 536870912
    v_lshlrev_b32 v38, 4, v38
    v_cndmask_b32 v8, v11, v8, vcc
    v_cndmask_b32 v38, v11, v38, vcc
    buffer_load_dword v32, v8, s[12:15], 0 offen offset:0
    buffer_load_dword v33, v8, s[12:15], 0 offen offset:8
    buffer_load_dword v34, v8, s[12:15], 0 offen offset:16
    buffer_load_dword v35, v8, s[12:15], 0 offen offset:24
    s_mul_i32 s27, s20, 40960
    s_waitcnt vmcnt(0)
    v_min_u32 v24, -2, v24
    v_min_u32 v25, -2, v25
    v_min_u32 v26, -2, v26
    v_min_u32 v27, -2, v27
    v_min_u32 v28, -2, v28
    v_min_u32 v29, -2, v29
    v_min_u32 v30, -2, v30
    v_min_u32 v31, -2, v31
    v_min_u32 v32, -2, v32
    v_min_u32 v33, -2, v33
    v_min_u32 v34, -2, v34
    v_min_u32 v35, -2, v35
    buffer_store_dwordx4 v[24:27], v36, s[4:7], s27 offen sc1
    buffer_store_dwordx4 v[28:31], v37, s[4:7], s27 offen sc1
    buffer_store_dwordx4 v[32:35], v38, s[4:7], s27 offen sc1
L_ig_2:
    s_sub_u32 s26, s2, 224
    s_lshl_b32 s26, s26, 12
    s_add_u32 s27, s26, 327680
    buffer_store_dwordx4 v[4:7], v1, s[4:7], s27 offen sc1
    s_add_u32 s27, s27, 131072
    buffer_store_dwordx4 v[4:7], v1, s[4:7], s27 offen sc1
    s_add_u32 s27, s27, 131072
    buffer_store_dwordx4 v[4:7], v1, s[4:7], s27 offen sc1
    s_add_u32 s27, s27, 131072
    buffer_store_dwordx4 v[4:7], v1, s[4:7], s27 offen sc1
    s_add_u32 s27, s27, 131072
    buffer_store_dwordx4 v[4:7], v1, s[4:7], s27 offen sc1
    s_add_u32 s27, s27, 131072
    buffer_store_dwordx4 v[4:7], v1, s[4:7], s27 offen sc1
    s_add_u32 s27, s27, 131072
    buffer_store_dwordx4 v[4:7], v1, s[4:7], s27 offen sc1
    s_add_u32 s27, s27, 131072
    buffer_store_dwordx4 v[4:7], v1, s[4:7], s27 offen sc1
    s_add_u32 s27, s27, 131072
    buffer_store_dwordx4 v[4:7], v1, s[4:7], s27 offen sc1
    s_add_u32 s27, s27, 131072
    buffer_store_dwordx4 v[4:7], v1, s[4:7], s27 offen sc1
    s_add_u32 s27, s27, 131072
    buffer_store_dwordx4 v[4:7], v1, s[4:7], s27 offen sc1
    s_add_u32 s27, s27, 131072
    buffer_store_dwordx4 v[4:7], v1, s[4:7], s27 offen sc1
    s_add_u32 s27, s27, 131072
    s_add_u32 s27, s26, 2097152
    buffer_store_dwordx4 v[4:7], v1, s[4:7], s27 offen sc1
    s_add_u32 s27, s27, 131072
    buffer_store_dwordx4 v[4:7], v1, s[4:7], s27 offen sc1
    s_add_u32 s27, s27, 131072
    buffer_store_dwordx4 v[4:7], v1, s[4:7], s27 offen sc1
    s_add_u32 s27, s27, 131072
    buffer_store_dwordx4 v[4:7], v1, s[4:7], s27 offen sc1
    s_add_u32 s27, s27, 131072
    buffer_store_dwordx4 v[4:7], v1, s[4:7], s27 offen sc1
    s_add_u32 s27, s27, 131072
    s_cmp_eq_u32 s21, 31
    s_cbranch_scc1 L_id_5
    s_cmp_eq_u32 s21, 30
    s_cbranch_scc1 L_if_4
    s_mul_i32 s27, s20, 40960
    s_sub_u32 s26, s21, 28
    s_mul_i32 s26, s26, 15360
    s_add_u32 s27, s27, s26
    s_add_u32 s27, s27, 10240
    buffer_store_dwordx4 v[4:7], v1, s[4:7], s27 offen sc1
    s_add_u32 s27, s27, 4096
    buffer_store_dwordx4 v[4:7], v1, s[4:7], s27 offen sc1
    s_add_u32 s27, s27, 4096
    buffer_store_dwordx4 v[4:7], v1, s[4:7], s27 offen sc1
    s_add_u32 s27, s27, 4096
    v_cmp_gt_u32 vcc, 192, v9
    v_mov_b32 v2, 536870912
    s_nop 0
    v_cndmask_b32 v1, v2, v1, vcc
    buffer_store_dwordx4 v[4:7], v1, s[4:7], s27 offen sc1
    s_add_u32 s27, s27, 4096
    s_branch L_id_5
L_if_4:
    v_mov_b32 v4, 0
    v_mov_b32 v5, 0
    v_mov_b32 v6, 0
    v_mov_b32 v7, 0
    v_cmp_gt_u32 vcc, 96, v9
    v_mov_b32 v2, 536870912
    s_mul_i32 s27, s20, 1536
    v_cndmask_b32 v1, v2, v1, vcc
    s_add_u32 s27, s27, 2818048
    buffer_store_dwordx4 v[4:7], v1, s[4:7], s27 offen sc1
    v_lshrrev_b32 v1, 6, v9
    v_lshlrev_b32 v1, 13, v1
    v_lshl_add_u32 v1, v0, 4, v1
    s_lshl_b32 s27, s20, 10
    s_add_u32 s27, s27, 2752512
    buffer_store_dwordx4 v[4:7], v1, s[4:7], s27 offen sc1
    s_branch L_id_5
L_id_5:
    s_waitcnt vmcnt(0) lgkmcnt(0)
    s_barrier
    s_cmp_lg_u32 s22, 0
    s_cbranch_scc1 L_in_6
    v_mov_b32 v2, 1
    v_mov_b32 v3, 224
    s_mov_b64 exec, 1
    buffer_atomic_add v2, v3, s[16:19], 0 offen
    s_mov_b64 exec, -1
L_in_6:
    s_load_dwordx4 s[32:35], s[0:1], 16
    s_load_dwordx2 s[36:37], s[0:1], 32
    s_sub_u32 s26, s21, 28
    s_lshl_b32 s26, s26, 2
    s_add_u32 s26, s26, s22
    s_mul_i32 s26, s26, 98304
    s_mul_i32 s27, s20, 1536
    s_add_u32 s26, s26, s27
    s_add_u32 s26, s26, 6291456
    v_lshrrev_b32 v1, 3, v0
    v_mul_u32_u24 v1, 12288, v1
    v_and_b32 v2, 7, v0
    v_lshl_add_u32 v1, v2, 4, v1
    s_waitcnt lgkmcnt(0)
    s_mov_b64 s[12:13], s[32:33]
    s_and_b32 s13, s13, 0xffff
    s_mov_b32 s14, 7864320
    s_mov_b32 s15, 0x20000
    buffer_load_dwordx4 v[20:23], v1, s[12:15], s26 offen offset:0
    buffer_load_dwordx4 v[20:23], v1, s[12:15], s26 offen offset:128
    buffer_load_dwordx4 v[20:23], v1, s[12:15], s26 offen offset:256
    buffer_load_dwordx4 v[20:23], v1, s[12:15], s26 offen offset:384
    buffer_load_dwordx4 v[20:23], v1, s[12:15], s26 offen offset:512
    buffer_load_dwordx4 v[20:23], v1, s[12:15], s26 offen offset:640
    buffer_load_dwordx4 v[20:23], v1, s[12:15], s26 offen offset:768
    buffer_load_dwordx4 v[20:23], v1, s[12:15], s26 offen offset:896
    buffer_load_dwordx4 v[20:23], v1, s[12:15], s26 offen offset:1024
    buffer_load_dwordx4 v[20:23], v1, s[12:15], s26 offen offset:1152
    buffer_load_dwordx4 v[20:23], v1, s[12:15], s26 offen offset:1280
    buffer_load_dwordx4 v[20:23], v1, s[12:15], s26 offen offset:1408
    s_mov_b64 s[12:13], s[34:35]
    s_and_b32 s13, s13, 0xffff
    s_mov_b32 s14, 7864320
    s_mov_b32 s15, 0x20000
    buffer_load_dwordx4 v[20:23], v1, s[12:15], s26 offen offset:0
    buffer_load_dwordx4 v[20:23], v1, s[12:15], s26 offen offset:128
    buffer_load_dwordx4 v[20:23], v1, s[12:15], s26 offen offset:256
    buffer_load_dwordx4 v[20:23], v1, s[12:15], s26 offen offset:384
    buffer_load_dwordx4 v[20:23], v1, s[12:15], s26 offen offset:512
    buffer_load_dwordx4 v[20:23], v1, s[12:15], s26 offen offset:640
    buffer_load_dwordx4 v[20:23], v1, s[12:15], s26 offen offset:768
    buffer_load_dwordx4 v[20:23], v1, s[12:15], s26 offen offset:896
    buffer_load_dwordx4 v[20:23], v1, s[12:15], s26 offen offset:1024
    buffer_load_dwordx4 v[20:23], v1, s[12:15], s26 offen offset:1152
    buffer_load_dwordx4 v[20:23], v1, s[12:15], s26 offen offset:1280
    buffer_load_dwordx4 v[20:23], v1, s[12:15], s26 offen offset:1408
    s_mov_b64 s[12:13], s[36:37]
    s_and_b32 s13, s13, 0xffff
    s_mov_b32 s14, 7864320
    s_mov_b32 s15, 0x20000
    buffer_load_dwordx4 v[20:23], v1, s[12:15], s26 offen offset:0
    buffer_load_dwordx4 v[20:23], v1, s[12:15], s26 offen offset:128
    buffer_load_dwordx4 v[20:23], v1, s[12:15], s26 offen offset:256
    buffer_load_dwordx4 v[20:23], v1, s[12:15], s26 offen offset:384
    buffer_load_dwordx4 v[20:23], v1, s[12:15], s26 offen offset:512
    buffer_load_dwordx4 v[20:23], v1, s[12:15], s26 offen offset:640
    buffer_load_dwordx4 v[20:23], v1, s[12:15], s26 offen offset:768
    buffer_load_dwordx4 v[20:23], v1, s[12:15], s26 offen offset:896
    buffer_load_dwordx4 v[20:23], v1, s[12:15], s26 offen offset:1024
    buffer_load_dwordx4 v[20:23], v1, s[12:15], s26 offen offset:1152
    buffer_load_dwordx4 v[20:23], v1, s[12:15], s26 offen offset:1280
    buffer_load_dwordx4 v[20:23], v1, s[12:15], s26 offen offset:1408
    s_add_u32 s26, s26, 1572864
    s_cmp_lt_u32 s21, 30
    s_cbranch_scc1 L_xs
    s_branch L_bg
L_s1:
    s_lshl_b32 s30, s21, 2
    s_add_u32 s30, s30, s22
    s_mul_i32 s32, s21, 43
    s_lshr_b32 s32, s32, 8
    s_mul_i32 s26, s32, 24
    s_sub_u32 s26, s30, s26
    s_mul_i32 s31, s26, 43
    s_lshr_b32 s31, s31, 8
    s_mul_i32 s27, s31, 6
    s_sub_u32 s33, s26, s27
    s_mul_i32 s95, s31, 3
    s_add_u32 s95, s95, s32
    s_mul_i32 s95, s95, 6
    s_add_u32 s95, s95, s33
    s_load_dwordx4 s[52:55], s[0:1], 16
    s_load_dwordx2 s[56:57], s[0:1], 32
    v_lshlrev_b32 v1, 4, v0
    s_and_b32 s28, s22, 1
    s_lshl_b32 s29, s28, 2
    v_lshrrev_b32 v10, 3, v0
    v_and_b32 v11, 2, v10
    v_or_b32 v11, s29, v11
    v_xor_b32 v11, v0, v11
    v_and_b32 v11, 7, v11
    v_mul_u32_u24 v10, 12288, v10
    v_lshl_add_u32 v10, v11, 4, v10
    s_waitcnt lgkmcnt(0)
    s_cmp_eq_u32 s32, 1
    s_cselect_b64 s[12:13], s[54:55], s[52:53]
    s_cmp_eq_u32 s32, 2
    s_cselect_b64 s[12:13], s[56:57], s[12:13]
    s_and_b32 s13, s13, 0xffff
    s_mov_b32 s14, 7864320
    s_mov_b32 s15, 0x20000
    s_lshl_b32 s26, s20, 2
    s_add_u32 s26, s26, s31
    s_mul_i32 s26, s26, 384
    s_lshr_b32 s27, s33, 1
    s_lshl_b32 s27, s27, 7
    s_add_u32 s26, s26, s27
    s_mul_i32 s27, s28, 98304
    s_add_u32 s26, s26, s27
    s_lshr_b32 s46, s22, 1
    s_mul_i32 s46, s46, 40960
    s_lshl_b32 s27, s28, 10
    s_add_u32 s41, s46, s27
    s_mul_i32 s27, s2, 0
    s_mul_i32 s28, s27, 3277
    s_lshr_b32 s28, s28, 16
    s_mul_i32 s28, s28, 20
    s_sub_u32 s27, s27, s28
    s_lshl_b32 s28, s27, 11
    s_add_u32 m0, s41, s28
    s_mul_i32 s28, s27, 196608
    s_add_u32 s28, s28, s26
    buffer_load_dwordx4 v10, s[12:15], s28 offen nt lds
    s_add_u32 s27, s27, 1
    s_cmp_eq_u32 s27, 20
    s_cselect_b32 s27, 0, s27
    s_lshl_b32 s28, s27, 11
    s_add_u32 m0, s41, s28
    s_mul_i32 s28, s27, 196608
    s_add_u32 s28, s28, s26
    buffer_load_dwordx4 v10, s[12:15], s28 offen nt lds
    s_add_u32 s27, s27, 1
    s_cmp_eq_u32 s27, 20
    s_cselect_b32 s27, 0, s27
    s_lshl_b32 s28, s27, 11
    s_add_u32 m0, s41, s28
    s_mul_i32 s28, s27, 196608
    s_add_u32 s28, s28, s26
    buffer_load_dwordx4 v10, s[12:15], s28 offen nt lds
    s_add_u32 s27, s27, 1
    s_cmp_eq_u32 s27, 20
    s_cselect_b32 s27, 0, s27
    s_lshl_b32 s28, s27, 11
    s_add_u32 m0, s41, s28
    s_mul_i32 s28, s27, 196608
    s_add_u32 s28, s28, s26
    buffer_load_dwordx4 v10, s[12:15], s28 offen nt lds
    s_add_u32 s27, s27, 1
    s_cmp_eq_u32 s27, 20
    s_cselect_b32 s27, 0, s27
    s_lshl_b32 s28, s27, 11
    s_add_u32 m0, s41, s28
    s_mul_i32 s28, s27, 196608
    s_add_u32 s28, s28, s26
    buffer_load_dwordx4 v10, s[12:15], s28 offen nt lds
    s_add_u32 s27, s27, 1
    s_cmp_eq_u32 s27, 20
    s_cselect_b32 s27, 0, s27
    s_lshl_b32 s28, s27, 11
    s_add_u32 m0, s41, s28
    s_mul_i32 s28, s27, 196608
    s_add_u32 s28, s28, s26
    buffer_load_dwordx4 v10, s[12:15], s28 offen nt lds
    s_add_u32 s27, s27, 1
    s_cmp_eq_u32 s27, 20
    s_cselect_b32 s27, 0, s27
    s_lshl_b32 s28, s27, 11
    s_add_u32 m0, s41, s28
    s_mul_i32 s28, s27, 196608
    s_add_u32 s28, s28, s26
    buffer_load_dwordx4 v10, s[12:15], s28 offen nt lds
    s_add_u32 s27, s27, 1
    s_cmp_eq_u32 s27, 20
    s_cselect_b32 s27, 0, s27
    s_lshl_b32 s28, s27, 11
    s_add_u32 m0, s41, s28
    s_mul_i32 s28, s27, 196608
    s_add_u32 s28, s28, s26
    buffer_load_dwordx4 v10, s[12:15], s28 offen nt lds
    s_add_u32 s27, s27, 1
    s_cmp_eq_u32 s27, 20
    s_cselect_b32 s27, 0, s27
    s_lshl_b32 s28, s27, 11
    s_add_u32 m0, s41, s28
    s_mul_i32 s28, s27, 196608
    s_add_u32 s28, s28, s26
    buffer_load_dwordx4 v10, s[12:15], s28 offen nt lds
    s_add_u32 s27, s27, 1
    s_cmp_eq_u32 s27, 20
    s_cselect_b32 s27, 0, s27
    s_lshl_b32 s28, s27, 11
    s_add_u32 m0, s41, s28
    s_mul_i32 s28, s27, 196608
    s_add_u32 s28, s28, s26
    buffer_load_dwordx4 v10, s[12:15], s28 offen nt lds
    s_add_u32 s27, s27, 1
    s_cmp_eq_u32 s27, 20
    s_cselect_b32 s27, 0, s27
    s_lshl_b32 s28, s27, 11
    s_add_u32 m0, s41, s28
    s_mul_i32 s28, s27, 196608
    s_add_u32 s28, s28, s26
    buffer_load_dwordx4 v10, s[12:15], s28 offen nt lds
    s_add_u32 s27, s27, 1
    s_cmp_eq_u32 s27, 20
    s_cselect_b32 s27, 0, s27
    s_lshl_b32 s28, s27, 11
    s_add_u32 m0, s41, s28
    s_mul_i32 s28, s27, 196608
    s_add_u32 s28, s28, s26
    buffer_load_dwordx4 v10, s[12:15], s28 offen nt lds
    s_add_u32 s27, s27, 1
    s_cmp_eq_u32 s27, 20
    s_cselect_b32 s27, 0, s27
    s_lshl_b32 s28, s27, 11
    s_add_u32 m0, s41, s28
    s_mul_i32 s28, s27, 196608
    s_add_u32 s28, s28, s26
    buffer_load_dwordx4 v10, s[12:15], s28 offen nt lds
    s_add_u32 s27, s27, 1
    s_cmp_eq_u32 s27, 20
    s_cselect_b32 s27, 0, s27
    s_lshl_b32 s28, s27, 11
    s_add_u32 m0, s41, s28
    s_mul_i32 s28, s27, 196608
    s_add_u32 s28, s28, s26
    buffer_load_dwordx4 v10, s[12:15], s28 offen nt lds
    s_add_u32 s27, s27, 1
    s_cmp_eq_u32 s27, 20
    s_cselect_b32 s27, 0, s27
    s_lshl_b32 s28, s27, 11
    s_add_u32 m0, s41, s28
    s_mul_i32 s28, s27, 196608
    s_add_u32 s28, s28, s26
    buffer_load_dwordx4 v10, s[12:15], s28 offen nt lds
    s_add_u32 s27, s27, 1
    s_cmp_eq_u32 s27, 20
    s_cselect_b32 s27, 0, s27
    s_lshl_b32 s28, s27, 11
    s_add_u32 m0, s41, s28
    s_mul_i32 s28, s27, 196608
    s_add_u32 s28, s28, s26
    buffer_load_dwordx4 v10, s[12:15], s28 offen nt lds
    s_add_u32 s27, s27, 1
    s_cmp_eq_u32 s27, 20
    s_cselect_b32 s27, 0, s27
    s_lshl_b32 s28, s27, 11
    s_add_u32 m0, s41, s28
    s_mul_i32 s28, s27, 196608
    s_add_u32 s28, s28, s26
    buffer_load_dwordx4 v10, s[12:15], s28 offen nt lds
    s_add_u32 s27, s27, 1
    s_cmp_eq_u32 s27, 20
    s_cselect_b32 s27, 0, s27
    s_lshl_b32 s28, s27, 11
    s_add_u32 m0, s41, s28
    s_mul_i32 s28, s27, 196608
    s_add_u32 s28, s28, s26
    buffer_load_dwordx4 v10, s[12:15], s28 offen nt lds
    s_add_u32 s27, s27, 1
    s_cmp_eq_u32 s27, 20
    s_cselect_b32 s27, 0, s27
    s_lshl_b32 s28, s27, 11
    s_add_u32 m0, s41, s28
    s_mul_i32 s28, s27, 196608
    s_add_u32 s28, s28, s26
    buffer_load_dwordx4 v10, s[12:15], s28 offen nt lds
    s_add_u32 s27, s27, 1
    s_cmp_eq_u32 s27, 20
    s_cselect_b32 s27, 0, s27
    s_lshl_b32 s28, s27, 11
    s_add_u32 m0, s41, s28
    s_mul_i32 s28, s27, 196608
    s_add_u32 s28, s28, s26
    buffer_load_dwordx4 v10, s[12:15], s28 offen nt lds
    s_add_u32 s27, s27, 1
    s_cmp_eq_u32 s27, 20
    s_cselect_b32 s27, 0, s27
    s_add_u32 s41, s41, 81920
    s_add_u32 s26, s26, 3932160
    s_lshl_b32 s28, s27, 11
    s_add_u32 m0, s41, s28
    s_mul_i32 s28, s27, 196608
    s_add_u32 s28, s28, s26
    buffer_load_dwordx4 v10, s[12:15], s28 offen nt lds
    s_add_u32 s27, s27, 1
    s_cmp_eq_u32 s27, 20
    s_cselect_b32 s27, 0, s27
    s_lshl_b32 s28, s27, 11
    s_add_u32 m0, s41, s28
    s_mul_i32 s28, s27, 196608
    s_add_u32 s28, s28, s26
    buffer_load_dwordx4 v10, s[12:15], s28 offen nt lds
    s_add_u32 s27, s27, 1
    s_cmp_eq_u32 s27, 20
    s_cselect_b32 s27, 0, s27
    s_lshl_b32 s28, s27, 11
    s_add_u32 m0, s41, s28
    s_mul_i32 s28, s27, 196608
    s_add_u32 s28, s28, s26
    buffer_load_dwordx4 v10, s[12:15], s28 offen nt lds
    s_add_u32 s27, s27, 1
    s_cmp_eq_u32 s27, 20
    s_cselect_b32 s27, 0, s27
    s_lshl_b32 s28, s27, 11
    s_add_u32 m0, s41, s28
    s_mul_i32 s28, s27, 196608
    s_add_u32 s28, s28, s26
    buffer_load_dwordx4 v10, s[12:15], s28 offen nt lds
    s_add_u32 s27, s27, 1
    s_cmp_eq_u32 s27, 20
    s_cselect_b32 s27, 0, s27
    s_lshl_b32 s28, s27, 11
    s_add_u32 m0, s41, s28
    s_mul_i32 s28, s27, 196608
    s_add_u32 s28, s28, s26
    buffer_load_dwordx4 v10, s[12:15], s28 offen nt lds
    s_add_u32 s27, s27, 1
    s_cmp_eq_u32 s27, 20
    s_cselect_b32 s27, 0, s27
    s_lshl_b32 s28, s27, 11
    s_add_u32 m0, s41, s28
    s_mul_i32 s28, s27, 196608
    s_add_u32 s28, s28, s26
    buffer_load_dwordx4 v10, s[12:15], s28 offen nt lds
    s_add_u32 s27, s27, 1
    s_cmp_eq_u32 s27, 20
    s_cselect_b32 s27, 0, s27
    s_lshl_b32 s28, s27, 11
    s_add_u32 m0, s41, s28
    s_mul_i32 s28, s27, 196608
    s_add_u32 s28, s28, s26
    buffer_load_dwordx4 v10, s[12:15], s28 offen nt lds
    s_add_u32 s27, s27, 1
    s_cmp_eq_u32 s27, 20
    s_cselect_b32 s27, 0, s27
    s_lshl_b32 s28, s27, 11
    s_add_u32 m0, s41, s28
    s_mul_i32 s28, s27, 196608
    s_add_u32 s28, s28, s26
    buffer_load_dwordx4 v10, s[12:15], s28 offen nt lds
    s_add_u32 s27, s27, 1
    s_cmp_eq_u32 s27, 20
    s_cselect_b32 s27, 0, s27
    s_lshl_b32 s28, s27, 11
    s_add_u32 m0, s41, s28
    s_mul_i32 s28, s27, 196608
    s_add_u32 s28, s28, s26
    buffer_load_dwordx4 v10, s[12:15], s28 offen nt lds
    s_add_u32 s27, s27, 1
    s_cmp_eq_u32 s27, 20
    s_cselect_b32 s27, 0, s27
    s_lshl_b32 s28, s27, 11
    s_add_u32 m0, s41, s28
    s_mul_i32 s28, s27, 196608
    s_add_u32 s28, s28, s26
    buffer_load_dwordx4 v10, s[12:15], s28 offen nt lds
    s_add_u32 s27, s27, 1
    s_cmp_eq_u32 s27, 20
    s_cselect_b32 s27, 0, s27
    s_lshl_b32 s28, s27, 11
    s_add_u32 m0, s41, s28
    s_mul_i32 s28, s27, 196608
    s_add_u32 s28, s28, s26
    buffer_load_dwordx4 v10, s[12:15], s28 offen nt lds
    s_add_u32 s27, s27, 1
    s_cmp_eq_u32 s27, 20
    s_cselect_b32 s27, 0, s27
    s_lshl_b32 s28, s27, 11
    s_add_u32 m0, s41, s28
    s_mul_i32 s28, s27, 196608
    s_add_u32 s28, s28, s26
    buffer_load_dwordx4 v10, s[12:15], s28 offen nt lds
    s_add_u32 s27, s27, 1
    s_cmp_eq_u32 s27, 20
    s_cselect_b32 s27, 0, s27
    s_lshl_b32 s28, s27, 11
    s_add_u32 m0, s41, s28
    s_mul_i32 s28, s27, 196608
    s_add_u32 s28, s28, s26
    buffer_load_dwordx4 v10, s[12:15], s28 offen nt lds
    s_add_u32 s27, s27, 1
    s_cmp_eq_u32 s27, 20
    s_cselect_b32 s27, 0, s27
    s_lshl_b32 s28, s27, 11
    s_add_u32 m0, s41, s28
    s_mul_i32 s28, s27, 196608
    s_add_u32 s28, s28, s26
    buffer_load_dwordx4 v10, s[12:15], s28 offen nt lds
    s_add_u32 s27, s27, 1
    s_cmp_eq_u32 s27, 20
    s_cselect_b32 s27, 0, s27
    s_lshl_b32 s28, s27, 11
    s_add_u32 m0, s41, s28
    s_mul_i32 s28, s27, 196608
    s_add_u32 s28, s28, s26
    buffer_load_dwordx4 v10, s[12:15], s28 offen nt lds
    s_add_u32 s27, s27, 1
    s_cmp_eq_u32 s27, 20
    s_cselect_b32 s27, 0, s27
    s_lshl_b32 s28, s27, 11
    s_add_u32 m0, s41, s28
    s_mul_i32 s28, s27, 196608
    s_add_u32 s28, s28, s26
    buffer_load_dwordx4 v10, s[12:15], s28 offen nt lds
    s_add_u32 s27, s27, 1
    s_cmp_eq_u32 s27, 20
    s_cselect_b32 s27, 0, s27
    s_lshl_b32 s28, s27, 11
    s_add_u32 m0, s41, s28
    s_mul_i32 s28, s27, 196608
    s_add_u32 s28, s28, s26
    buffer_load_dwordx4 v10, s[12:15], s28 offen nt lds
    s_add_u32 s27, s27, 1
    s_cmp_eq_u32 s27, 20
    s_cselect_b32 s27, 0, s27
    s_lshl_b32 s28, s27, 11
    s_add_u32 m0, s41, s28
    s_mul_i32 s28, s27, 196608
    s_add_u32 s28, s28, s26
    buffer_load_dwordx4 v10, s[12:15], s28 offen nt lds
    s_add_u32 s27, s27, 1
    s_cmp_eq_u32 s27, 20
    s_cselect_b32 s27, 0, s27
    s_lshl_b32 s28, s27, 11
    s_add_u32 m0, s41, s28
    s_mul_i32 s28, s27, 196608
    s_add_u32 s28, s28, s26
    buffer_load_dwordx4 v10, s[12:15], s28 offen nt lds
    s_add_u32 s27, s27, 1
    s_cmp_eq_u32 s27, 20
    s_cselect_b32 s27, 0, s27
    s_lshl_b32 s28, s27, 11
    s_add_u32 m0, s41, s28
    s_mul_i32 s28, s27, 196608
    s_add_u32 s28, s28, s26
    buffer_load_dwordx4 v10, s[12:15], s28 offen nt lds
    s_add_u32 s27, s27, 1
    s_cmp_eq_u32 s27, 20
    s_cselect_b32 s27, 0, s27
    s_lshl_b32 s26, s30, 10
    s_add_u32 s26, s26, 8192
    buffer_load_dwordx4 v[20:23], v1, s[8:11], s26 offen
    v_and_b32 v11, 15, v0
    v_lshrrev_b32 v12, 4, v0
    v_cmp_gt_u32 vcc, 8, v11
    v_mov_b32 v13, 0xeeee
    v_mov_b32 v14, 0x4444
    v_cndmask_b32 v4, v13, v14, vcc
    v_mov_b32 v8, -1
    v_lshrrev_b32 v5, 2, v0
    v_mul_u32_u24 v5, 1280, v5
    v_sub_u32 v13, 0, v12
    v_xor_b32 v13, v0, v13
    v_and_b32 v13, 3, v13
    v_lshl_add_u32 v5, v13, 4, v5
    v_lshrrev_b32 v13, 2, v11
    v_sub_u32 v13, 0, v13
    v_xor_b32 v13, v12, v13
    v_and_b32 v13, 3, v13
    v_lshl_add_u32 v13, v11, 2, v13
    v_lshlrev_b32 v6, 4, v13
    v_lshlrev_b32 v7, 5, v13
    v_add_u32 v7, 40960, v7
    v_bfe_u32 v13, v0, 2, 1
    v_bfe_u32 v14, v0, 3, 1
    v_lshl_add_u32 v13, v13, 1, v14
    v_and_b32 v14, 1, v11
    v_lshlrev_b32 v14, 4, v14
    v_mov_b32 v15, 0x3f80
    v_lshlrev_b32 v14, v14, v15
    v_cmp_eq_u32 vcc, 0, v13
    s_nop 1
    v_cndmask_b32 v128, 0, v14, vcc
    v_cmp_eq_u32 vcc, 1, v13
    s_nop 1
    v_cndmask_b32 v129, 0, v14, vcc
    v_cmp_eq_u32 vcc, 2, v13
    s_nop 1
    v_cndmask_b32 v130, 0, v14, vcc
    v_cmp_eq_u32 vcc, 3, v13
    s_nop 1
    v_cndmask_b32 v131, 0, v14, vcc
    s_lshl_b32 s26, s22, 10
    v_add_u32 v144, s26, v1
    v_add_u32 v145, 81920, v144
    v_add_u32 v146, 81920, v1
    s_add_u32 s30, s30, 40
    s_cmp_ge_u32 s30, 72
    s_cselect_b32 s26, 72, 0
    s_sub_u32 s30, s30, s26
    s_cmp_ge_u32 s30, 40
    s_cselect_b32 s26, 40, 0
    s_sub_u32 s26, s30, s26
    s_lshr_b32 s47, s26, 2
    s_lshl_b32 s47, s47, 14
    s_and_b32 s27, s26, 3
    s_lshl_b32 s27, s27, 11
    s_add_u32 s47, s47, s27
    s_add_u32 s47, s47, 2097152
    v_lshlrev_b32 v13, 2, v0
    s_lshl_b32 s26, s26, 8
    s_cmp_ge_u32 s30, 40
    s_cselect_b32 s26, 536870912, s26
    v_add_u32 v2, s26, v13
    v_lshl_add_u32 v188, v0, 2, s26
    v_and_b32 v13, 31, v0
    v_lshlrev_b32 v13, 3, v13
    v_lshrrev_b32 v14, 5, v0
    v_lshl_add_u32 v13, v14, 13, v13
    s_lshl_b32 s26, s20, 8
    s_cmp_ge_u32 s30, 40
    s_cselect_b32 s26, 536870912, s26
    v_add_u32 v161, s26, v13
    v_mov_b32 v162, -1
    v_mov_b32 v163, -1
    v_bfe_u32 v13, v0, 4, 1
    v_lshrrev_b32 v14, 5, v0
    v_lshlrev_b32 v13, 2, v13
    v_lshl_add_u32 v13, v14, 1, v13
    s_and_b32 s26, s33, 1
    s_lshr_b32 s27, s33, 1
    s_lshl_b32 s27, s27, 10
    v_lshrrev_b32 v14, 2, v11
    v_lshl_add_u32 v14, v14, 4, v13
    v_lshlrev_b32 v14, 4, v14
    v_and_b32 v15, 3, v11
    v_lshl_add_u32 v14, v15, 2, v14
    s_lshl_b32 s28, s26, 7
    s_add_u32 s28, s28, s27
    v_add_u32 v14, s28, v14
    v_lshrrev_b32 v15, 3, v11
    v_lshl_add_u32 v15, v15, 4, v13
    v_and_b32 v16, 1, v11
    v_lshl_add_u32 v15, v16, 3, v15
    v_lshlrev_b32 v15, 4, v15
    v_bfe_u32 v16, v11, 1, 2
    v_lshl_add_u32 v15, v16, 2, v15
    s_lshl_b32 s28, s26, 9
    s_add_u32 s28, s28, s27
    v_add_u32 v15, s28, v15
    v_lshl_add_u32 v16, v0, 3, s28
    v_and_b32 v17, 15, v0
    v_lshlrev_b32 v17, 3, v17
    v_lshl_add_u32 v17, v12, 8, v17
    s_lshl_b32 s28, s26, 7
    s_add_u32 s28, s28, s27
    v_add_u32 v17, s28, v17
    s_cmp_eq_u32 s32, 2
    s_cselect_b64 vcc, -1, 0
    v_cndmask_b32 v3, v14, v15, vcc
    v_cndmask_b32 v189, v17, v16, vcc
    s_cselect_b32 s28, 256, 0
    s_sub_u32 s28, 512, s28
    s_sub_u32 s27, s28, 16
    v_bfe_u32 v14, v0, 3, 1
    v_mul_lo_u32 v14, s27, v14
    v_sub_u32 v3, v3, v14
    v_add_u32 v191, s28, v3
    v_cmp_eq_u32 vcc, 0, v0
    v_mov_b32 v14, 536870912
    s_nop 0
    v_cndmask_b32 v9, v14, v0, vcc
    v_cmp_gt_u32 vcc, 2, v0
    v_lshlrev_b32 v15, 10, v0
    s_nop 0
    v_cndmask_b32 v190, v14, v15, vcc
    s_lshl_b32 s26, s20, 2
    s_add_u32 s26, s26, 128
    v_mov_b32 v160, s26
    v_min_u32 v147, 7, v0
    v_lshlrev_b32 v147, 10, v147
    s_lshl_b32 s58, s20, 7
    s_lshl_b32 s26, s21, 2
    s_add_u32 s59, s58, s26
    s_add_u32 s59, s59, 2828288
    s_cmp_eq_u32 s22, 0
    s_cselect_b32 s59, s59, 536870912
    s_add_u32 s58, s58, 2827264
    s_cmp_lt_u32 s22, 2
    s_mov_b32 s51, 536870912
    s_cselect_b32 s51, 8192, s51
    s_mul_i32 s48, s20, 40960
    s_mul_i32 s26, s31, 3
    s_add_u32 s26, s26, s32
    s_mul_i32 s49, s20, 147456
    s_mul_i32 s27, s26, 3072
    s_add_u32 s49, s49, s27
    s_add_u32 s49, s49, 327680
    s_mul_i32 s43, s20, 606208
    s_lshl_b32 s27, s95, 1
    s_add_u32 s27, s27, s31
    s_lshl_b32 s27, s27, 10
    s_add_u32 s43, s43, s27
    s_add_u32 s43, s43, 2883584
    s_add_u32 s42, s43, 606208
    s_mov_b32 s41, s43
    s_lshl_b32 s44, s20, 9
    s_lshl_b32 s27, s95, 2
    s_add_u32 s44, s44, s27
    s_add_u32 s44, s44, 2818048
    v_bfe_u32 v13, v0, 2, 2
    v_lshl_add_u32 v14, v12, 3, v13
    v_lshlrev_b32 v14, 7, v14
    v_and_b32 v15, 1, v0
    v_lshl_add_u32 v14, v15, 3, v14
    v_add_u32 v14, s46, v14
    v_and_b32 v13, 2, v13
    v_and_b32 v15, 1, v12
    v_lshl_add_u32 v13, v15, 2, v13
    v_bfe_u32 v15, v0, 1, 1
    s_and_b32 s26, s22, 1
    s_lshl_b32 s26, s26, 2
    v_or_b32 v15, s26, v15
    v_xor_b32 v15, v15, v13
    v_xor_b32 v16, 2, v15
    v_lshl_add_u32 v15, v15, 4, v14
    v_lshl_add_u32 v16, v16, 4, v14
    s_waitcnt vmcnt(21)
    s_barrier
    ds_read_b64_tr_b16 a[0:1], v15 offset:0
    ds_read_b64_tr_b16 a[2:3], v15 offset:512
    ds_read_b64_tr_b16 a[80:81], v16 offset:0
    ds_read_b64_tr_b16 a[82:83], v16 offset:512
    ds_read_b64_tr_b16 a[4:5], v15 offset:4096
    ds_read_b64_tr_b16 a[6:7], v15 offset:4608
    ds_read_b64_tr_b16 a[84:85], v16 offset:4096
    ds_read_b64_tr_b16 a[86:87], v16 offset:4608
    ds_read_b64_tr_b16 a[8:9], v15 offset:8192
    ds_read_b64_tr_b16 a[10:11], v15 offset:8704
    ds_read_b64_tr_b16 a[88:89], v16 offset:8192
    ds_read_b64_tr_b16 a[90:91], v16 offset:8704
    ds_read_b64_tr_b16 a[12:13], v15 offset:12288
    ds_read_b64_tr_b16 a[14:15], v15 offset:12800
    ds_read_b64_tr_b16 a[92:93], v16 offset:12288
    ds_read_b64_tr_b16 a[94:95], v16 offset:12800
    ds_read_b64_tr_b16 a[16:17], v15 offset:16384
    ds_read_b64_tr_b16 a[18:19], v15 offset:16896
    ds_read_b64_tr_b16 a[96:97], v16 offset:16384
    ds_read_b64_tr_b16 a[98:99], v16 offset:16896
    ds_read_b64_tr_b16 a[20:21], v15 offset:20480
    ds_read_b64_tr_b16 a[22:23], v15 offset:20992
    ds_read_b64_tr_b16 a[100:101], v16 offset:20480
    ds_read_b64_tr_b16 a[102:103], v16 offset:20992
    ds_read_b64_tr_b16 a[24:25], v15 offset:24576
    ds_read_b64_tr_b16 a[26:27], v15 offset:25088
    ds_read_b64_tr_b16 a[104:105], v16 offset:24576
    ds_read_b64_tr_b16 a[106:107], v16 offset:25088
    ds_read_b64_tr_b16 a[28:29], v15 offset:28672
    ds_read_b64_tr_b16 a[30:31], v15 offset:29184
    ds_read_b64_tr_b16 a[108:109], v16 offset:28672
    ds_read_b64_tr_b16 a[110:111], v16 offset:29184
    ds_read_b64_tr_b16 a[32:33], v15 offset:32768
    ds_read_b64_tr_b16 a[34:35], v15 offset:33280
    ds_read_b64_tr_b16 a[112:113], v16 offset:32768
    ds_read_b64_tr_b16 a[114:115], v16 offset:33280
    ds_read_b64_tr_b16 a[36:37], v15 offset:36864
    ds_read_b64_tr_b16 a[38:39], v15 offset:37376
    ds_read_b64_tr_b16 a[116:117], v16 offset:36864
    ds_read_b64_tr_b16 a[118:119], v16 offset:37376
    v_add_u32 v15, 81920, v15
    v_add_u32 v16, 81920, v16
    s_waitcnt lgkmcnt(0)
    s_barrier
    s_mul_i32 s45, s22, 320
    s_mul_i32 s46, s22, 10240
    s_mov_b32 s50, 0
    s_add_u32 m0, s46, s50
    s_add_u32 s26, s45, 0
    buffer_load_dwordx4 v5, s[8:11], s26 offen lds
    s_add_u32 m0, m0, 1024
    s_add_u32 s26, s45, 20480
    buffer_load_dwordx4 v5, s[8:11], s26 offen lds
    s_add_u32 m0, m0, 1024
    s_add_u32 s26, s45, 64
    buffer_load_dwordx4 v5, s[8:11], s26 offen lds
    s_add_u32 m0, m0, 1024
    s_add_u32 s26, s45, 20544
    buffer_load_dwordx4 v5, s[8:11], s26 offen lds
    s_add_u32 m0, m0, 1024
    s_add_u32 s26, s45, 128
    buffer_load_dwordx4 v5, s[8:11], s26 offen lds
    s_add_u32 m0, m0, 1024
    s_add_u32 s26, s45, 20608
    buffer_load_dwordx4 v5, s[8:11], s26 offen lds
    s_add_u32 m0, m0, 1024
    s_add_u32 s26, s45, 192
    buffer_load_dwordx4 v5, s[8:11], s26 offen lds
    s_add_u32 m0, m0, 1024
    s_add_u32 s26, s45, 20672
    buffer_load_dwordx4 v5, s[8:11], s26 offen lds
    s_add_u32 m0, m0, 1024
    s_add_u32 s26, s45, 256
    buffer_load_dwordx4 v5, s[8:11], s26 offen lds
    s_add_u32 m0, m0, 1024
    s_add_u32 s26, s45, 20736
    buffer_load_dwordx4 v5, s[8:11], s26 offen lds
    s_add_u32 s45, s45, 40960
    s_sub_u32 s50, 40960, s50
    v_lshlrev_b32 v10, 2, v0
    buffer_load_dword v11, v10, s[16:19], 0 offen sc1
    s_waitcnt vmcnt(11)
    s_barrier
    ds_read_b64_tr_b16 a[40:41], v15 offset:0
    ds_read_b64_tr_b16 a[42:43], v15 offset:512
    ds_read_b64_tr_b16 a[120:121], v16 offset:0
    ds_read_b64_tr_b16 a[122:123], v16 offset:512
    ds_read_b64_tr_b16 a[44:45], v15 offset:4096
    ds_read_b64_tr_b16 a[46:47], v15 offset:4608
    ds_read_b64_tr_b16 a[124:125], v16 offset:4096
    ds_read_b64_tr_b16 a[126:127], v16 offset:4608
    ds_read_b64_tr_b16 a[48:49], v15 offset:8192
    ds_read_b64_tr_b16 a[50:51], v15 offset:8704
    ds_read_b64_tr_b16 a[128:129], v16 offset:8192
    ds_read_b64_tr_b16 a[130:131], v16 offset:8704
    ds_read_b64_tr_b16 a[52:53], v15 offset:12288
    ds_read_b64_tr_b16 a[54:55], v15 offset:12800
    ds_read_b64_tr_b16 a[132:133], v16 offset:12288
    ds_read_b64_tr_b16 a[134:135], v16 offset:12800
    ds_read_b64_tr_b16 a[56:57], v15 offset:16384
    ds_read_b64_tr_b16 a[58:59], v15 offset:16896
    ds_read_b64_tr_b16 a[136:137], v16 offset:16384
    ds_read_b64_tr_b16 a[138:139], v16 offset:16896
    ds_read_b64_tr_b16 a[60:61], v15 offset:20480
    ds_read_b64_tr_b16 a[62:63], v15 offset:20992
    ds_read_b64_tr_b16 a[140:141], v16 offset:20480
    ds_read_b64_tr_b16 a[142:143], v16 offset:20992
    ds_read_b64_tr_b16 a[64:65], v15 offset:24576
    ds_read_b64_tr_b16 a[66:67], v15 offset:25088
    ds_read_b64_tr_b16 a[144:145], v16 offset:24576
    ds_read_b64_tr_b16 a[146:147], v16 offset:25088
    ds_read_b64_tr_b16 a[68:69], v15 offset:28672
    ds_read_b64_tr_b16 a[70:71], v15 offset:29184
    ds_read_b64_tr_b16 a[148:149], v16 offset:28672
    ds_read_b64_tr_b16 a[150:151], v16 offset:29184
    ds_read_b64_tr_b16 a[72:73], v15 offset:32768
    ds_read_b64_tr_b16 a[74:75], v15 offset:33280
    ds_read_b64_tr_b16 a[152:153], v16 offset:32768
    ds_read_b64_tr_b16 a[154:155], v16 offset:33280
    ds_read_b64_tr_b16 a[76:77], v15 offset:36864
    ds_read_b64_tr_b16 a[78:79], v15 offset:37376
    ds_read_b64_tr_b16 a[156:157], v16 offset:36864
    ds_read_b64_tr_b16 a[158:159], v16 offset:37376
    s_mov_b32 s24, -2
    s_lshl_b32 s93, s20, 1
    s_add_u32 s93, s93, 16
    s_add_u32 s94, s93, 1
    s_branch L_loc1_8
L_loc_7:
    v_lshlrev_b32 v10, 2, v0
    buffer_load_dword v11, v10, s[16:19], 0 offen sc1
    s_sub_u32 s23, s23, 1
    s_movk_i32 s29, 1
    s_cbranch_scc1 L_fail
L_loc1_8:
    s_waitcnt vmcnt(0)
    v_readlane_b32 s26, v11, s93
    v_readlane_b32 s27, v11, s94
    v_readlane_b32 s29, v11, 56
    s_lshr_b32 s28, s27, 24
    s_min_u32 s28, s28, s29
    s_cmp_lt_u32 s28, 32
    s_cbranch_scc1 L_loc_7
    s_and_b32 s27, s27, 0xffffff
    s_mul_i32 s28, s25, 6
    s_lshl_b64 s[28:29], 32, s28
    s_cmp_eq_u64 s[26:27], s[28:29]
    s_cbranch_scc0 L_s1_glb
    s_cmp_lt_u32 s25, 8
    s_cbranch_scc0 L_s1_glb
    s_branch L_s1_loc
L_s1_loc:
    s_waitcnt lgkmcnt(0)
L_s1_loc_pro:
    s_barrier
    s_add_u32 s26, s24, 1
    v_mov_b32 v12, s26
    v_add_u32 v13, 1, v12
    ds_read_b128 v[164:167], v6 offset:0
    ds_read_b128 v[168:171], v6 offset:1024
    ds_read_b128 v[172:175], v6 offset:2048
    ds_read_b128 v[176:179], v6 offset:3072
L_s1_loc_bub:
    s_cmp_ge_i32 s24, 62
    s_cbranch_scc1 L_s1_loc_nox
    s_cmp_lt_i32 s24, 1
    s_cselect_b32 s39, 536870912, s39
    s_cselect_b32 s40, 536870912, s40
    s_cselect_b32 s52, 536870912, s52
    s_waitcnt lgkmcnt(2)
    v_mfma_f32_16x16x32_bf16 v[88:91], a[0:3], v[164:167], 0
    ds_read_b128 v[180:183], v6 offset:4096
    s_mov_b32 s63, s39
    v_mfma_f32_16x16x32_bf16 v[92:95], a[80:83], v[164:167], 0
    ds_read_b128 v[184:187], v6 offset:5120
    s_mov_b32 s64, s40
    v_mfma_f32_16x16x32_bf16 v[96:99], a[0:3], v[168:171], 0
    buffer_store_dwordx2 v[162:163], v161, s[4:7], s52 offen sc1
    buffer_load_dword v14, v160, s[16:19], 0 offen sc1
    v_mfma_f32_16x16x32_bf16 v[100:103], a[80:83], v[168:171], 0
    s_waitcnt lgkmcnt(2)
    v_mfma_f32_16x16x32_bf16 v[88:91], a[4:7], v[172:175], v[88:91]
    ds_read_b128 v[164:167], v6 offset:6144
    s_and_b32 s27, s24, 3
    v_mfma_f32_16x16x32_bf16 v[92:95], a[84:87], v[172:175], v[92:95]
    ds_read_b128 v[168:171], v6 offset:7168
    s_mul_i32 s34, s27, 163840
    v_mfma_f32_16x16x32_bf16 v[96:99], a[4:7], v[176:179], v[96:99]
    s_add_u32 s34, s34, s47
    s_mul_i32 s39, s27, 10240
    v_mfma_f32_16x16x32_bf16 v[100:103], a[84:87], v[176:179], v[100:103]
    s_waitcnt lgkmcnt(2)
    v_mfma_f32_16x16x32_bf16 v[88:91], a[8:11], v[180:183], v[88:91]
    ds_read_b128 v[172:175], v6 offset:8192
    s_add_u32 s39, s39, s48
    v_mfma_f32_16x16x32_bf16 v[92:95], a[88:91], v[180:183], v[92:95]
    ds_read_b128 v[176:179], v6 offset:9216
    s_add_u32 s27, s24, 3
    v_mfma_f32_16x16x32_bf16 v[96:99], a[8:11], v[184:187], v[96:99]
    s_and_b32 s27, s27, 3
    s_mul_i32 s52, s27, 163840
    v_mfma_f32_16x16x32_bf16 v[100:103], a[88:91], v[184:187], v[100:103]
    s_waitcnt lgkmcnt(2)
    v_mfma_f32_16x16x32_bf16 v[88:91], a[12:15], v[164:167], v[88:91]
    ds_read_b128 v[180:183], v6 offset:10240
    s_add_u32 s52, s52, s47
    v_mfma_f32_16x16x32_bf16 v[92:95], a[92:95], v[164:167], v[92:95]
    ds_read_b128 v[184:187], v6 offset:11264
    s_mul_i32 s40, s27, 36864
    v_mfma_f32_16x16x32_bf16 v[96:99], a[12:15], v[168:171], v[96:99]
    s_add_u32 s40, s40, s49
    s_add_u32 s27, s24, 1
    v_mfma_f32_16x16x32_bf16 v[100:103], a[92:95], v[168:171], v[100:103]
    s_waitcnt lgkmcnt(2)
    v_mfma_f32_16x16x32_bf16 v[88:91], a[16:19], v[172:175], v[88:91]
    ds_read_b128 v[164:167], v6 offset:12288
    s_and_b32 s27, s27, 3
    v_mfma_f32_16x16x32_bf16 v[92:95], a[96:99], v[172:175], v[92:95]
    ds_read_b128 v[168:171], v6 offset:13312
    s_mul_i32 s35, s27, 10240
    v_mfma_f32_16x16x32_bf16 v[96:99], a[16:19], v[176:179], v[96:99]
    s_add_u32 s35, s35, s48
    s_add_u32 s36, s35, 4096
    v_mfma_f32_16x16x32_bf16 v[100:103], a[96:99], v[176:179], v[100:103]
    s_waitcnt lgkmcnt(2)
    v_mfma_f32_16x16x32_bf16 v[88:91], a[20:23], v[180:183], v[88:91]
    ds_read_b128 v[172:175], v6 offset:14336
    buffer_store_dword v8, v188, s[4:7], s63 offen
    v_mfma_f32_16x16x32_bf16 v[92:95], a[100:103], v[180:183], v[92:95]
    ds_read_b128 v[176:179], v6 offset:15360
    buffer_store_dwordx2 v[162:163], v189, s[4:7], s64 offen
    v_mfma_f32_16x16x32_bf16 v[96:99], a[20:23], v[184:187], v[96:99]
    buffer_store_dword v13, v9, s[4:7], s44 offen
    s_add_u32 s37, s35, s51
    v_mfma_f32_16x16x32_bf16 v[100:103], a[100:103], v[184:187], v[100:103]
    s_waitcnt lgkmcnt(2)
    v_mfma_f32_16x16x32_bf16 v[88:91], a[24:27], v[164:167], v[88:91]
    ds_read_b128 v[180:183], v6 offset:16384
    s_mul_i32 s38, s27, 36864
    v_mfma_f32_16x16x32_bf16 v[92:95], a[104:107], v[164:167], v[92:95]
    ds_read_b128 v[184:187], v6 offset:17408
    s_add_u32 s38, s38, s49
    v_mfma_f32_16x16x32_bf16 v[96:99], a[24:27], v[168:171], v[96:99]
    s_add_u32 s28, s46, s50
    s_add_u32 s26, s45, 20480
    v_mfma_f32_16x16x32_bf16 v[100:103], a[104:107], v[168:171], v[100:103]
    s_waitcnt lgkmcnt(2)
    v_mfma_f32_16x16x32_bf16 v[88:91], a[28:31], v[172:175], v[88:91]
    ds_read_b128 v[164:167], v6 offset:18432
    v_mfma_f32_16x16x32_bf16 v[92:95], a[108:111], v[172:175], v[92:95]
    ds_read_b128 v[168:171], v6 offset:19456
    v_mfma_f32_16x16x32_bf16 v[96:99], a[28:31], v[176:179], v[96:99]
    v_mfma_f32_16x16x32_bf16 v[100:103], a[108:111], v[176:179], v[100:103]
    s_waitcnt lgkmcnt(2)
    v_mfma_f32_16x16x32_bf16 v[88:91], a[32:35], v[180:183], v[88:91]
    ds_read_b128 v[172:175], v6 offset:20480
    v_mfma_f32_16x16x32_bf16 v[92:95], a[112:115], v[180:183], v[92:95]
    ds_read_b128 v[176:179], v6 offset:21504
    v_mfma_f32_16x16x32_bf16 v[96:99], a[32:35], v[184:187], v[96:99]
    v_mfma_f32_16x16x32_bf16 v[100:103], a[112:115], v[184:187], v[100:103]
    s_waitcnt lgkmcnt(2)
    v_mfma_f32_16x16x32_bf16 v[88:91], a[36:39], v[164:167], v[88:91]
    ds_read_b128 v[180:183], v6 offset:22528
    v_mfma_f32_16x16x32_bf16 v[92:95], a[116:119], v[164:167], v[92:95]
    ds_read_b128 v[184:187], v6 offset:23552
    v_mfma_f32_16x16x32_bf16 v[96:99], a[36:39], v[168:171], v[96:99]
    v_mfma_f32_16x16x32_bf16 v[100:103], a[116:119], v[168:171], v[100:103]
    s_waitcnt lgkmcnt(2)
    v_mfma_f32_16x16x32_bf16 v[88:91], a[40:43], v[172:175], v[88:91]
    ds_read_b128 v[164:167], v6 offset:24576
    v_mfma_f32_16x16x32_bf16 v[92:95], a[120:123], v[172:175], v[92:95]
    ds_read_b128 v[168:171], v6 offset:25600
    v_mfma_f32_16x16x32_bf16 v[96:99], a[40:43], v[176:179], v[96:99]
    v_mfma_f32_16x16x32_bf16 v[100:103], a[120:123], v[176:179], v[100:103]
    s_waitcnt lgkmcnt(2)
    v_mfma_f32_16x16x32_bf16 v[88:91], a[44:47], v[180:183], v[88:91]
    ds_read_b128 v[172:175], v6 offset:26624
    v_mfma_f32_16x16x32_bf16 v[92:95], a[124:127], v[180:183], v[92:95]
    ds_read_b128 v[176:179], v6 offset:27648
    v_mfma_f32_16x16x32_bf16 v[96:99], a[44:47], v[184:187], v[96:99]
    v_mfma_f32_16x16x32_bf16 v[100:103], a[124:127], v[184:187], v[100:103]
    s_waitcnt lgkmcnt(2)
    v_mfma_f32_16x16x32_bf16 v[88:91], a[48:51], v[164:167], v[88:91]
    ds_read_b128 v[180:183], v6 offset:28672
    v_mfma_f32_16x16x32_bf16 v[92:95], a[128:131], v[164:167], v[92:95]
    ds_read_b128 v[184:187], v6 offset:29696
    v_mfma_f32_16x16x32_bf16 v[96:99], a[48:51], v[168:171], v[96:99]
    v_mfma_f32_16x16x32_bf16 v[100:103], a[128:131], v[168:171], v[100:103]
    s_waitcnt lgkmcnt(2)
    v_mfma_f32_16x16x32_bf16 v[88:91], a[52:55], v[172:175], v[88:91]
    ds_read_b128 v[164:167], v6 offset:30720
    s_add_u32 m0, s28, 0
    v_mfma_f32_16x16x32_bf16 v[92:95], a[132:135], v[172:175], v[92:95]
    ds_read_b128 v[168:171], v6 offset:31744
    buffer_load_dwordx4 v5, s[8:11], s45 offen offset:0 lds
    v_mfma_f32_16x16x32_bf16 v[96:99], a[52:55], v[176:179], v[96:99]
    v_mfma_f32_16x16x32_bf16 v[100:103], a[132:135], v[176:179], v[100:103]
    s_waitcnt lgkmcnt(2)
    v_mfma_f32_16x16x32_bf16 v[88:91], a[56:59], v[180:183], v[88:91]
    ds_read_b128 v[172:175], v6 offset:32768
    s_add_u32 m0, s28, 1984
    v_mfma_f32_16x16x32_bf16 v[92:95], a[136:139], v[180:183], v[92:95]
    ds_read_b128 v[176:179], v6 offset:33792
    buffer_load_dwordx4 v5, s[8:11], s45 offen offset:64 lds
    v_mfma_f32_16x16x32_bf16 v[96:99], a[56:59], v[184:187], v[96:99]
    v_mfma_f32_16x16x32_bf16 v[100:103], a[136:139], v[184:187], v[100:103]
    s_waitcnt lgkmcnt(2)
    v_mfma_f32_16x16x32_bf16 v[88:91], a[60:63], v[164:167], v[88:91]
    ds_read_b128 v[180:183], v6 offset:34816
    s_add_u32 m0, s28, 3968
    v_mfma_f32_16x16x32_bf16 v[92:95], a[140:143], v[164:167], v[92:95]
    ds_read_b128 v[184:187], v6 offset:35840
    buffer_load_dwordx4 v5, s[8:11], s45 offen offset:128 lds
    v_mfma_f32_16x16x32_bf16 v[96:99], a[60:63], v[168:171], v[96:99]
    v_mfma_f32_16x16x32_bf16 v[100:103], a[140:143], v[168:171], v[100:103]
    s_waitcnt lgkmcnt(2)
    v_mfma_f32_16x16x32_bf16 v[88:91], a[64:67], v[172:175], v[88:91]
    ds_read_b128 v[164:167], v6 offset:36864
    s_add_u32 m0, s28, 5952
    v_mfma_f32_16x16x32_bf16 v[92:95], a[144:147], v[172:175], v[92:95]
    ds_read_b128 v[168:171], v6 offset:37888
    buffer_load_dwordx4 v5, s[8:11], s45 offen offset:192 lds
    v_mfma_f32_16x16x32_bf16 v[96:99], a[64:67], v[176:179], v[96:99]
    v_mfma_f32_16x16x32_bf16 v[100:103], a[144:147], v[176:179], v[100:103]
    s_waitcnt lgkmcnt(2)
    v_mfma_f32_16x16x32_bf16 v[88:91], a[68:71], v[180:183], v[88:91]
    ds_read_b128 v[172:175], v6 offset:38912
    s_add_u32 m0, s28, 7936
    v_mfma_f32_16x16x32_bf16 v[92:95], a[148:151], v[180:183], v[92:95]
    ds_read_b128 v[176:179], v6 offset:39936
    buffer_load_dwordx4 v5, s[8:11], s45 offen offset:256 lds
    v_mfma_f32_16x16x32_bf16 v[96:99], a[68:71], v[184:187], v[96:99]
    v_mfma_f32_16x16x32_bf16 v[100:103], a[148:151], v[184:187], v[100:103]
    s_waitcnt lgkmcnt(2)
    v_mfma_f32_16x16x32_bf16 v[88:91], a[72:75], v[164:167], v[88:91]
    s_add_u32 m0, s28, 1024
    v_mfma_f32_16x16x32_bf16 v[92:95], a[152:155], v[164:167], v[92:95]
    buffer_load_dwordx4 v5, s[8:11], s26 offen offset:0 lds
    v_mfma_f32_16x16x32_bf16 v[96:99], a[72:75], v[168:171], v[96:99]
    v_mfma_f32_16x16x32_bf16 v[100:103], a[152:155], v[168:171], v[100:103]
    s_waitcnt lgkmcnt(0)
    v_mfma_f32_16x16x32_bf16 v[88:91], a[76:79], v[172:175], v[88:91]
    s_add_u32 m0, s28, 3008
    v_mfma_f32_16x16x32_bf16 v[92:95], a[156:159], v[172:175], v[92:95]
    buffer_load_dwordx4 v5, s[8:11], s26 offen offset:64 lds
    v_mfma_f32_16x16x32_bf16 v[96:99], a[76:79], v[176:179], v[96:99]
    v_mfma_f32_16x16x32_bf16 v[100:103], a[156:159], v[176:179], v[100:103]
    s_add_u32 m0, s28, 4992
    s_nop 0
    buffer_load_dwordx4 v5, s[8:11], s26 offen offset:128 lds
    s_add_u32 m0, s28, 6976
    s_nop 0
    buffer_load_dwordx4 v5, s[8:11], s26 offen offset:192 lds
    s_add_u32 m0, s28, 8960
    s_nop 0
    buffer_load_dwordx4 v5, s[8:11], s26 offen offset:256 lds
    s_add_u32 s45, s45, 40960
    s_sub_u32 s50, 40960, s50
    v_sub_u32 v6, v7, v6
    s_mov_b32 s26, s41
    s_add_u32 s41, s41, 151552
    s_cmp_eq_u32 s41, s42
    s_cselect_b32 s41, s43, s41
    v_cvt_pk_bf16_f32 v120, v88, v92
    v_cvt_pk_bf16_f32 v121, v89, v93
    v_cvt_pk_bf16_f32 v122, v90, v94
    v_cvt_pk_bf16_f32 v123, v91, v95
    buffer_store_dwordx4 v[120:123], v1, s[4:7], s26 offen offset:0
    v_cvt_pk_bf16_f32 v124, v96, v100
    v_cvt_pk_bf16_f32 v125, v97, v101
    v_cvt_pk_bf16_f32 v126, v98, v102
    v_cvt_pk_bf16_f32 v127, v99, v103
    buffer_store_dwordx4 v[124:127], v1, s[4:7], s26 offen offset:1024
    s_waitcnt vmcnt(15)
    s_branch L_xdone_9
L_s1_loc_nox:
    s_cmp_lt_i32 s24, 1
    s_cselect_b32 s39, 536870912, s39
    s_cselect_b32 s40, 536870912, s40
    s_cselect_b32 s52, 536870912, s52
    buffer_store_dword v8, v188, s[4:7], s39 offen
    buffer_store_dwordx2 v[162:163], v189, s[4:7], s40 offen
    buffer_store_dwordx2 v[162:163], v161, s[4:7], s52 offen sc1
    buffer_load_dword v14, v160, s[16:19], 0 offen sc1
    buffer_store_dword v13, v9, s[4:7], s44 offen
    s_and_b32 s27, s24, 3
    s_mul_i32 s34, s27, 163840
    s_add_u32 s34, s34, s47
    s_mul_i32 s39, s27, 10240
    s_add_u32 s39, s39, s48
    s_add_u32 s27, s24, 3
    s_and_b32 s27, s27, 3
    s_mul_i32 s52, s27, 163840
    s_add_u32 s52, s52, s47
    s_mul_i32 s40, s27, 36864
    s_add_u32 s40, s40, s49
    s_add_u32 s27, s24, 1
    s_and_b32 s27, s27, 3
    s_mul_i32 s35, s27, 10240
    s_add_u32 s35, s35, s48
    s_add_u32 s36, s35, 4096
    s_add_u32 s37, s35, s51
    s_mul_i32 s38, s27, 36864
    s_add_u32 s38, s38, s49
    s_waitcnt vmcnt(1)
L_xdone_9:
    s_add_u32 s24, s24, 1
    v_readfirstlane_b32 s26, v14
    s_cmp_eq_u32 s26, 2
    s_cselect_b32 s26, 8192, 0
    s_add_u32 s34, s34, s26
    s_add_u32 s58, s26, 2753408
    s_cmp_gt_i32 s24, 0
    s_cbranch_scc1 L_steady_10
    v_add_u32 v13, 1, v13
    s_waitcnt vmcnt(0)
    buffer_store_dword v13, v9, s[4:7], s44 offen
    s_cmp_lt_i32 s24, 0
    s_cbranch_scc1 L_s1_loc_pro
    s_branch L_s1_loc_h1
L_steady_10:
    s_cmp_eq_u32 s24, 64
    s_cbranch_scc1 L_s1_done
    s_cmp_lg_u32 s22, 0
    s_cbranch_scc1 L_gate_11
    buffer_load_dword v10, v147, s[4:7], s58 offen sc1
    s_sleep 1
    buffer_load_dword v11, v147, s[4:7], s58 offen sc1
    s_sleep 1
    buffer_load_dword v12, v147, s[4:7], s58 offen sc1
    s_sleep 1
    buffer_load_dword v13, v147, s[4:7], s58 offen sc1
L_dp_12:
    s_waitcnt vmcnt(3)
    v_cmp_gt_u32 vcc, s24, v10
    s_cbranch_vccz L_dpok_13
    buffer_load_dword v10, v147, s[4:7], s58 offen sc1
    s_waitcnt vmcnt(3)
    v_cmp_gt_u32 vcc, s24, v11
    s_cbranch_vccz L_dpok_13
    buffer_load_dword v11, v147, s[4:7], s58 offen sc1
    s_waitcnt vmcnt(3)
    v_cmp_gt_u32 vcc, s24, v12
    s_cbranch_vccz L_dpok_13
    buffer_load_dword v12, v147, s[4:7], s58 offen sc1
    s_waitcnt vmcnt(3)
    v_cmp_gt_u32 vcc, s24, v13
    s_cbranch_vccz L_dpok_13
    buffer_load_dword v13, v147, s[4:7], s58 offen sc1
    s_sub_u32 s23, s23, 1
    s_movk_i32 s29, 13
    s_cbranch_scc1 L_fail
    s_branch L_dp_12
L_dpok_13:
L_gate_11:
    s_barrier
    s_sleep 1
    s_cmp_lt_u32 s30, 40
    s_cbranch_scc1 L_red_14
    s_sleep 12
    s_branch L_s1_loc_h1
L_red_14:
L_s1_loc_s3:
    buffer_load_dwordx4 v[60:63], v1, s[4:7], s34 offen offset:0 sc1
    buffer_load_dwordx4 v[64:67], v1, s[4:7], s34 offen offset:1024 sc1
    s_waitcnt vmcnt(1)
    v_mfma_f32_16x16x32_bf16 v[10:13], v[128:131], v[60:63], 0
    s_waitcnt vmcnt(0)
    v_mfma_f32_16x16x32_bf16 v[10:13], v[128:131], v[64:67], v[10:13]
    s_nop 7
    v_cmp_u_f32 vcc, v10, v11
    v_cvt_pk_bf16_f32 v14, v10, v11
    s_cbranch_vccnz L_s1_loc_slow
L_s1_loc_cont:
    buffer_store_dword v14, v2, s[4:7], s35 offen
    s_sleep 3
L_s1_loc_h1:
    s_cmp_eq_u32 s22, 0
    s_cbranch_scc1 L_s1_loc_h1_0
    s_cmp_eq_u32 s22, 1
    s_cbranch_scc1 L_s1_loc_h1_1
    s_cmp_eq_u32 s22, 2
    s_cbranch_scc1 L_s1_loc_h1_2
L_s1_loc_h1_3:
    buffer_load_dwordx4 v[132:135], v144, s[4:7], s35 offen sc1
    buffer_load_dwordx4 v[136:139], v144, s[4:7], s36 offen sc1
    v_mov_b32 v76, 0
    v_mov_b32 v77, 0
    v_mov_b32 v78, 0
    v_mov_b32 v79, 0
    v_mov_b32 v80, 0
    v_mov_b32 v81, 0
    v_mov_b32 v82, 0
    v_mov_b32 v83, 0
    s_sleep 3
    buffer_load_dwordx4 v[148:151], v144, s[4:7], s35 offen sc1
    buffer_load_dwordx4 v[152:155], v144, s[4:7], s36 offen sc1
    s_waitcnt vmcnt(3)
    ds_write_b128 v145, v[132:135] offset:0
    v_max3_u32 v84, v132, v133, v134
    s_waitcnt vmcnt(2)
    ds_write_b128 v145, v[136:139] offset:4096
    v_max3_u32 v84, v135, v136, v84
    v_max3_u32 v84, v137, v138, v84
    v_max_u32 v84, v139, v84
    v_cmp_eq_u32 vcc, -1, v84
    s_waitcnt lgkmcnt(0)
    s_cbranch_vccnz L_s1_loc_h1retry_3
L_s1_loc_h1ok_3:
    s_barrier
    ds_read_b128 v[20:23], v146 offset:0
    ds_read_b128 v[24:27], v146 offset:1024
    ds_read_b128 v[28:31], v146 offset:2048
    ds_read_b128 v[36:39], v146 offset:4096
    ds_read_b128 v[40:43], v146 offset:5120
    ds_read_b128 v[44:47], v146 offset:6144
    ds_read_b128 v[52:55], v146 offset:8192
    ds_read_b128 v[56:59], v146 offset:9216
    v_smfmac_f32_16x16x64_bf16 v[76:79], v[132:135], a[24:31], v4
    v_smfmac_f32_16x16x64_bf16 v[80:83], v[132:135], a[104:111], v4
    v_smfmac_f32_16x16x64_bf16 v[76:79], v[136:139], a[56:63], v4
    v_smfmac_f32_16x16x64_bf16 v[80:83], v[136:139], a[136:143], v4
L_s1_loc_h1rest_3:
    s_waitcnt lgkmcnt(7)
    v_smfmac_f32_16x16x64_bf16 v[76:79], v[20:23], a[0:7], v4
    v_smfmac_f32_16x16x64_bf16 v[80:83], v[20:23], a[80:87], v4
    s_add_u32 s26, s24, 1
    v_mov_b32 v12, s26
    v_add_u32 v13, 1, v12
    s_waitcnt lgkmcnt(6)
    v_smfmac_f32_16x16x64_bf16 v[76:79], v[24:27], a[8:15], v4
    v_smfmac_f32_16x16x64_bf16 v[80:83], v[24:27], a[88:95], v4
    s_waitcnt lgkmcnt(5)
    v_smfmac_f32_16x16x64_bf16 v[76:79], v[28:31], a[16:23], v4
    v_smfmac_f32_16x16x64_bf16 v[80:83], v[28:31], a[96:103], v4
    s_waitcnt lgkmcnt(4)
    v_smfmac_f32_16x16x64_bf16 v[76:79], v[36:39], a[32:39], v4
    v_smfmac_f32_16x16x64_bf16 v[80:83], v[36:39], a[112:119], v4
    s_waitcnt lgkmcnt(3)
    v_smfmac_f32_16x16x64_bf16 v[76:79], v[40:43], a[40:47], v4
    v_smfmac_f32_16x16x64_bf16 v[80:83], v[40:43], a[120:127], v4
    s_waitcnt lgkmcnt(2)
    v_smfmac_f32_16x16x64_bf16 v[76:79], v[44:47], a[48:55], v4
    v_smfmac_f32_16x16x64_bf16 v[80:83], v[44:47], a[128:135], v4
    s_waitcnt lgkmcnt(1)
    v_smfmac_f32_16x16x64_bf16 v[76:79], v[52:55], a[64:71], v4
    v_smfmac_f32_16x16x64_bf16 v[80:83], v[52:55], a[144:151], v4
    s_waitcnt lgkmcnt(0)
    v_smfmac_f32_16x16x64_bf16 v[76:79], v[56:59], a[72:79], v4
    v_smfmac_f32_16x16x64_bf16 v[80:83], v[56:59], a[152:159], v4
    ds_read_b128 v[164:167], v6 offset:0
    ds_read_b128 v[168:171], v6 offset:1024
    ds_read_b128 v[172:175], v6 offset:2048
    ds_read_b128 v[176:179], v6 offset:3072
    s_nop 2
    v_permlane32_swap_b32 v76, v78
    v_permlane32_swap_b32 v77, v79
    v_permlane32_swap_b32 v80, v82
    v_permlane32_swap_b32 v81, v83
    v_add_f32 v76, v76, v78
    v_add_f32 v80, v80, v82
    v_add_f32 v77, v77, v79
    v_add_f32 v81, v81, v83
    v_cvt_pk_bf16_f32 v10, v76, v80
    v_cvt_pk_bf16_f32 v15, v77, v81
    v_cvt_pk_bf16_f32 v11, v77, v81
    v_mov_b32_dpp v11, v10 row_ror:8 row_mask:0xf bank_mask:0x3
    v_mov_b32_dpp v10, v15 row_ror:8 row_mask:0xf bank_mask:0xc
    buffer_store_dword v11, v191, s[4:7], s38 offen
    buffer_store_dword v10, v3, s[4:7], s38 offen
    s_branch L_s1_loc_bub
L_s1_loc_h1retry_3:
    s_sub_u32 s23, s23, 1
    s_movk_i32 s29, 3
    s_cbranch_scc1 L_fail
    buffer_load_dwordx4 v[132:135], v144, s[4:7], s35 offen sc1
    buffer_load_dwordx4 v[136:139], v144, s[4:7], s36 offen sc1
    s_waitcnt vmcnt(3)
    ds_write_b128 v145, v[148:151] offset:0
    v_max3_u32 v84, v148, v149, v150
    s_waitcnt vmcnt(2)
    ds_write_b128 v145, v[152:155] offset:4096
    v_max3_u32 v84, v151, v152, v84
    v_max3_u32 v84, v153, v154, v84
    v_max_u32 v84, v155, v84
    v_cmp_eq_u32 vcc, -1, v84
    s_waitcnt lgkmcnt(0)
    s_cbranch_vccz L_s1_loc_h1okB_3
    buffer_load_dwordx4 v[148:151], v144, s[4:7], s35 offen sc1
    buffer_load_dwordx4 v[152:155], v144, s[4:7], s36 offen sc1
    s_waitcnt vmcnt(3)
    ds_write_b128 v145, v[132:135] offset:0
    v_max3_u32 v84, v132, v133, v134
    s_waitcnt vmcnt(2)
    ds_write_b128 v145, v[136:139] offset:4096
    v_max3_u32 v84, v135, v136, v84
    v_max3_u32 v84, v137, v138, v84
    v_max_u32 v84, v139, v84
    v_cmp_eq_u32 vcc, -1, v84
    s_waitcnt lgkmcnt(0)
    s_cbranch_vccz L_s1_loc_h1ok_3
    s_branch L_s1_loc_h1retry_3
L_s1_loc_h1okB_3:
    s_barrier
    ds_read_b128 v[20:23], v146 offset:0
    ds_read_b128 v[24:27], v146 offset:1024
    ds_read_b128 v[28:31], v146 offset:2048
    ds_read_b128 v[36:39], v146 offset:4096
    ds_read_b128 v[40:43], v146 offset:5120
    ds_read_b128 v[44:47], v146 offset:6144
    ds_read_b128 v[52:55], v146 offset:8192
    ds_read_b128 v[56:59], v146 offset:9216
    v_smfmac_f32_16x16x64_bf16 v[76:79], v[148:151], a[24:31], v4
    v_smfmac_f32_16x16x64_bf16 v[80:83], v[148:151], a[104:111], v4
    v_smfmac_f32_16x16x64_bf16 v[76:79], v[152:155], a[56:63], v4
    v_smfmac_f32_16x16x64_bf16 v[80:83], v[152:155], a[136:143], v4
    s_branch L_s1_loc_h1rest_3
L_s1_loc_h1_0:
    buffer_load_dwordx4 v[132:135], v144, s[4:7], s35 offen sc1
    buffer_load_dwordx4 v[136:139], v144, s[4:7], s36 offen sc1
    buffer_load_dwordx4 v[140:143], v144, s[4:7], s37 offen sc1
    v_mov_b32 v76, 0
    v_mov_b32 v77, 0
    v_mov_b32 v78, 0
    v_mov_b32 v79, 0
    v_mov_b32 v80, 0
    v_mov_b32 v81, 0
    v_mov_b32 v82, 0
    v_mov_b32 v83, 0
    s_sleep 3
    buffer_load_dwordx4 v[148:151], v144, s[4:7], s35 offen sc1
    buffer_load_dwordx4 v[152:155], v144, s[4:7], s36 offen sc1
    buffer_load_dwordx4 v[156:159], v144, s[4:7], s37 offen sc1
    s_waitcnt vmcnt(5)
    ds_write_b128 v145, v[132:135] offset:0
    v_max3_u32 v84, v132, v133, v134
    s_waitcnt vmcnt(4)
    ds_write_b128 v145, v[136:139] offset:4096
    v_max3_u32 v84, v135, v136, v84
    v_max3_u32 v84, v137, v138, v84
    s_waitcnt vmcnt(3)
    ds_write_b128 v145, v[140:143] offset:8192
    v_max3_u32 v84, v139, v140, v84
    v_max3_u32 v84, v141, v142, v84
    v_max_u32 v84, v143, v84
    v_cmp_eq_u32 vcc, -1, v84
    s_waitcnt lgkmcnt(0)
    s_cbranch_vccnz L_s1_loc_h1retry_0
L_s1_loc_h1ok_0:
    s_barrier
    ds_read_b128 v[24:27], v146 offset:1024
    ds_read_b128 v[28:31], v146 offset:2048
    ds_read_b128 v[32:35], v146 offset:3072
    ds_read_b128 v[40:43], v146 offset:5120
    ds_read_b128 v[44:47], v146 offset:6144
    ds_read_b128 v[48:51], v146 offset:7168
    ds_read_b128 v[56:59], v146 offset:9216
    v_smfmac_f32_16x16x64_bf16 v[76:79], v[132:135], a[0:7], v4
    v_smfmac_f32_16x16x64_bf16 v[80:83], v[132:135], a[80:87], v4
    v_smfmac_f32_16x16x64_bf16 v[76:79], v[136:139], a[32:39], v4
    v_smfmac_f32_16x16x64_bf16 v[80:83], v[136:139], a[112:119], v4
    v_smfmac_f32_16x16x64_bf16 v[76:79], v[140:143], a[64:71], v4
    v_smfmac_f32_16x16x64_bf16 v[80:83], v[140:143], a[144:151], v4
L_s1_loc_h1rest_0:
    s_waitcnt lgkmcnt(6)
    v_smfmac_f32_16x16x64_bf16 v[76:79], v[24:27], a[8:15], v4
    v_smfmac_f32_16x16x64_bf16 v[80:83], v[24:27], a[88:95], v4
    s_add_u32 s26, s24, 1
    v_mov_b32 v12, s26
    v_add_u32 v13, 1, v12
    s_waitcnt lgkmcnt(5)
    v_smfmac_f32_16x16x64_bf16 v[76:79], v[28:31], a[16:23], v4
    v_smfmac_f32_16x16x64_bf16 v[80:83], v[28:31], a[96:103], v4
    s_waitcnt lgkmcnt(4)
    v_smfmac_f32_16x16x64_bf16 v[76:79], v[32:35], a[24:31], v4
    v_smfmac_f32_16x16x64_bf16 v[80:83], v[32:35], a[104:111], v4
    s_waitcnt lgkmcnt(3)
    v_smfmac_f32_16x16x64_bf16 v[76:79], v[40:43], a[40:47], v4
    v_smfmac_f32_16x16x64_bf16 v[80:83], v[40:43], a[120:127], v4
    s_waitcnt lgkmcnt(2)
    v_smfmac_f32_16x16x64_bf16 v[76:79], v[44:47], a[48:55], v4
    v_smfmac_f32_16x16x64_bf16 v[80:83], v[44:47], a[128:135], v4
    s_waitcnt lgkmcnt(1)
    v_smfmac_f32_16x16x64_bf16 v[76:79], v[48:51], a[56:63], v4
    v_smfmac_f32_16x16x64_bf16 v[80:83], v[48:51], a[136:143], v4
    s_waitcnt lgkmcnt(0)
    v_smfmac_f32_16x16x64_bf16 v[76:79], v[56:59], a[72:79], v4
    v_smfmac_f32_16x16x64_bf16 v[80:83], v[56:59], a[152:159], v4
    buffer_store_dword v12, v9, s[4:7], s59 offen
    ds_read_b128 v[164:167], v6 offset:0
    ds_read_b128 v[168:171], v6 offset:1024
    ds_read_b128 v[172:175], v6 offset:2048
    ds_read_b128 v[176:179], v6 offset:3072
    s_nop 1
    v_permlane32_swap_b32 v76, v78
    v_permlane32_swap_b32 v77, v79
    v_permlane32_swap_b32 v80, v82
    v_permlane32_swap_b32 v81, v83
    v_add_f32 v76, v76, v78
    v_add_f32 v80, v80, v82
    v_add_f32 v77, v77, v79
    v_add_f32 v81, v81, v83
    v_cvt_pk_bf16_f32 v10, v76, v80
    v_cvt_pk_bf16_f32 v15, v77, v81
    v_cvt_pk_bf16_f32 v11, v77, v81
    v_mov_b32_dpp v11, v10 row_ror:8 row_mask:0xf bank_mask:0x3
    v_mov_b32_dpp v10, v15 row_ror:8 row_mask:0xf bank_mask:0xc
    buffer_store_dword v11, v191, s[4:7], s38 offen
    buffer_store_dword v10, v3, s[4:7], s38 offen
    s_branch L_s1_loc_bub
L_s1_loc_h1retry_0:
    s_sub_u32 s23, s23, 1
    s_movk_i32 s29, 3
    s_cbranch_scc1 L_fail
    buffer_load_dwordx4 v[132:135], v144, s[4:7], s35 offen sc1
    buffer_load_dwordx4 v[136:139], v144, s[4:7], s36 offen sc1
    buffer_load_dwordx4 v[140:143], v144, s[4:7], s37 offen sc1
    s_waitcnt vmcnt(5)
    ds_write_b128 v145, v[148:151] offset:0
    v_max3_u32 v84, v148, v149, v150
    s_waitcnt vmcnt(4)
    ds_write_b128 v145, v[152:155] offset:4096
    v_max3_u32 v84, v151, v152, v84
    v_max3_u32 v84, v153, v154, v84
    s_waitcnt vmcnt(3)
    ds_write_b128 v145, v[156:159] offset:8192
    v_max3_u32 v84, v155, v156, v84
    v_max3_u32 v84, v157, v158, v84
    v_max_u32 v84, v159, v84
    v_cmp_eq_u32 vcc, -1, v84
    s_waitcnt lgkmcnt(0)
    s_cbranch_vccz L_s1_loc_h1okB_0
    buffer_load_dwordx4 v[148:151], v144, s[4:7], s35 offen sc1
    buffer_load_dwordx4 v[152:155], v144, s[4:7], s36 offen sc1
    buffer_load_dwordx4 v[156:159], v144, s[4:7], s37 offen sc1
    s_waitcnt vmcnt(5)
    ds_write_b128 v145, v[132:135] offset:0
    v_max3_u32 v84, v132, v133, v134
    s_waitcnt vmcnt(4)
    ds_write_b128 v145, v[136:139] offset:4096
    v_max3_u32 v84, v135, v136, v84
    v_max3_u32 v84, v137, v138, v84
    s_waitcnt vmcnt(3)
    ds_write_b128 v145, v[140:143] offset:8192
    v_max3_u32 v84, v139, v140, v84
    v_max3_u32 v84, v141, v142, v84
    v_max_u32 v84, v143, v84
    v_cmp_eq_u32 vcc, -1, v84
    s_waitcnt lgkmcnt(0)
    s_cbranch_vccz L_s1_loc_h1ok_0
    s_branch L_s1_loc_h1retry_0
L_s1_loc_h1okB_0:
    s_barrier
    ds_read_b128 v[24:27], v146 offset:1024
    ds_read_b128 v[28:31], v146 offset:2048
    ds_read_b128 v[32:35], v146 offset:3072
    ds_read_b128 v[40:43], v146 offset:5120
    ds_read_b128 v[44:47], v146 offset:6144
    ds_read_b128 v[48:51], v146 offset:7168
    ds_read_b128 v[56:59], v146 offset:9216
    v_smfmac_f32_16x16x64_bf16 v[76:79], v[148:151], a[0:7], v4
    v_smfmac_f32_16x16x64_bf16 v[80:83], v[148:151], a[80:87], v4
    v_smfmac_f32_16x16x64_bf16 v[76:79], v[152:155], a[32:39], v4
    v_smfmac_f32_16x16x64_bf16 v[80:83], v[152:155], a[112:119], v4
    v_smfmac_f32_16x16x64_bf16 v[76:79], v[156:159], a[64:71], v4
    v_smfmac_f32_16x16x64_bf16 v[80:83], v[156:159], a[144:151], v4
    s_branch L_s1_loc_h1rest_0
L_s1_loc_h1_1:
    buffer_load_dwordx4 v[132:135], v144, s[4:7], s35 offen sc1
    buffer_load_dwordx4 v[136:139], v144, s[4:7], s36 offen sc1
    buffer_load_dwordx4 v[140:143], v144, s[4:7], s37 offen sc1
    v_mov_b32 v76, 0
    v_mov_b32 v77, 0
    v_mov_b32 v78, 0
    v_mov_b32 v79, 0
    v_mov_b32 v80, 0
    v_mov_b32 v81, 0
    v_mov_b32 v82, 0
    v_mov_b32 v83, 0
    s_sleep 3
    buffer_load_dwordx4 v[148:151], v144, s[4:7], s35 offen sc1
    buffer_load_dwordx4 v[152:155], v144, s[4:7], s36 offen sc1
    buffer_load_dwordx4 v[156:159], v144, s[4:7], s37 offen sc1
    s_waitcnt vmcnt(5)
    ds_write_b128 v145, v[132:135] offset:0
    v_max3_u32 v84, v132, v133, v134
    s_waitcnt vmcnt(4)
    ds_write_b128 v145, v[136:139] offset:4096
    v_max3_u32 v84, v135, v136, v84
    v_max3_u32 v84, v137, v138, v84
    s_waitcnt vmcnt(3)
    ds_write_b128 v145, v[140:143] offset:8192
    v_max3_u32 v84, v139, v140, v84
    v_max3_u32 v84, v141, v142, v84
    v_max_u32 v84, v143, v84
    v_cmp_eq_u32 vcc, -1, v84
    s_waitcnt lgkmcnt(0)
    s_cbranch_vccnz L_s1_loc_h1retry_1
L_s1_loc_h1ok_1:
    s_barrier
    ds_read_b128 v[20:23], v146 offset:0
    ds_read_b128 v[28:31], v146 offset:2048
    ds_read_b128 v[32:35], v146 offset:3072
    ds_read_b128 v[36:39], v146 offset:4096
    ds_read_b128 v[44:47], v146 offset:6144
    ds_read_b128 v[48:51], v146 offset:7168
    ds_read_b128 v[52:55], v146 offset:8192
    v_smfmac_f32_16x16x64_bf16 v[76:79], v[132:135], a[8:15], v4
    v_smfmac_f32_16x16x64_bf16 v[80:83], v[132:135], a[88:95], v4
    v_smfmac_f32_16x16x64_bf16 v[76:79], v[136:139], a[40:47], v4
    v_smfmac_f32_16x16x64_bf16 v[80:83], v[136:139], a[120:127], v4
    v_smfmac_f32_16x16x64_bf16 v[76:79], v[140:143], a[72:79], v4
    v_smfmac_f32_16x16x64_bf16 v[80:83], v[140:143], a[152:159], v4
L_s1_loc_h1rest_1:
    s_waitcnt lgkmcnt(6)
    v_smfmac_f32_16x16x64_bf16 v[76:79], v[20:23], a[0:7], v4
    v_smfmac_f32_16x16x64_bf16 v[80:83], v[20:23], a[80:87], v4
    s_add_u32 s26, s24, 1
    v_mov_b32 v12, s26
    v_add_u32 v13, 1, v12
    s_waitcnt lgkmcnt(5)
    v_smfmac_f32_16x16x64_bf16 v[76:79], v[28:31], a[16:23], v4
    v_smfmac_f32_16x16x64_bf16 v[80:83], v[28:31], a[96:103], v4
    s_waitcnt lgkmcnt(4)
    v_smfmac_f32_16x16x64_bf16 v[76:79], v[32:35], a[24:31], v4
    v_smfmac_f32_16x16x64_bf16 v[80:83], v[32:35], a[104:111], v4
    s_waitcnt lgkmcnt(3)
    v_smfmac_f32_16x16x64_bf16 v[76:79], v[36:39], a[32:39], v4
    v_smfmac_f32_16x16x64_bf16 v[80:83], v[36:39], a[112:119], v4
    s_waitcnt lgkmcnt(2)
    v_smfmac_f32_16x16x64_bf16 v[76:79], v[44:47], a[48:55], v4
    v_smfmac_f32_16x16x64_bf16 v[80:83], v[44:47], a[128:135], v4
    s_waitcnt lgkmcnt(1)
    v_smfmac_f32_16x16x64_bf16 v[76:79], v[48:51], a[56:63], v4
    v_smfmac_f32_16x16x64_bf16 v[80:83], v[48:51], a[136:143], v4
    s_waitcnt lgkmcnt(0)
    v_smfmac_f32_16x16x64_bf16 v[76:79], v[52:55], a[64:71], v4
    v_smfmac_f32_16x16x64_bf16 v[80:83], v[52:55], a[144:151], v4
    ds_read_b128 v[164:167], v6 offset:0
    ds_read_b128 v[168:171], v6 offset:1024
    ds_read_b128 v[172:175], v6 offset:2048
    ds_read_b128 v[176:179], v6 offset:3072
    s_nop 2
    v_permlane32_swap_b32 v76, v78
    v_permlane32_swap_b32 v77, v79
    v_permlane32_swap_b32 v80, v82
    v_permlane32_swap_b32 v81, v83
    v_add_f32 v76, v76, v78
    v_add_f32 v80, v80, v82
    v_add_f32 v77, v77, v79
    v_add_f32 v81, v81, v83
    v_cvt_pk_bf16_f32 v10, v76, v80
    v_cvt_pk_bf16_f32 v15, v77, v81
    v_cvt_pk_bf16_f32 v11, v77, v81
    v_mov_b32_dpp v11, v10 row_ror:8 row_mask:0xf bank_mask:0x3
    v_mov_b32_dpp v10, v15 row_ror:8 row_mask:0xf bank_mask:0xc
    buffer_store_dword v11, v191, s[4:7], s38 offen
    buffer_store_dword v10, v3, s[4:7], s38 offen
    s_branch L_s1_loc_bub
L_s1_loc_h1retry_1:
    s_sub_u32 s23, s23, 1
    s_movk_i32 s29, 3
    s_cbranch_scc1 L_fail
    buffer_load_dwordx4 v[132:135], v144, s[4:7], s35 offen sc1
    buffer_load_dwordx4 v[136:139], v144, s[4:7], s36 offen sc1
    buffer_load_dwordx4 v[140:143], v144, s[4:7], s37 offen sc1
    s_waitcnt vmcnt(5)
    ds_write_b128 v145, v[148:151] offset:0
    v_max3_u32 v84, v148, v149, v150
    s_waitcnt vmcnt(4)
    ds_write_b128 v145, v[152:155] offset:4096
    v_max3_u32 v84, v151, v152, v84
    v_max3_u32 v84, v153, v154, v84
    s_waitcnt vmcnt(3)
    ds_write_b128 v145, v[156:159] offset:8192
    v_max3_u32 v84, v155, v156, v84
    v_max3_u32 v84, v157, v158, v84
    v_max_u32 v84, v159, v84
    v_cmp_eq_u32 vcc, -1, v84
    s_waitcnt lgkmcnt(0)
    s_cbranch_vccz L_s1_loc_h1okB_1
    buffer_load_dwordx4 v[148:151], v144, s[4:7], s35 offen sc1
    buffer_load_dwordx4 v[152:155], v144, s[4:7], s36 offen sc1
    buffer_load_dwordx4 v[156:159], v144, s[4:7], s37 offen sc1
    s_waitcnt vmcnt(5)
    ds_write_b128 v145, v[132:135] offset:0
    v_max3_u32 v84, v132, v133, v134
    s_waitcnt vmcnt(4)
    ds_write_b128 v145, v[136:139] offset:4096
    v_max3_u32 v84, v135, v136, v84
    v_max3_u32 v84, v137, v138, v84
    s_waitcnt vmcnt(3)
    ds_write_b128 v145, v[140:143] offset:8192
    v_max3_u32 v84, v139, v140, v84
    v_max3_u32 v84, v141, v142, v84
    v_max_u32 v84, v143, v84
    v_cmp_eq_u32 vcc, -1, v84
    s_waitcnt lgkmcnt(0)
    s_cbranch_vccz L_s1_loc_h1ok_1
    s_branch L_s1_loc_h1retry_1
L_s1_loc_h1okB_1:
    s_barrier
    ds_read_b128 v[20:23], v146 offset:0
    ds_read_b128 v[28:31], v146 offset:2048
    ds_read_b128 v[32:35], v146 offset:3072
    ds_read_b128 v[36:39], v146 offset:4096
    ds_read_b128 v[44:47], v146 offset:6144
    ds_read_b128 v[48:51], v146 offset:7168
    ds_read_b128 v[52:55], v146 offset:8192
    v_smfmac_f32_16x16x64_bf16 v[76:79], v[148:151], a[8:15], v4
    v_smfmac_f32_16x16x64_bf16 v[80:83], v[148:151], a[88:95], v4
    v_smfmac_f32_16x16x64_bf16 v[76:79], v[152:155], a[40:47], v4
    v_smfmac_f32_16x16x64_bf16 v[80:83], v[152:155], a[120:127], v4
    v_smfmac_f32_16x16x64_bf16 v[76:79], v[156:159], a[72:79], v4
    v_smfmac_f32_16x16x64_bf16 v[80:83], v[156:159], a[152:159], v4
    s_branch L_s1_loc_h1rest_1
L_s1_loc_h1_2:
    buffer_load_dwordx4 v[132:135], v144, s[4:7], s35 offen sc1
    buffer_load_dwordx4 v[136:139], v144, s[4:7], s36 offen sc1
    v_mov_b32 v76, 0
    v_mov_b32 v77, 0
    v_mov_b32 v78, 0
    v_mov_b32 v79, 0
    v_mov_b32 v80, 0
    v_mov_b32 v81, 0
    v_mov_b32 v82, 0
    v_mov_b32 v83, 0
    s_sleep 3
    buffer_load_dwordx4 v[148:151], v144, s[4:7], s35 offen sc1
    buffer_load_dwordx4 v[152:155], v144, s[4:7], s36 offen sc1
    s_waitcnt vmcnt(3)
    ds_write_b128 v145, v[132:135] offset:0
    v_max3_u32 v84, v132, v133, v134
    s_waitcnt vmcnt(2)
    ds_write_b128 v145, v[136:139] offset:4096
    v_max3_u32 v84, v135, v136, v84
    v_max3_u32 v84, v137, v138, v84
    v_max_u32 v84, v139, v84
    v_cmp_eq_u32 vcc, -1, v84
    s_waitcnt lgkmcnt(0)
    s_cbranch_vccnz L_s1_loc_h1retry_2
L_s1_loc_h1ok_2:
    s_barrier
    ds_read_b128 v[20:23], v146 offset:0
    ds_read_b128 v[24:27], v146 offset:1024
    ds_read_b128 v[32:35], v146 offset:3072
    ds_read_b128 v[36:39], v146 offset:4096
    ds_read_b128 v[40:43], v146 offset:5120
    ds_read_b128 v[48:51], v146 offset:7168
    ds_read_b128 v[52:55], v146 offset:8192
    ds_read_b128 v[56:59], v146 offset:9216
    v_smfmac_f32_16x16x64_bf16 v[76:79], v[132:135], a[16:23], v4
    v_smfmac_f32_16x16x64_bf16 v[80:83], v[132:135], a[96:103], v4
    v_smfmac_f32_16x16x64_bf16 v[76:79], v[136:139], a[48:55], v4
    v_smfmac_f32_16x16x64_bf16 v[80:83], v[136:139], a[128:135], v4
L_s1_loc_h1rest_2:
    s_waitcnt lgkmcnt(7)
    v_smfmac_f32_16x16x64_bf16 v[76:79], v[20:23], a[0:7], v4
    v_smfmac_f32_16x16x64_bf16 v[80:83], v[20:23], a[80:87], v4
    s_add_u32 s26, s24, 1
    v_mov_b32 v12, s26
    v_add_u32 v13, 1, v12
    s_waitcnt lgkmcnt(6)
    v_smfmac_f32_16x16x64_bf16 v[76:79], v[24:27], a[8:15], v4
    v_smfmac_f32_16x16x64_bf16 v[80:83], v[24:27], a[88:95], v4
    s_waitcnt lgkmcnt(5)
    v_smfmac_f32_16x16x64_bf16 v[76:79], v[32:35], a[24:31], v4
    v_smfmac_f32_16x16x64_bf16 v[80:83], v[32:35], a[104:111], v4
    s_waitcnt lgkmcnt(4)
    v_smfmac_f32_16x16x64_bf16 v[76:79], v[36:39], a[32:39], v4
    v_smfmac_f32_16x16x64_bf16 v[80:83], v[36:39], a[112:119], v4
    s_waitcnt lgkmcnt(3)
    v_smfmac_f32_16x16x64_bf16 v[76:79], v[40:43], a[40:47], v4
    v_smfmac_f32_16x16x64_bf16 v[80:83], v[40:43], a[120:127], v4
    s_waitcnt lgkmcnt(2)
    v_smfmac_f32_16x16x64_bf16 v[76:79], v[48:51], a[56:63], v4
    v_smfmac_f32_16x16x64_bf16 v[80:83], v[48:51], a[136:143], v4
    s_waitcnt lgkmcnt(1)
    v_smfmac_f32_16x16x64_bf16 v[76:79], v[52:55], a[64:71], v4
    v_smfmac_f32_16x16x64_bf16 v[80:83], v[52:55], a[144:151], v4
    s_waitcnt lgkmcnt(0)
    v_smfmac_f32_16x16x64_bf16 v[76:79], v[56:59], a[72:79], v4
    v_smfmac_f32_16x16x64_bf16 v[80:83], v[56:59], a[152:159], v4
    ds_read_b128 v[164:167], v6 offset:0
    ds_read_b128 v[168:171], v6 offset:1024
    ds_read_b128 v[172:175], v6 offset:2048
    ds_read_b128 v[176:179], v6 offset:3072
    s_nop 2
    v_permlane32_swap_b32 v76, v78
    v_permlane32_swap_b32 v77, v79
    v_permlane32_swap_b32 v80, v82
    v_permlane32_swap_b32 v81, v83
    v_add_f32 v76, v76, v78
    v_add_f32 v80, v80, v82
    v_add_f32 v77, v77, v79
    v_add_f32 v81, v81, v83
    v_cvt_pk_bf16_f32 v10, v76, v80
    v_cvt_pk_bf16_f32 v15, v77, v81
    v_cvt_pk_bf16_f32 v11, v77, v81
    v_mov_b32_dpp v11, v10 row_ror:8 row_mask:0xf bank_mask:0x3
    v_mov_b32_dpp v10, v15 row_ror:8 row_mask:0xf bank_mask:0xc
    buffer_store_dword v11, v191, s[4:7], s38 offen
    buffer_store_dword v10, v3, s[4:7], s38 offen
    s_branch L_s1_loc_bub
L_s1_loc_h1retry_2:
    s_sub_u32 s23, s23, 1
    s_movk_i32 s29, 3
    s_cbranch_scc1 L_fail
    buffer_load_dwordx4 v[132:135], v144, s[4:7], s35 offen sc1
    buffer_load_dwordx4 v[136:139], v144, s[4:7], s36 offen sc1
    s_waitcnt vmcnt(3)
    ds_write_b128 v145, v[148:151] offset:0
    v_max3_u32 v84, v148, v149, v150
    s_waitcnt vmcnt(2)
    ds_write_b128 v145, v[152:155] offset:4096
    v_max3_u32 v84, v151, v152, v84
    v_max3_u32 v84, v153, v154, v84
    v_max_u32 v84, v155, v84
    v_cmp_eq_u32 vcc, -1, v84
    s_waitcnt lgkmcnt(0)
    s_cbranch_vccz L_s1_loc_h1okB_2
    buffer_load_dwordx4 v[148:151], v144, s[4:7], s35 offen sc1
    buffer_load_dwordx4 v[152:155], v144, s[4:7], s36 offen sc1
    s_waitcnt vmcnt(3)
    ds_write_b128 v145, v[132:135] offset:0
    v_max3_u32 v84, v132, v133, v134
    s_waitcnt vmcnt(2)
    ds_write_b128 v145, v[136:139] offset:4096
    v_max3_u32 v84, v135, v136, v84
    v_max3_u32 v84, v137, v138, v84
    v_max_u32 v84, v139, v84
    v_cmp_eq_u32 vcc, -1, v84
    s_waitcnt lgkmcnt(0)
    s_cbranch_vccz L_s1_loc_h1ok_2
    s_branch L_s1_loc_h1retry_2
L_s1_loc_h1okB_2:
    s_barrier
    ds_read_b128 v[20:23], v146 offset:0
    ds_read_b128 v[24:27], v146 offset:1024
    ds_read_b128 v[32:35], v146 offset:3072
    ds_read_b128 v[36:39], v146 offset:4096
    ds_read_b128 v[40:43], v146 offset:5120
    ds_read_b128 v[48:51], v146 offset:7168
    ds_read_b128 v[52:55], v146 offset:8192
    ds_read_b128 v[56:59], v146 offset:9216
    v_smfmac_f32_16x16x64_bf16 v[76:79], v[148:151], a[16:23], v4
    v_smfmac_f32_16x16x64_bf16 v[80:83], v[148:151], a[96:103], v4
    v_smfmac_f32_16x16x64_bf16 v[76:79], v[152:155], a[48:55], v4
    v_smfmac_f32_16x16x64_bf16 v[80:83], v[152:155], a[128:135], v4
    s_branch L_s1_loc_h1rest_2
L_s1_loc_slow:
    v_max3_u32 v84, v60, v61, v62
    v_max3_u32 v84, v63, v64, v84
    v_max3_u32 v84, v65, v66, v84
    v_max_u32 v84, v67, v84
    v_cmp_eq_u32 vcc, -1, v84
    v_min_u32 v14, -2, v14
    s_cbranch_vccz L_s1_loc_cont
    s_sub_u32 s23, s23, 1
    s_movk_i32 s29, 2
    s_cbranch_scc1 L_fail
    s_branch L_s1_loc_s3
L_s1_glb:
    s_waitcnt lgkmcnt(0)
L_s1_glb_pro:
    s_barrier
    s_add_u32 s26, s24, 1
    v_mov_b32 v12, s26
    v_add_u32 v13, 1, v12
    ds_read_b128 v[164:167], v6 offset:0
    ds_read_b128 v[168:171], v6 offset:1024
    ds_read_b128 v[172:175], v6 offset:2048
    ds_read_b128 v[176:179], v6 offset:3072
L_s1_glb_bub:
    s_cmp_ge_i32 s24, 62
    s_cbranch_scc1 L_s1_glb_nox
    s_cmp_lt_i32 s24, 1
    s_cselect_b32 s39, 536870912, s39
    s_cselect_b32 s40, 536870912, s40
    s_cselect_b32 s52, 536870912, s52
    s_waitcnt lgkmcnt(2)
    v_mfma_f32_16x16x32_bf16 v[88:91], a[0:3], v[164:167], 0
    ds_read_b128 v[180:183], v6 offset:4096
    s_mov_b32 s63, s39
    v_mfma_f32_16x16x32_bf16 v[92:95], a[80:83], v[164:167], 0
    ds_read_b128 v[184:187], v6 offset:5120
    s_mov_b32 s64, s40
    v_mfma_f32_16x16x32_bf16 v[96:99], a[0:3], v[168:171], 0
    buffer_store_dwordx2 v[162:163], v161, s[4:7], s52 offen sc1
    buffer_load_dword v14, v160, s[16:19], 0 offen sc1
    v_mfma_f32_16x16x32_bf16 v[100:103], a[80:83], v[168:171], 0
    s_waitcnt lgkmcnt(2)
    v_mfma_f32_16x16x32_bf16 v[88:91], a[4:7], v[172:175], v[88:91]
    ds_read_b128 v[164:167], v6 offset:6144
    s_and_b32 s27, s24, 3
    v_mfma_f32_16x16x32_bf16 v[92:95], a[84:87], v[172:175], v[92:95]
    ds_read_b128 v[168:171], v6 offset:7168
    s_mul_i32 s34, s27, 163840
    v_mfma_f32_16x16x32_bf16 v[96:99], a[4:7], v[176:179], v[96:99]
    s_add_u32 s34, s34, s47
    s_mul_i32 s39, s27, 10240
    v_mfma_f32_16x16x32_bf16 v[100:103], a[84:87], v[176:179], v[100:103]
    s_waitcnt lgkmcnt(2)
    v_mfma_f32_16x16x32_bf16 v[88:91], a[8:11], v[180:183], v[88:91]
    ds_read_b128 v[172:175], v6 offset:8192
    s_add_u32 s39, s39, s48
    v_mfma_f32_16x16x32_bf16 v[92:95], a[88:91], v[180:183], v[92:95]
    ds_read_b128 v[176:179], v6 offset:9216
    s_add_u32 s27, s24, 3
    v_mfma_f32_16x16x32_bf16 v[96:99], a[8:11], v[184:187], v[96:99]
    s_and_b32 s27, s27, 3
    s_mul_i32 s52, s27, 163840
    v_mfma_f32_16x16x32_bf16 v[100:103], a[88:91], v[184:187], v[100:103]
    s_waitcnt lgkmcnt(2)
    v_mfma_f32_16x16x32_bf16 v[88:91], a[12:15], v[164:167], v[88:91]
    ds_read_b128 v[180:183], v6 offset:10240
    s_add_u32 s52, s52, s47
    v_mfma_f32_16x16x32_bf16 v[92:95], a[92:95], v[164:167], v[92:95]
    ds_read_b128 v[184:187], v6 offset:11264
    s_mul_i32 s40, s27, 36864
    v_mfma_f32_16x16x32_bf16 v[96:99], a[12:15], v[168:171], v[96:99]
    s_add_u32 s40, s40, s49
    s_add_u32 s27, s24, 1
    v_mfma_f32_16x16x32_bf16 v[100:103], a[92:95], v[168:171], v[100:103]
    s_waitcnt lgkmcnt(2)
    v_mfma_f32_16x16x32_bf16 v[88:91], a[16:19], v[172:175], v[88:91]
    ds_read_b128 v[164:167], v6 offset:12288
    s_and_b32 s27, s27, 3
    v_mfma_f32_16x16x32_bf16 v[92:95], a[96:99], v[172:175], v[92:95]
    ds_read_b128 v[168:171], v6 offset:13312
    s_mul_i32 s35, s27, 10240
    v_mfma_f32_16x16x32_bf16 v[96:99], a[16:19], v[176:179], v[96:99]
    s_add_u32 s35, s35, s48
    s_add_u32 s36, s35, 4096
    v_mfma_f32_16x16x32_bf16 v[100:103], a[96:99], v[176:179], v[100:103]
    s_waitcnt lgkmcnt(2)
    v_mfma_f32_16x16x32_bf16 v[88:91], a[20:23], v[180:183], v[88:91]
    ds_read_b128 v[172:175], v6 offset:14336
    buffer_store_dword v8, v188, s[4:7], s63 offen sc1
    v_mfma_f32_16x16x32_bf16 v[92:95], a[100:103], v[180:183], v[92:95]
    ds_read_b128 v[176:179], v6 offset:15360
    buffer_store_dwordx2 v[162:163], v189, s[4:7], s64 offen sc1
    v_mfma_f32_16x16x32_bf16 v[96:99], a[20:23], v[184:187], v[96:99]
    buffer_store_dword v13, v9, s[4:7], s44 offen sc1
    s_add_u32 s37, s35, s51
    v_mfma_f32_16x16x32_bf16 v[100:103], a[100:103], v[184:187], v[100:103]
    s_waitcnt lgkmcnt(2)
    v_mfma_f32_16x16x32_bf16 v[88:91], a[24:27], v[164:167], v[88:91]
    ds_read_b128 v[180:183], v6 offset:16384
    s_mul_i32 s38, s27, 36864
    v_mfma_f32_16x16x32_bf16 v[92:95], a[104:107], v[164:167], v[92:95]
    ds_read_b128 v[184:187], v6 offset:17408
    s_add_u32 s38, s38, s49
    v_mfma_f32_16x16x32_bf16 v[96:99], a[24:27], v[168:171], v[96:99]
    s_add_u32 s28, s46, s50
    s_add_u32 s26, s45, 20480
    v_mfma_f32_16x16x32_bf16 v[100:103], a[104:107], v[168:171], v[100:103]
    s_waitcnt lgkmcnt(2)
    v_mfma_f32_16x16x32_bf16 v[88:91], a[28:31], v[172:175], v[88:91]
    ds_read_b128 v[164:167], v6 offset:18432
    v_mfma_f32_16x16x32_bf16 v[92:95], a[108:111], v[172:175], v[92:95]
    ds_read_b128 v[168:171], v6 offset:19456
    v_mfma_f32_16x16x32_bf16 v[96:99], a[28:31], v[176:179], v[96:99]
    v_mfma_f32_16x16x32_bf16 v[100:103], a[108:111], v[176:179], v[100:103]
    s_waitcnt lgkmcnt(2)
    v_mfma_f32_16x16x32_bf16 v[88:91], a[32:35], v[180:183], v[88:91]
    ds_read_b128 v[172:175], v6 offset:20480
    v_mfma_f32_16x16x32_bf16 v[92:95], a[112:115], v[180:183], v[92:95]
    ds_read_b128 v[176:179], v6 offset:21504
    v_mfma_f32_16x16x32_bf16 v[96:99], a[32:35], v[184:187], v[96:99]
    v_mfma_f32_16x16x32_bf16 v[100:103], a[112:115], v[184:187], v[100:103]
    s_waitcnt lgkmcnt(2)
    v_mfma_f32_16x16x32_bf16 v[88:91], a[36:39], v[164:167], v[88:91]
    ds_read_b128 v[180:183], v6 offset:22528
    v_mfma_f32_16x16x32_bf16 v[92:95], a[116:119], v[164:167], v[92:95]
    ds_read_b128 v[184:187], v6 offset:23552
    v_mfma_f32_16x16x32_bf16 v[96:99], a[36:39], v[168:171], v[96:99]
    v_mfma_f32_16x16x32_bf16 v[100:103], a[116:119], v[168:171], v[100:103]
    s_waitcnt lgkmcnt(2)
    v_mfma_f32_16x16x32_bf16 v[88:91], a[40:43], v[172:175], v[88:91]
    ds_read_b128 v[164:167], v6 offset:24576
    v_mfma_f32_16x16x32_bf16 v[92:95], a[120:123], v[172:175], v[92:95]
    ds_read_b128 v[168:171], v6 offset:25600
    v_mfma_f32_16x16x32_bf16 v[96:99], a[40:43], v[176:179], v[96:99]
    v_mfma_f32_16x16x32_bf16 v[100:103], a[120:123], v[176:179], v[100:103]
    s_waitcnt lgkmcnt(2)
    v_mfma_f32_16x16x32_bf16 v[88:91], a[44:47], v[180:183], v[88:91]
    ds_read_b128 v[172:175], v6 offset:26624
    v_mfma_f32_16x16x32_bf16 v[92:95], a[124:127], v[180:183], v[92:95]
    ds_read_b128 v[176:179], v6 offset:27648
    v_mfma_f32_16x16x32_bf16 v[96:99], a[44:47], v[184:187], v[96:99]
    v_mfma_f32_16x16x32_bf16 v[100:103], a[124:127], v[184:187], v[100:103]
    s_waitcnt lgkmcnt(2)
    v_mfma_f32_16x16x32_bf16 v[88:91], a[48:51], v[164:167], v[88:91]
    ds_read_b128 v[180:183], v6 offset:28672
    v_mfma_f32_16x16x32_bf16 v[92:95], a[128:131], v[164:167], v[92:95]
    ds_read_b128 v[184:187], v6 offset:29696
    v_mfma_f32_16x16x32_bf16 v[96:99], a[48:51], v[168:171], v[96:99]
    v_mfma_f32_16x16x32_bf16 v[100:103], a[128:131], v[168:171], v[100:103]
    s_waitcnt lgkmcnt(2)
    v_mfma_f32_16x16x32_bf16 v[88:91], a[52:55], v[172:175], v[88:91]
    ds_read_b128 v[164:167], v6 offset:30720
    s_add_u32 m0, s28, 0
    v_mfma_f32_16x16x32_bf16 v[92:95], a[132:135], v[172:175], v[92:95]
    ds_read_b128 v[168:171], v6 offset:31744
    buffer_load_dwordx4 v5, s[8:11], s45 offen offset:0 lds
    v_mfma_f32_16x16x32_bf16 v[96:99], a[52:55], v[176:179], v[96:99]
    v_mfma_f32_16x16x32_bf16 v[100:103], a[132:135], v[176:179], v[100:103]
    s_waitcnt lgkmcnt(2)
    v_mfma_f32_16x16x32_bf16 v[88:91], a[56:59], v[180:183], v[88:91]
    ds_read_b128 v[172:175], v6 offset:32768
    s_add_u32 m0, s28, 1984
    v_mfma_f32_16x16x32_bf16 v[92:95], a[136:139], v[180:183], v[92:95]
    ds_read_b128 v[176:179], v6 offset:33792
    buffer_load_dwordx4 v5, s[8:11], s45 offen offset:64 lds
    v_mfma_f32_16x16x32_bf16 v[96:99], a[56:59], v[184:187], v[96:99]
    v_mfma_f32_16x16x32_bf16 v[100:103], a[136:139], v[184:187], v[100:103]
    s_waitcnt lgkmcnt(2)
    v_mfma_f32_16x16x32_bf16 v[88:91], a[60:63], v[164:167], v[88:91]
    ds_read_b128 v[180:183], v6 offset:34816
    s_add_u32 m0, s28, 3968
    v_mfma_f32_16x16x32_bf16 v[92:95], a[140:143], v[164:167], v[92:95]
    ds_read_b128 v[184:187], v6 offset:35840
    buffer_load_dwordx4 v5, s[8:11], s45 offen offset:128 lds
    v_mfma_f32_16x16x32_bf16 v[96:99], a[60:63], v[168:171], v[96:99]
    v_mfma_f32_16x16x32_bf16 v[100:103], a[140:143], v[168:171], v[100:103]
    s_waitcnt lgkmcnt(2)
    v_mfma_f32_16x16x32_bf16 v[88:91], a[64:67], v[172:175], v[88:91]
    ds_read_b128 v[164:167], v6 offset:36864
    s_add_u32 m0, s28, 5952
    v_mfma_f32_16x16x32_bf16 v[92:95], a[144:147], v[172:175], v[92:95]
    ds_read_b128 v[168:171], v6 offset:37888
    buffer_load_dwordx4 v5, s[8:11], s45 offen offset:192 lds
    v_mfma_f32_16x16x32_bf16 v[96:99], a[64:67], v[176:179], v[96:99]
    v_mfma_f32_16x16x32_bf16 v[100:103], a[144:147], v[176:179], v[100:103]
    s_waitcnt lgkmcnt(2)
    v_mfma_f32_16x16x32_bf16 v[88:91], a[68:71], v[180:183], v[88:91]
    ds_read_b128 v[172:175], v6 offset:38912
    s_add_u32 m0, s28, 7936
    v_mfma_f32_16x16x32_bf16 v[92:95], a[148:151], v[180:183], v[92:95]
    ds_read_b128 v[176:179], v6 offset:39936
    buffer_load_dwordx4 v5, s[8:11], s45 offen offset:256 lds
    v_mfma_f32_16x16x32_bf16 v[96:99], a[68:71], v[184:187], v[96:99]
    v_mfma_f32_16x16x32_bf16 v[100:103], a[148:151], v[184:187], v[100:103]
    s_waitcnt lgkmcnt(2)
    v_mfma_f32_16x16x32_bf16 v[88:91], a[72:75], v[164:167], v[88:91]
    s_add_u32 m0, s28, 1024
    v_mfma_f32_16x16x32_bf16 v[92:95], a[152:155], v[164:167], v[92:95]
    buffer_load_dwordx4 v5, s[8:11], s26 offen offset:0 lds
    v_mfma_f32_16x16x32_bf16 v[96:99], a[72:75], v[168:171], v[96:99]
    v_mfma_f32_16x16x32_bf16 v[100:103], a[152:155], v[168:171], v[100:103]
    s_waitcnt lgkmcnt(0)
    v_mfma_f32_16x16x32_bf16 v[88:91], a[76:79], v[172:175], v[88:91]
    s_add_u32 m0, s28, 3008
    v_mfma_f32_16x16x32_bf16 v[92:95], a[156:159], v[172:175], v[92:95]
    buffer_load_dwordx4 v5, s[8:11], s26 offen offset:64 lds
    v_mfma_f32_16x16x32_bf16 v[96:99], a[76:79], v[176:179], v[96:99]
    v_mfma_f32_16x16x32_bf16 v[100:103], a[156:159], v[176:179], v[100:103]
    s_add_u32 m0, s28, 4992
    s_nop 0
    buffer_load_dwordx4 v5, s[8:11], s26 offen offset:128 lds
    s_add_u32 m0, s28, 6976
    s_nop 0
    buffer_load_dwordx4 v5, s[8:11], s26 offen offset:192 lds
    s_add_u32 m0, s28, 8960
    s_nop 0
    buffer_load_dwordx4 v5, s[8:11], s26 offen offset:256 lds
    s_add_u32 s45, s45, 40960
    s_sub_u32 s50, 40960, s50
    v_sub_u32 v6, v7, v6
    s_mov_b32 s26, s41
    s_add_u32 s41, s41, 151552
    s_cmp_eq_u32 s41, s42
    s_cselect_b32 s41, s43, s41
    v_cvt_pk_bf16_f32 v120, v88, v92
    v_cvt_pk_bf16_f32 v121, v89, v93
    v_cvt_pk_bf16_f32 v122, v90, v94
    v_cvt_pk_bf16_f32 v123, v91, v95
    buffer_store_dwordx4 v[120:123], v1, s[4:7], s26 offen offset:0 sc1
    v_cvt_pk_bf16_f32 v124, v96, v100
    v_cvt_pk_bf16_f32 v125, v97, v101
    v_cvt_pk_bf16_f32 v126, v98, v102
    v_cvt_pk_bf16_f32 v127, v99, v103
    buffer_store_dwordx4 v[124:127], v1, s[4:7], s26 offen offset:1024 sc1
    s_waitcnt vmcnt(15)
    s_branch L_xdone_15
L_s1_glb_nox:
    s_cmp_lt_i32 s24, 1
    s_cselect_b32 s39, 536870912, s39
    s_cselect_b32 s40, 536870912, s40
    s_cselect_b32 s52, 536870912, s52
    buffer_store_dword v8, v188, s[4:7], s39 offen sc1
    buffer_store_dwordx2 v[162:163], v189, s[4:7], s40 offen sc1
    buffer_store_dwordx2 v[162:163], v161, s[4:7], s52 offen sc1
    buffer_load_dword v14, v160, s[16:19], 0 offen sc1
    buffer_store_dword v13, v9, s[4:7], s44 offen sc1
    s_and_b32 s27, s24, 3
    s_mul_i32 s34, s27, 163840
    s_add_u32 s34, s34, s47
    s_mul_i32 s39, s27, 10240
    s_add_u32 s39, s39, s48
    s_add_u32 s27, s24, 3
    s_and_b32 s27, s27, 3
    s_mul_i32 s52, s27, 163840
    s_add_u32 s52, s52, s47
    s_mul_i32 s40, s27, 36864
    s_add_u32 s40, s40, s49
    s_add_u32 s27, s24, 1
    s_and_b32 s27, s27, 3
    s_mul_i32 s35, s27, 10240
    s_add_u32 s35, s35, s48
    s_add_u32 s36, s35, 4096
    s_add_u32 s37, s35, s51
    s_mul_i32 s38, s27, 36864
    s_add_u32 s38, s38, s49
    s_waitcnt vmcnt(1)
L_xdone_15:
    s_add_u32 s24, s24, 1
    v_readfirstlane_b32 s26, v14
    s_cmp_eq_u32 s26, 99
    s_cselect_b32 s26, 8192, 0
    s_add_u32 s34, s34, s26
    s_add_u32 s58, s26, 2753408
    s_cmp_gt_i32 s24, 0
    s_cbranch_scc1 L_steady_16
    v_add_u32 v13, 1, v13
    s_waitcnt vmcnt(0)
    buffer_store_dword v13, v9, s[4:7], s44 offen sc1
    s_cmp_lt_i32 s24, 0
    s_cbranch_scc1 L_s1_glb_pro
    s_branch L_s1_glb_h1
L_steady_16:
    s_cmp_eq_u32 s24, 64
    s_cbranch_scc1 L_s1_done
    s_barrier
L_s1_glb_s3:
    buffer_load_dwordx4 v[60:63], v1, s[4:7], s34 offen offset:0 sc1
    buffer_load_dwordx4 v[64:67], v1, s[4:7], s34 offen offset:1024 sc1
    s_waitcnt vmcnt(1)
    v_mfma_f32_16x16x32_bf16 v[10:13], v[128:131], v[60:63], 0
    s_waitcnt vmcnt(0)
    v_mfma_f32_16x16x32_bf16 v[10:13], v[128:131], v[64:67], v[10:13]
    s_nop 7
    v_cmp_u_f32 vcc, v10, v11
    v_cvt_pk_bf16_f32 v14, v10, v11
    s_cbranch_vccnz L_s1_glb_slow
L_s1_glb_cont:
    buffer_store_dword v14, v2, s[4:7], s35 offen sc1
    s_sleep 3
L_s1_glb_h1:
    s_cmp_eq_u32 s22, 0
    s_cbranch_scc1 L_s1_glb_h1_0
    s_cmp_eq_u32 s22, 1
    s_cbranch_scc1 L_s1_glb_h1_1
    s_cmp_eq_u32 s22, 2
    s_cbranch_scc1 L_s1_glb_h1_2
L_s1_glb_h1_3:
    buffer_load_dwordx4 v[132:135], v144, s[4:7], s35 offen sc1
    buffer_load_dwordx4 v[136:139], v144, s[4:7], s36 offen sc1
    v_mov_b32 v76, 0
    v_mov_b32 v77, 0
    v_mov_b32 v78, 0
    v_mov_b32 v79, 0
    v_mov_b32 v80, 0
    v_mov_b32 v81, 0
    v_mov_b32 v82, 0
    v_mov_b32 v83, 0
    s_sleep 3
    buffer_load_dwordx4 v[148:151], v144, s[4:7], s35 offen sc1
    buffer_load_dwordx4 v[152:155], v144, s[4:7], s36 offen sc1
    s_waitcnt vmcnt(3)
    ds_write_b128 v145, v[132:135] offset:0
    v_max3_u32 v84, v132, v133, v134
    s_waitcnt vmcnt(2)
    ds_write_b128 v145, v[136:139] offset:4096
    v_max3_u32 v84, v135, v136, v84
    v_max3_u32 v84, v137, v138, v84
    v_max_u32 v84, v139, v84
    v_cmp_eq_u32 vcc, -1, v84
    s_waitcnt lgkmcnt(0)
    s_cbranch_vccnz L_s1_glb_h1retry_3
L_s1_glb_h1ok_3:
    s_barrier
    ds_read_b128 v[20:23], v146 offset:0
    ds_read_b128 v[24:27], v146 offset:1024
    ds_read_b128 v[28:31], v146 offset:2048
    ds_read_b128 v[36:39], v146 offset:4096
    ds_read_b128 v[40:43], v146 offset:5120
    ds_read_b128 v[44:47], v146 offset:6144
    ds_read_b128 v[52:55], v146 offset:8192
    ds_read_b128 v[56:59], v146 offset:9216
    v_smfmac_f32_16x16x64_bf16 v[76:79], v[132:135], a[24:31], v4
    v_smfmac_f32_16x16x64_bf16 v[80:83], v[132:135], a[104:111], v4
    v_smfmac_f32_16x16x64_bf16 v[76:79], v[136:139], a[56:63], v4
    v_smfmac_f32_16x16x64_bf16 v[80:83], v[136:139], a[136:143], v4
L_s1_glb_h1rest_3:
    s_waitcnt lgkmcnt(7)
    v_smfmac_f32_16x16x64_bf16 v[76:79], v[20:23], a[0:7], v4
    v_smfmac_f32_16x16x64_bf16 v[80:83], v[20:23], a[80:87], v4
    s_add_u32 s26, s24, 1
    v_mov_b32 v12, s26
    v_add_u32 v13, 1, v12
    s_waitcnt lgkmcnt(6)
    v_smfmac_f32_16x16x64_bf16 v[76:79], v[24:27], a[8:15], v4
    v_smfmac_f32_16x16x64_bf16 v[80:83], v[24:27], a[88:95], v4
    s_waitcnt lgkmcnt(5)
    v_smfmac_f32_16x16x64_bf16 v[76:79], v[28:31], a[16:23], v4
    v_smfmac_f32_16x16x64_bf16 v[80:83], v[28:31], a[96:103], v4
    s_waitcnt lgkmcnt(4)
    v_smfmac_f32_16x16x64_bf16 v[76:79], v[36:39], a[32:39], v4
    v_smfmac_f32_16x16x64_bf16 v[80:83], v[36:39], a[112:119], v4
    s_waitcnt lgkmcnt(3)
    v_smfmac_f32_16x16x64_bf16 v[76:79], v[40:43], a[40:47], v4
    v_smfmac_f32_16x16x64_bf16 v[80:83], v[40:43], a[120:127], v4
    s_waitcnt lgkmcnt(2)
    v_smfmac_f32_16x16x64_bf16 v[76:79], v[44:47], a[48:55], v4
    v_smfmac_f32_16x16x64_bf16 v[80:83], v[44:47], a[128:135], v4
    s_waitcnt lgkmcnt(1)
    v_smfmac_f32_16x16x64_bf16 v[76:79], v[52:55], a[64:71], v4
    v_smfmac_f32_16x16x64_bf16 v[80:83], v[52:55], a[144:151], v4
    s_waitcnt lgkmcnt(0)
    v_smfmac_f32_16x16x64_bf16 v[76:79], v[56:59], a[72:79], v4
    v_smfmac_f32_16x16x64_bf16 v[80:83], v[56:59], a[152:159], v4
    ds_read_b128 v[164:167], v6 offset:0
    ds_read_b128 v[168:171], v6 offset:1024
    ds_read_b128 v[172:175], v6 offset:2048
    ds_read_b128 v[176:179], v6 offset:3072
    s_nop 2
    v_permlane32_swap_b32 v76, v78
    v_permlane32_swap_b32 v77, v79
    v_permlane32_swap_b32 v80, v82
    v_permlane32_swap_b32 v81, v83
    v_add_f32 v76, v76, v78
    v_add_f32 v80, v80, v82
    v_add_f32 v77, v77, v79
    v_add_f32 v81, v81, v83
    v_cvt_pk_bf16_f32 v10, v76, v80
    v_cvt_pk_bf16_f32 v15, v77, v81
    v_cvt_pk_bf16_f32 v11, v77, v81
    v_mov_b32_dpp v11, v10 row_ror:8 row_mask:0xf bank_mask:0x3
    v_mov_b32_dpp v10, v15 row_ror:8 row_mask:0xf bank_mask:0xc
    buffer_store_dword v11, v191, s[4:7], s38 offen sc1
    buffer_store_dword v10, v3, s[4:7], s38 offen sc1
    s_branch L_s1_glb_bub
L_s1_glb_h1retry_3:
    s_sub_u32 s23, s23, 1
    s_movk_i32 s29, 3
    s_cbranch_scc1 L_fail
    buffer_load_dwordx4 v[132:135], v144, s[4:7], s35 offen sc1
    buffer_load_dwordx4 v[136:139], v144, s[4:7], s36 offen sc1
    s_waitcnt vmcnt(3)
    ds_write_b128 v145, v[148:151] offset:0
    v_max3_u32 v84, v148, v149, v150
    s_waitcnt vmcnt(2)
    ds_write_b128 v145, v[152:155] offset:4096
    v_max3_u32 v84, v151, v152, v84
    v_max3_u32 v84, v153, v154, v84
    v_max_u32 v84, v155, v84
    v_cmp_eq_u32 vcc, -1, v84
    s_waitcnt lgkmcnt(0)
    s_cbranch_vccz L_s1_glb_h1okB_3
    buffer_load_dwordx4 v[148:151], v144, s[4:7], s35 offen sc1
    buffer_load_dwordx4 v[152:155], v144, s[4:7], s36 offen sc1
    s_waitcnt vmcnt(3)
    ds_write_b128 v145, v[132:135] offset:0
    v_max3_u32 v84, v132, v133, v134
    s_waitcnt vmcnt(2)
    ds_write_b128 v145, v[136:139] offset:4096
    v_max3_u32 v84, v135, v136, v84
    v_max3_u32 v84, v137, v138, v84
    v_max_u32 v84, v139, v84
    v_cmp_eq_u32 vcc, -1, v84
    s_waitcnt lgkmcnt(0)
    s_cbranch_vccz L_s1_glb_h1ok_3
    s_branch L_s1_glb_h1retry_3
L_s1_glb_h1okB_3:
    s_barrier
    ds_read_b128 v[20:23], v146 offset:0
    ds_read_b128 v[24:27], v146 offset:1024
    ds_read_b128 v[28:31], v146 offset:2048
    ds_read_b128 v[36:39], v146 offset:4096
    ds_read_b128 v[40:43], v146 offset:5120
    ds_read_b128 v[44:47], v146 offset:6144
    ds_read_b128 v[52:55], v146 offset:8192
    ds_read_b128 v[56:59], v146 offset:9216
    v_smfmac_f32_16x16x64_bf16 v[76:79], v[148:151], a[24:31], v4
    v_smfmac_f32_16x16x64_bf16 v[80:83], v[148:151], a[104:111], v4
    v_smfmac_f32_16x16x64_bf16 v[76:79], v[152:155], a[56:63], v4
    v_smfmac_f32_16x16x64_bf16 v[80:83], v[152:155], a[136:143], v4
    s_branch L_s1_glb_h1rest_3
L_s1_glb_h1_0:
    buffer_load_dwordx4 v[132:135], v144, s[4:7], s35 offen sc1
    buffer_load_dwordx4 v[136:139], v144, s[4:7], s36 offen sc1
    buffer_load_dwordx4 v[140:143], v144, s[4:7], s37 offen sc1
    v_mov_b32 v76, 0
    v_mov_b32 v77, 0
    v_mov_b32 v78, 0
    v_mov_b32 v79, 0
    v_mov_b32 v80, 0
    v_mov_b32 v81, 0
    v_mov_b32 v82, 0
    v_mov_b32 v83, 0
    s_sleep 3
    buffer_load_dwordx4 v[148:151], v144, s[4:7], s35 offen sc1
    buffer_load_dwordx4 v[152:155], v144, s[4:7], s36 offen sc1
    buffer_load_dwordx4 v[156:159], v144, s[4:7], s37 offen sc1
    s_waitcnt vmcnt(5)
    ds_write_b128 v145, v[132:135] offset:0
    v_max3_u32 v84, v132, v133, v134
    s_waitcnt vmcnt(4)
    ds_write_b128 v145, v[136:139] offset:4096
    v_max3_u32 v84, v135, v136, v84
    v_max3_u32 v84, v137, v138, v84
    s_waitcnt vmcnt(3)
    ds_write_b128 v145, v[140:143] offset:8192
    v_max3_u32 v84, v139, v140, v84
    v_max3_u32 v84, v141, v142, v84
    v_max_u32 v84, v143, v84
    v_cmp_eq_u32 vcc, -1, v84
    s_waitcnt lgkmcnt(0)
    s_cbranch_vccnz L_s1_glb_h1retry_0
L_s1_glb_h1ok_0:
    s_barrier
    ds_read_b128 v[24:27], v146 offset:1024
    ds_read_b128 v[28:31], v146 offset:2048
    ds_read_b128 v[32:35], v146 offset:3072
    ds_read_b128 v[40:43], v146 offset:5120
    ds_read_b128 v[44:47], v146 offset:6144
    ds_read_b128 v[48:51], v146 offset:7168
    ds_read_b128 v[56:59], v146 offset:9216
    v_smfmac_f32_16x16x64_bf16 v[76:79], v[132:135], a[0:7], v4
    v_smfmac_f32_16x16x64_bf16 v[80:83], v[132:135], a[80:87], v4
    v_smfmac_f32_16x16x64_bf16 v[76:79], v[136:139], a[32:39], v4
    v_smfmac_f32_16x16x64_bf16 v[80:83], v[136:139], a[112:119], v4
    v_smfmac_f32_16x16x64_bf16 v[76:79], v[140:143], a[64:71], v4
    v_smfmac_f32_16x16x64_bf16 v[80:83], v[140:143], a[144:151], v4
L_s1_glb_h1rest_0:
    s_waitcnt lgkmcnt(6)
    v_smfmac_f32_16x16x64_bf16 v[76:79], v[24:27], a[8:15], v4
    v_smfmac_f32_16x16x64_bf16 v[80:83], v[24:27], a[88:95], v4
    s_add_u32 s26, s24, 1
    v_mov_b32 v12, s26
    v_add_u32 v13, 1, v12
    s_waitcnt lgkmcnt(5)
    v_smfmac_f32_16x16x64_bf16 v[76:79], v[28:31], a[16:23], v4
    v_smfmac_f32_16x16x64_bf16 v[80:83], v[28:31], a[96:103], v4
    s_waitcnt lgkmcnt(4)
    v_smfmac_f32_16x16x64_bf16 v[76:79], v[32:35], a[24:31], v4
    v_smfmac_f32_16x16x64_bf16 v[80:83], v[32:35], a[104:111], v4
    s_waitcnt lgkmcnt(3)
    v_smfmac_f32_16x16x64_bf16 v[76:79], v[40:43], a[40:47], v4
    v_smfmac_f32_16x16x64_bf16 v[80:83], v[40:43], a[120:127], v4
    s_waitcnt lgkmcnt(2)
    v_smfmac_f32_16x16x64_bf16 v[76:79], v[44:47], a[48:55], v4
    v_smfmac_f32_16x16x64_bf16 v[80:83], v[44:47], a[128:135], v4
    s_waitcnt lgkmcnt(1)
    v_smfmac_f32_16x16x64_bf16 v[76:79], v[48:51], a[56:63], v4
    v_smfmac_f32_16x16x64_bf16 v[80:83], v[48:51], a[136:143], v4
    s_waitcnt lgkmcnt(0)
    v_smfmac_f32_16x16x64_bf16 v[76:79], v[56:59], a[72:79], v4
    v_smfmac_f32_16x16x64_bf16 v[80:83], v[56:59], a[152:159], v4
    buffer_store_dword v12, v9, s[4:7], s59 offen sc1
    ds_read_b128 v[164:167], v6 offset:0
    ds_read_b128 v[168:171], v6 offset:1024
    ds_read_b128 v[172:175], v6 offset:2048
    ds_read_b128 v[176:179], v6 offset:3072
    s_nop 1
    v_permlane32_swap_b32 v76, v78
    v_permlane32_swap_b32 v77, v79
    v_permlane32_swap_b32 v80, v82
    v_permlane32_swap_b32 v81, v83
    v_add_f32 v76, v76, v78
    v_add_f32 v80, v80, v82
    v_add_f32 v77, v77, v79
    v_add_f32 v81, v81, v83
    v_cvt_pk_bf16_f32 v10, v76, v80
    v_cvt_pk_bf16_f32 v15, v77, v81
    v_cvt_pk_bf16_f32 v11, v77, v81
    v_mov_b32_dpp v11, v10 row_ror:8 row_mask:0xf bank_mask:0x3
    v_mov_b32_dpp v10, v15 row_ror:8 row_mask:0xf bank_mask:0xc
    buffer_store_dword v11, v191, s[4:7], s38 offen sc1
    buffer_store_dword v10, v3, s[4:7], s38 offen sc1
    s_branch L_s1_glb_bub
L_s1_glb_h1retry_0:
    s_sub_u32 s23, s23, 1
    s_movk_i32 s29, 3
    s_cbranch_scc1 L_fail
    buffer_load_dwordx4 v[132:135], v144, s[4:7], s35 offen sc1
    buffer_load_dwordx4 v[136:139], v144, s[4:7], s36 offen sc1
    buffer_load_dwordx4 v[140:143], v144, s[4:7], s37 offen sc1
    s_waitcnt vmcnt(5)
    ds_write_b128 v145, v[148:151] offset:0
    v_max3_u32 v84, v148, v149, v150
    s_waitcnt vmcnt(4)
    ds_write_b128 v145, v[152:155] offset:4096
    v_max3_u32 v84, v151, v152, v84
    v_max3_u32 v84, v153, v154, v84
    s_waitcnt vmcnt(3)
    ds_write_b128 v145, v[156:159] offset:8192
    v_max3_u32 v84, v155, v156, v84
    v_max3_u32 v84, v157, v158, v84
    v_max_u32 v84, v159, v84
    v_cmp_eq_u32 vcc, -1, v84
    s_waitcnt lgkmcnt(0)
    s_cbranch_vccz L_s1_glb_h1okB_0
    buffer_load_dwordx4 v[148:151], v144, s[4:7], s35 offen sc1
    buffer_load_dwordx4 v[152:155], v144, s[4:7], s36 offen sc1
    buffer_load_dwordx4 v[156:159], v144, s[4:7], s37 offen sc1
    s_waitcnt vmcnt(5)
    ds_write_b128 v145, v[132:135] offset:0
    v_max3_u32 v84, v132, v133, v134
    s_waitcnt vmcnt(4)
    ds_write_b128 v145, v[136:139] offset:4096
    v_max3_u32 v84, v135, v136, v84
    v_max3_u32 v84, v137, v138, v84
    s_waitcnt vmcnt(3)
    ds_write_b128 v145, v[140:143] offset:8192
    v_max3_u32 v84, v139, v140, v84
    v_max3_u32 v84, v141, v142, v84
    v_max_u32 v84, v143, v84
    v_cmp_eq_u32 vcc, -1, v84
    s_waitcnt lgkmcnt(0)
    s_cbranch_vccz L_s1_glb_h1ok_0
    s_branch L_s1_glb_h1retry_0
L_s1_glb_h1okB_0:
    s_barrier
    ds_read_b128 v[24:27], v146 offset:1024
    ds_read_b128 v[28:31], v146 offset:2048
    ds_read_b128 v[32:35], v146 offset:3072
    ds_read_b128 v[40:43], v146 offset:5120
    ds_read_b128 v[44:47], v146 offset:6144
    ds_read_b128 v[48:51], v146 offset:7168
    ds_read_b128 v[56:59], v146 offset:9216
    v_smfmac_f32_16x16x64_bf16 v[76:79], v[148:151], a[0:7], v4
    v_smfmac_f32_16x16x64_bf16 v[80:83], v[148:151], a[80:87], v4
    v_smfmac_f32_16x16x64_bf16 v[76:79], v[152:155], a[32:39], v4
    v_smfmac_f32_16x16x64_bf16 v[80:83], v[152:155], a[112:119], v4
    v_smfmac_f32_16x16x64_bf16 v[76:79], v[156:159], a[64:71], v4
    v_smfmac_f32_16x16x64_bf16 v[80:83], v[156:159], a[144:151], v4
    s_branch L_s1_glb_h1rest_0
L_s1_glb_h1_1:
    buffer_load_dwordx4 v[132:135], v144, s[4:7], s35 offen sc1
    buffer_load_dwordx4 v[136:139], v144, s[4:7], s36 offen sc1
    buffer_load_dwordx4 v[140:143], v144, s[4:7], s37 offen sc1
    v_mov_b32 v76, 0
    v_mov_b32 v77, 0
    v_mov_b32 v78, 0
    v_mov_b32 v79, 0
    v_mov_b32 v80, 0
    v_mov_b32 v81, 0
    v_mov_b32 v82, 0
    v_mov_b32 v83, 0
    s_sleep 3
    buffer_load_dwordx4 v[148:151], v144, s[4:7], s35 offen sc1
    buffer_load_dwordx4 v[152:155], v144, s[4:7], s36 offen sc1
    buffer_load_dwordx4 v[156:159], v144, s[4:7], s37 offen sc1
    s_waitcnt vmcnt(5)
    ds_write_b128 v145, v[132:135] offset:0
    v_max3_u32 v84, v132, v133, v134
    s_waitcnt vmcnt(4)
    ds_write_b128 v145, v[136:139] offset:4096
    v_max3_u32 v84, v135, v136, v84
    v_max3_u32 v84, v137, v138, v84
    s_waitcnt vmcnt(3)
    ds_write_b128 v145, v[140:143] offset:8192
    v_max3_u32 v84, v139, v140, v84
    v_max3_u32 v84, v141, v142, v84
    v_max_u32 v84, v143, v84
    v_cmp_eq_u32 vcc, -1, v84
    s_waitcnt lgkmcnt(0)
    s_cbranch_vccnz L_s1_glb_h1retry_1
L_s1_glb_h1ok_1:
    s_barrier
    ds_read_b128 v[20:23], v146 offset:0
    ds_read_b128 v[28:31], v146 offset:2048
    ds_read_b128 v[32:35], v146 offset:3072
    ds_read_b128 v[36:39], v146 offset:4096
    ds_read_b128 v[44:47], v146 offset:6144
    ds_read_b128 v[48:51], v146 offset:7168
    ds_read_b128 v[52:55], v146 offset:8192
    v_smfmac_f32_16x16x64_bf16 v[76:79], v[132:135], a[8:15], v4
    v_smfmac_f32_16x16x64_bf16 v[80:83], v[132:135], a[88:95], v4
    v_smfmac_f32_16x16x64_bf16 v[76:79], v[136:139], a[40:47], v4
    v_smfmac_f32_16x16x64_bf16 v[80:83], v[136:139], a[120:127], v4
    v_smfmac_f32_16x16x64_bf16 v[76:79], v[140:143], a[72:79], v4
    v_smfmac_f32_16x16x64_bf16 v[80:83], v[140:143], a[152:159], v4
L_s1_glb_h1rest_1:
    s_waitcnt lgkmcnt(6)
    v_smfmac_f32_16x16x64_bf16 v[76:79], v[20:23], a[0:7], v4
    v_smfmac_f32_16x16x64_bf16 v[80:83], v[20:23], a[80:87], v4
    s_add_u32 s26, s24, 1
    v_mov_b32 v12, s26
    v_add_u32 v13, 1, v12
    s_waitcnt lgkmcnt(5)
    v_smfmac_f32_16x16x64_bf16 v[76:79], v[28:31], a[16:23], v4
    v_smfmac_f32_16x16x64_bf16 v[80:83], v[28:31], a[96:103], v4
    s_waitcnt lgkmcnt(4)
    v_smfmac_f32_16x16x64_bf16 v[76:79], v[32:35], a[24:31], v4
    v_smfmac_f32_16x16x64_bf16 v[80:83], v[32:35], a[104:111], v4
    s_waitcnt lgkmcnt(3)
    v_smfmac_f32_16x16x64_bf16 v[76:79], v[36:39], a[32:39], v4
    v_smfmac_f32_16x16x64_bf16 v[80:83], v[36:39], a[112:119], v4
    s_waitcnt lgkmcnt(2)
    v_smfmac_f32_16x16x64_bf16 v[76:79], v[44:47], a[48:55], v4
    v_smfmac_f32_16x16x64_bf16 v[80:83], v[44:47], a[128:135], v4
    s_waitcnt lgkmcnt(1)
    v_smfmac_f32_16x16x64_bf16 v[76:79], v[48:51], a[56:63], v4
    v_smfmac_f32_16x16x64_bf16 v[80:83], v[48:51], a[136:143], v4
    s_waitcnt lgkmcnt(0)
    v_smfmac_f32_16x16x64_bf16 v[76:79], v[52:55], a[64:71], v4
    v_smfmac_f32_16x16x64_bf16 v[80:83], v[52:55], a[144:151], v4
    ds_read_b128 v[164:167], v6 offset:0
    ds_read_b128 v[168:171], v6 offset:1024
    ds_read_b128 v[172:175], v6 offset:2048
    ds_read_b128 v[176:179], v6 offset:3072
    s_nop 2
    v_permlane32_swap_b32 v76, v78
    v_permlane32_swap_b32 v77, v79
    v_permlane32_swap_b32 v80, v82
    v_permlane32_swap_b32 v81, v83
    v_add_f32 v76, v76, v78
    v_add_f32 v80, v80, v82
    v_add_f32 v77, v77, v79
    v_add_f32 v81, v81, v83
    v_cvt_pk_bf16_f32 v10, v76, v80
    v_cvt_pk_bf16_f32 v15, v77, v81
    v_cvt_pk_bf16_f32 v11, v77, v81
    v_mov_b32_dpp v11, v10 row_ror:8 row_mask:0xf bank_mask:0x3
    v_mov_b32_dpp v10, v15 row_ror:8 row_mask:0xf bank_mask:0xc
    buffer_store_dword v11, v191, s[4:7], s38 offen sc1
    buffer_store_dword v10, v3, s[4:7], s38 offen sc1
    s_branch L_s1_glb_bub
L_s1_glb_h1retry_1:
    s_sub_u32 s23, s23, 1
    s_movk_i32 s29, 3
    s_cbranch_scc1 L_fail
    buffer_load_dwordx4 v[132:135], v144, s[4:7], s35 offen sc1
    buffer_load_dwordx4 v[136:139], v144, s[4:7], s36 offen sc1
    buffer_load_dwordx4 v[140:143], v144, s[4:7], s37 offen sc1
    s_waitcnt vmcnt(5)
    ds_write_b128 v145, v[148:151] offset:0
    v_max3_u32 v84, v148, v149, v150
    s_waitcnt vmcnt(4)
    ds_write_b128 v145, v[152:155] offset:4096
    v_max3_u32 v84, v151, v152, v84
    v_max3_u32 v84, v153, v154, v84
    s_waitcnt vmcnt(3)
    ds_write_b128 v145, v[156:159] offset:8192
    v_max3_u32 v84, v155, v156, v84
    v_max3_u32 v84, v157, v158, v84
    v_max_u32 v84, v159, v84
    v_cmp_eq_u32 vcc, -1, v84
    s_waitcnt lgkmcnt(0)
    s_cbranch_vccz L_s1_glb_h1okB_1
    buffer_load_dwordx4 v[148:151], v144, s[4:7], s35 offen sc1
    buffer_load_dwordx4 v[152:155], v144, s[4:7], s36 offen sc1
    buffer_load_dwordx4 v[156:159], v144, s[4:7], s37 offen sc1
    s_waitcnt vmcnt(5)
    ds_write_b128 v145, v[132:135] offset:0
    v_max3_u32 v84, v132, v133, v134
    s_waitcnt vmcnt(4)
    ds_write_b128 v145, v[136:139] offset:4096
    v_max3_u32 v84, v135, v136, v84
    v_max3_u32 v84, v137, v138, v84
    s_waitcnt vmcnt(3)
    ds_write_b128 v145, v[140:143] offset:8192
    v_max3_u32 v84, v139, v140, v84
    v_max3_u32 v84, v141, v142, v84
    v_max_u32 v84, v143, v84
    v_cmp_eq_u32 vcc, -1, v84
    s_waitcnt lgkmcnt(0)
    s_cbranch_vccz L_s1_glb_h1ok_1
    s_branch L_s1_glb_h1retry_1
L_s1_glb_h1okB_1:
    s_barrier
    ds_read_b128 v[20:23], v146 offset:0
    ds_read_b128 v[28:31], v146 offset:2048
    ds_read_b128 v[32:35], v146 offset:3072
    ds_read_b128 v[36:39], v146 offset:4096
    ds_read_b128 v[44:47], v146 offset:6144
    ds_read_b128 v[48:51], v146 offset:7168
    ds_read_b128 v[52:55], v146 offset:8192
    v_smfmac_f32_16x16x64_bf16 v[76:79], v[148:151], a[8:15], v4
    v_smfmac_f32_16x16x64_bf16 v[80:83], v[148:151], a[88:95], v4
    v_smfmac_f32_16x16x64_bf16 v[76:79], v[152:155], a[40:47], v4
    v_smfmac_f32_16x16x64_bf16 v[80:83], v[152:155], a[120:127], v4
    v_smfmac_f32_16x16x64_bf16 v[76:79], v[156:159], a[72:79], v4
    v_smfmac_f32_16x16x64_bf16 v[80:83], v[156:159], a[152:159], v4
    s_branch L_s1_glb_h1rest_1
L_s1_glb_h1_2:
    buffer_load_dwordx4 v[132:135], v144, s[4:7], s35 offen sc1
    buffer_load_dwordx4 v[136:139], v144, s[4:7], s36 offen sc1
    v_mov_b32 v76, 0
    v_mov_b32 v77, 0
    v_mov_b32 v78, 0
    v_mov_b32 v79, 0
    v_mov_b32 v80, 0
    v_mov_b32 v81, 0
    v_mov_b32 v82, 0
    v_mov_b32 v83, 0
    s_sleep 3
    buffer_load_dwordx4 v[148:151], v144, s[4:7], s35 offen sc1
    buffer_load_dwordx4 v[152:155], v144, s[4:7], s36 offen sc1
    s_waitcnt vmcnt(3)
    ds_write_b128 v145, v[132:135] offset:0
    v_max3_u32 v84, v132, v133, v134
    s_waitcnt vmcnt(2)
    ds_write_b128 v145, v[136:139] offset:4096
    v_max3_u32 v84, v135, v136, v84
    v_max3_u32 v84, v137, v138, v84
    v_max_u32 v84, v139, v84
    v_cmp_eq_u32 vcc, -1, v84
    s_waitcnt lgkmcnt(0)
    s_cbranch_vccnz L_s1_glb_h1retry_2
L_s1_glb_h1ok_2:
    s_barrier
    ds_read_b128 v[20:23], v146 offset:0
    ds_read_b128 v[24:27], v146 offset:1024
    ds_read_b128 v[32:35], v146 offset:3072
    ds_read_b128 v[36:39], v146 offset:4096
    ds_read_b128 v[40:43], v146 offset:5120
    ds_read_b128 v[48:51], v146 offset:7168
    ds_read_b128 v[52:55], v146 offset:8192
    ds_read_b128 v[56:59], v146 offset:9216
    v_smfmac_f32_16x16x64_bf16 v[76:79], v[132:135], a[16:23], v4
    v_smfmac_f32_16x16x64_bf16 v[80:83], v[132:135], a[96:103], v4
    v_smfmac_f32_16x16x64_bf16 v[76:79], v[136:139], a[48:55], v4
    v_smfmac_f32_16x16x64_bf16 v[80:83], v[136:139], a[128:135], v4
L_s1_glb_h1rest_2:
    s_waitcnt lgkmcnt(7)
    v_smfmac_f32_16x16x64_bf16 v[76:79], v[20:23], a[0:7], v4
    v_smfmac_f32_16x16x64_bf16 v[80:83], v[20:23], a[80:87], v4
    s_add_u32 s26, s24, 1
    v_mov_b32 v12, s26
    v_add_u32 v13, 1, v12
    s_waitcnt lgkmcnt(6)
    v_smfmac_f32_16x16x64_bf16 v[76:79], v[24:27], a[8:15], v4
    v_smfmac_f32_16x16x64_bf16 v[80:83], v[24:27], a[88:95], v4
    s_waitcnt lgkmcnt(5)
    v_smfmac_f32_16x16x64_bf16 v[76:79], v[32:35], a[24:31], v4
    v_smfmac_f32_16x16x64_bf16 v[80:83], v[32:35], a[104:111], v4
    s_waitcnt lgkmcnt(4)
    v_smfmac_f32_16x16x64_bf16 v[76:79], v[36:39], a[32:39], v4
    v_smfmac_f32_16x16x64_bf16 v[80:83], v[36:39], a[112:119], v4
    s_waitcnt lgkmcnt(3)
    v_smfmac_f32_16x16x64_bf16 v[76:79], v[40:43], a[40:47], v4
    v_smfmac_f32_16x16x64_bf16 v[80:83], v[40:43], a[120:127], v4
    s_waitcnt lgkmcnt(2)
    v_smfmac_f32_16x16x64_bf16 v[76:79], v[48:51], a[56:63], v4
    v_smfmac_f32_16x16x64_bf16 v[80:83], v[48:51], a[136:143], v4
    s_waitcnt lgkmcnt(1)
    v_smfmac_f32_16x16x64_bf16 v[76:79], v[52:55], a[64:71], v4
    v_smfmac_f32_16x16x64_bf16 v[80:83], v[52:55], a[144:151], v4
    s_waitcnt lgkmcnt(0)
    v_smfmac_f32_16x16x64_bf16 v[76:79], v[56:59], a[72:79], v4
    v_smfmac_f32_16x16x64_bf16 v[80:83], v[56:59], a[152:159], v4
    ds_read_b128 v[164:167], v6 offset:0
    ds_read_b128 v[168:171], v6 offset:1024
    ds_read_b128 v[172:175], v6 offset:2048
    ds_read_b128 v[176:179], v6 offset:3072
    s_nop 2
    v_permlane32_swap_b32 v76, v78
    v_permlane32_swap_b32 v77, v79
    v_permlane32_swap_b32 v80, v82
    v_permlane32_swap_b32 v81, v83
    v_add_f32 v76, v76, v78
    v_add_f32 v80, v80, v82
    v_add_f32 v77, v77, v79
    v_add_f32 v81, v81, v83
    v_cvt_pk_bf16_f32 v10, v76, v80
    v_cvt_pk_bf16_f32 v15, v77, v81
    v_cvt_pk_bf16_f32 v11, v77, v81
    v_mov_b32_dpp v11, v10 row_ror:8 row_mask:0xf bank_mask:0x3
    v_mov_b32_dpp v10, v15 row_ror:8 row_mask:0xf bank_mask:0xc
    buffer_store_dword v11, v191, s[4:7], s38 offen sc1
    buffer_store_dword v10, v3, s[4:7], s38 offen sc1
    s_branch L_s1_glb_bub
L_s1_glb_h1retry_2:
    s_sub_u32 s23, s23, 1
    s_movk_i32 s29, 3
    s_cbranch_scc1 L_fail
    buffer_load_dwordx4 v[132:135], v144, s[4:7], s35 offen sc1
    buffer_load_dwordx4 v[136:139], v144, s[4:7], s36 offen sc1
    s_waitcnt vmcnt(3)
    ds_write_b128 v145, v[148:151] offset:0
    v_max3_u32 v84, v148, v149, v150
    s_waitcnt vmcnt(2)
    ds_write_b128 v145, v[152:155] offset:4096
    v_max3_u32 v84, v151, v152, v84
    v_max3_u32 v84, v153, v154, v84
    v_max_u32 v84, v155, v84
    v_cmp_eq_u32 vcc, -1, v84
    s_waitcnt lgkmcnt(0)
    s_cbranch_vccz L_s1_glb_h1okB_2
    buffer_load_dwordx4 v[148:151], v144, s[4:7], s35 offen sc1
    buffer_load_dwordx4 v[152:155], v144, s[4:7], s36 offen sc1
    s_waitcnt vmcnt(3)
    ds_write_b128 v145, v[132:135] offset:0
    v_max3_u32 v84, v132, v133, v134
    s_waitcnt vmcnt(2)
    ds_write_b128 v145, v[136:139] offset:4096
    v_max3_u32 v84, v135, v136, v84
    v_max3_u32 v84, v137, v138, v84
    v_max_u32 v84, v139, v84
    v_cmp_eq_u32 vcc, -1, v84
    s_waitcnt lgkmcnt(0)
    s_cbranch_vccz L_s1_glb_h1ok_2
    s_branch L_s1_glb_h1retry_2
L_s1_glb_h1okB_2:
    s_barrier
    ds_read_b128 v[20:23], v146 offset:0
    ds_read_b128 v[24:27], v146 offset:1024
    ds_read_b128 v[32:35], v146 offset:3072
    ds_read_b128 v[36:39], v146 offset:4096
    ds_read_b128 v[40:43], v146 offset:5120
    ds_read_b128 v[48:51], v146 offset:7168
    ds_read_b128 v[52:55], v146 offset:8192
    ds_read_b128 v[56:59], v146 offset:9216
    v_smfmac_f32_16x16x64_bf16 v[76:79], v[148:151], a[16:23], v4
    v_smfmac_f32_16x16x64_bf16 v[80:83], v[148:151], a[96:103], v4
    v_smfmac_f32_16x16x64_bf16 v[76:79], v[152:155], a[48:55], v4
    v_smfmac_f32_16x16x64_bf16 v[80:83], v[152:155], a[128:135], v4
    s_branch L_s1_glb_h1rest_2
L_s1_glb_slow:
    v_max3_u32 v84, v60, v61, v62
    v_max3_u32 v84, v63, v64, v84
    v_max3_u32 v84, v65, v66, v84
    v_max_u32 v84, v67, v84
    v_cmp_eq_u32 vcc, -1, v84
    v_min_u32 v14, -2, v14
    s_cbranch_vccz L_s1_glb_cont
    s_sub_u32 s23, s23, 1
    s_movk_i32 s29, 2
    s_cbranch_scc1 L_fail
    s_branch L_s1_glb_s3
L_s1_done:
    s_cmp_lg_u32 s22, 0
    s_cbranch_scc1 L_end
    s_cmp_ge_u32 s2, 80
    s_cbranch_scc1 L_end
    s_add_u32 s74, s2, 1200
    s_mov_b32 s79, 0
    s_mov_b32 s32, 0
    s_branch L_mixent
L_s2:
    s_sub_u32 s30, s21, 18
    s_load_dwordx2 s[12:13], s[0:1], 40
    v_lshlrev_b32 v1, 4, v0
    v_lshrrev_b32 v16, 3, v0
    v_mul_u32_u24 v16, 1280, v16
    v_and_b32 v17, 7, v0
    v_lshl_add_u32 v16, v17, 4, v16
    s_lshl_b32 s26, s20, 2
    s_add_u32 s26, s26, s22
    s_mul_i32 s26, s26, 245760
    s_lshl_b32 s27, s30, 7
    s_add_u32 s26, s26, s27
    s_mul_i32 s28, s22, 24576
    s_mov_b32 m0, s28
    s_waitcnt lgkmcnt(0)
    s_and_b32 s13, s13, 0xffff
    s_mov_b32 s14, 7864320
    s_mov_b32 s15, 0x20000
    s_load_dwordx4 s[60:63], s[0:1], 16
    s_load_dwordx2 s[64:65], s[0:1], 32
    s_lshl_b32 s66, s30, 2
    s_add_u32 s66, s66, s22
    s_cmp_ge_u32 s66, 36
    s_cbranch_scc1 L_nopf_17
    s_mul_i32 s67, s66, 43
    s_lshr_b32 s67, s67, 9
    s_mul_i32 s72, s67, 12
    s_sub_u32 s66, s66, s72
    s_lshl_b32 s66, s66, 7
    s_mul_i32 s72, s20, 1536
    s_add_u32 s66, s66, s72
    s_add_u32 s66, s66, 3145728
    v_lshrrev_b32 v18, 3, v0
    v_mul_u32_u24 v18, 12288, v18
    v_lshl_add_u32 v18, v17, 4, v18
    s_waitcnt lgkmcnt(0)
    s_cmp_eq_u32 s67, 1
    s_cselect_b64 s[68:69], s[62:63], s[60:61]
    s_cmp_eq_u32 s67, 2
    s_cselect_b64 s[68:69], s[64:65], s[68:69]
    s_and_b32 s69, s69, 0xffff
    s_mov_b32 s70, 7864320
    s_mov_b32 s71, 0x20000
    buffer_load_dwordx4 v[32:35], v18, s[68:71], s66 offen
    s_add_u32 s66, s66, 98304
    buffer_load_dwordx4 v[32:35], v18, s[68:71], s66 offen
    s_add_u32 s66, s66, 98304
    buffer_load_dwordx4 v[32:35], v18, s[68:71], s66 offen
    s_add_u32 s66, s66, 98304
    buffer_load_dwordx4 v[32:35], v18, s[68:71], s66 offen
    s_add_u32 s66, s66, 98304
    buffer_load_dwordx4 v[32:35], v18, s[68:71], s66 offen
    s_add_u32 s66, s66, 98304
    buffer_load_dwordx4 v[32:35], v18, s[68:71], s66 offen
    s_add_u32 s66, s66, 98304
    buffer_load_dwordx4 v[32:35], v18, s[68:71], s66 offen
    s_add_u32 s66, s66, 98304
    buffer_load_dwordx4 v[32:35], v18, s[68:71], s66 offen
    s_add_u32 s66, s66, 98304
    buffer_load_dwordx4 v[32:35], v18, s[68:71], s66 offen
    s_add_u32 s66, s66, 98304
    buffer_load_dwordx4 v[32:35], v18, s[68:71], s66 offen
    s_add_u32 s66, s66, 98304
    buffer_load_dwordx4 v[32:35], v18, s[68:71], s66 offen
    s_add_u32 s66, s66, 98304
    buffer_load_dwordx4 v[32:35], v18, s[68:71], s66 offen
    s_add_u32 s66, s66, 98304
    buffer_load_dwordx4 v[32:35], v18, s[68:71], s66 offen
    s_add_u32 s66, s66, 98304
    buffer_load_dwordx4 v[32:35], v18, s[68:71], s66 offen
    s_add_u32 s66, s66, 98304
    buffer_load_dwordx4 v[32:35], v18, s[68:71], s66 offen
    s_add_u32 s66, s66, 98304
    buffer_load_dwordx4 v[32:35], v18, s[68:71], s66 offen
    s_add_u32 s66, s66, 98304
    buffer_load_dwordx4 v[32:35], v18, s[68:71], s66 offen
    s_add_u32 s66, s66, 98304
    buffer_load_dwordx4 v[32:35], v18, s[68:71], s66 offen
    s_add_u32 s66, s66, 98304
    buffer_load_dwordx4 v[32:35], v18, s[68:71], s66 offen
    s_add_u32 s66, s66, 98304
    buffer_load_dwordx4 v[32:35], v18, s[68:71], s66 offen
    s_add_u32 s66, s66, 98304
    buffer_load_dwordx4 v[32:35], v18, s[68:71], s66 offen
    s_add_u32 s66, s66, 98304
    buffer_load_dwordx4 v[32:35], v18, s[68:71], s66 offen
    s_add_u32 s66, s66, 98304
    buffer_load_dwordx4 v[32:35], v18, s[68:71], s66 offen
    s_add_u32 s66, s66, 98304
    buffer_load_dwordx4 v[32:35], v18, s[68:71], s66 offen
    s_add_u32 s66, s66, 98304
    buffer_load_dwordx4 v[32:35], v18, s[68:71], s66 offen
    s_add_u32 s66, s66, 98304
    buffer_load_dwordx4 v[32:35], v18, s[68:71], s66 offen
    s_add_u32 s66, s66, 98304
    buffer_load_dwordx4 v[32:35], v18, s[68:71], s66 offen
    s_add_u32 s66, s66, 98304
    buffer_load_dwordx4 v[32:35], v18, s[68:71], s66 offen
    s_add_u32 s66, s66, 98304
    buffer_load_dwordx4 v[32:35], v18, s[68:71], s66 offen
    s_add_u32 s66, s66, 98304
    buffer_load_dwordx4 v[32:35], v18, s[68:71], s66 offen
    s_add_u32 s66, s66, 98304
    buffer_load_dwordx4 v[32:35], v18, s[68:71], s66 offen
    s_add_u32 s66, s66, 98304
    buffer_load_dwordx4 v[32:35], v18, s[68:71], s66 offen
    s_add_u32 s66, s66, 98304
L_nopf_17:
    s_waitcnt lgkmcnt(0)
    buffer_load_dwordx4 v16, s[12:15], s26 offen nt lds
    s_add_u32 m0, m0, 1024
    s_add_u32 s26, s26, 10240
    buffer_load_dwordx4 v16, s[12:15], s26 offen nt lds
    s_add_u32 m0, m0, 1024
    s_add_u32 s26, s26, 10240
    buffer_load_dwordx4 v16, s[12:15], s26 offen nt lds
    s_add_u32 m0, m0, 1024
    s_add_u32 s26, s26, 10240
    buffer_load_dwordx4 v16, s[12:15], s26 offen nt lds
    s_add_u32 m0, m0, 1024
    s_add_u32 s26, s26, 10240
    buffer_load_dwordx4 v16, s[12:15], s26 offen nt lds
    s_add_u32 m0, m0, 1024
    s_add_u32 s26, s26, 10240
    buffer_load_dwordx4 v16, s[12:15], s26 offen nt lds
    s_add_u32 m0, m0, 1024
    s_add_u32 s26, s26, 10240
    buffer_load_dwordx4 v16, s[12:15], s26 offen nt lds
    s_add_u32 m0, m0, 1024
    s_add_u32 s26, s26, 10240
    buffer_load_dwordx4 v16, s[12:15], s26 offen nt lds
    s_add_u32 m0, m0, 1024
    s_add_u32 s26, s26, 10240
    buffer_load_dwordx4 v16, s[12:15], s26 offen nt lds
    s_add_u32 m0, m0, 1024
    s_add_u32 s26, s26, 10240
    buffer_load_dwordx4 v16, s[12:15], s26 offen nt lds
    s_add_u32 m0, m0, 1024
    s_add_u32 s26, s26, 10240
    buffer_load_dwordx4 v16, s[12:15], s26 offen nt lds
    s_add_u32 m0, m0, 1024
    s_add_u32 s26, s26, 10240
    buffer_load_dwordx4 v16, s[12:15], s26 offen nt lds
    s_add_u32 m0, m0, 1024
    s_add_u32 s26, s26, 10240
    buffer_load_dwordx4 v16, s[12:15], s26 offen nt lds
    s_add_u32 m0, m0, 1024
    s_add_u32 s26, s26, 10240
    buffer_load_dwordx4 v16, s[12:15], s26 offen nt lds
    s_add_u32 m0, m0, 1024
    s_add_u32 s26, s26, 10240
    buffer_load_dwordx4 v16, s[12:15], s26 offen nt lds
    s_add_u32 m0, m0, 1024
    s_add_u32 s26, s26, 10240
    buffer_load_dwordx4 v16, s[12:15], s26 offen nt lds
    s_add_u32 m0, m0, 1024
    s_add_u32 s26, s26, 10240
    buffer_load_dwordx4 v16, s[12:15], s26 offen nt lds
    s_add_u32 m0, m0, 1024
    s_add_u32 s26, s26, 10240
    buffer_load_dwordx4 v16, s[12:15], s26 offen nt lds
    s_add_u32 m0, m0, 1024
    s_add_u32 s26, s26, 10240
    buffer_load_dwordx4 v16, s[12:15], s26 offen nt lds
    s_add_u32 m0, m0, 1024
    s_add_u32 s26, s26, 10240
    buffer_load_dwordx4 v16, s[12:15], s26 offen nt lds
    s_add_u32 m0, m0, 1024
    s_add_u32 s26, s26, 10240
    buffer_load_dwordx4 v16, s[12:15], s26 offen nt lds
    s_add_u32 m0, m0, 1024
    s_add_u32 s26, s26, 10240
    buffer_load_dwordx4 v16, s[12:15], s26 offen nt lds
    s_add_u32 m0, m0, 1024
    s_add_u32 s26, s26, 10240
    buffer_load_dwordx4 v16, s[12:15], s26 offen nt lds
    s_add_u32 m0, m0, 1024
    s_add_u32 s26, s26, 10240
    buffer_load_dwordx4 v16, s[12:15], s26 offen nt lds
    v_and_b32 v17, 15, v0
    v_lshrrev_b32 v18, 4, v0
    v_cmp_gt_u32 s[56:57], 8, v17
    v_mov_b32 v19, 0xeeee
    v_mov_b32 v20, 0x4444
    v_cndmask_b32 v3, v19, v20, s[56:57]
    v_mov_b32 v12, -1
    v_mov_b32 v13, -1
    v_mov_b32 v14, -1
    v_mov_b32 v15, -1
    v_lshlrev_b32 v7, 3, v0
    v_mov_b32 v19, 0x3f803f80
    v_mov_b32 v70, v19
    v_mov_b32 v71, v19
    v_mov_b32 v72, v19
    v_mov_b32 v73, v19
    v_cmp_gt_u32 vcc, 32, v0
    s_nop 1
    v_cndmask_b32 v74, 0, v19, vcc
    v_cndmask_b32 v75, 0, v19, vcc
    s_lshl_b32 s26, s22, 11
    s_add_u32 s26, s26, 98304
    v_lshrrev_b32 v19, 1, v0
    v_and_b32 v19, 8, v19
    v_xor_b32 v19, v0, v19
    v_lshl_add_u32 v4, v19, 4, s26
    v_bfe_u32 v19, v0, 3, 2
    v_and_b32 v20, 3, v0
    v_lshl_add_u32 v19, v20, 2, v19
    v_bfe_u32 v20, v0, 1, 2
    v_lshl_add_u32 v19, v20, 4, v19
    s_lshr_b32 s27, s22, 1
    s_lshl_b32 s27, s27, 3
    v_xor_b32 v19, s27, v19
    s_and_b32 s26, s22, 1
    s_lshl_b32 s26, s26, 10
    s_add_u32 s26, s26, 98304
    v_lshl_add_u32 v5, v19, 4, s26
    s_lshl_b32 s26, s22, 11
    s_add_u32 s26, s26, 106496
    v_add_u32 v11, s26, v1
    s_lshl_b32 s26, s22, 13
    s_add_u32 s26, s26, 106496
    v_add_u32 v99, s26, v1
    v_and_b32 v20, 31, v0
    v_lshlrev_b32 v20, 3, v20
    v_lshrrev_b32 v21, 5, v0
    v_lshl_add_u32 v6, v21, 13, v20
    v_mov_b32 v19, 536870912
    v_cmp_eq_u32 vcc, 0, v0
    s_nop 1
    v_cndmask_b32 v8, v19, v0, vcc
    v_min_u32 v9, 11, v0
    v_lshlrev_b32 v9, 2, v9
    v_min_u32 v10, 17, v0
    v_lshlrev_b32 v10, 2, v10
    s_mul_i32 s32, s20, 147456
    s_mul_i32 s26, s22, 9216
    s_add_u32 s32, s32, s26
    s_add_u32 s32, s32, 327680
    s_lshl_b32 s35, s30, 14
    s_lshl_b32 s26, s22, 11
    s_add_u32 s35, s35, s26
    s_lshl_b32 s26, s20, 8
    s_add_u32 s35, s35, s26
    s_add_u32 s35, s35, 2097152
    s_mul_i32 s38, s20, 606208
    s_mul_i32 s26, s22, 37888
    s_add_u32 s38, s38, s26
    s_add_u32 s38, s38, 2883584
    s_add_u32 s39, s38, 606208
    s_mul_i32 s41, s20, 49152
    s_mul_i32 s26, s22, 3072
    s_add_u32 s41, s41, s26
    s_add_u32 s41, s41, 1507328
    s_lshl_b32 s42, s30, 15
    s_lshl_b32 s26, s20, 12
    s_add_u32 s42, s42, s26
    s_lshl_b32 s26, s22, 10
    s_add_u32 s42, s42, s26
    s_add_u32 s42, s42, 9437184
    s_lshl_b32 s43, s30, 7
    s_lshl_b32 s26, s20, 4
    s_add_u32 s43, s43, s26
    s_lshl_b32 s26, s22, 2
    s_add_u32 s43, s43, s26
    s_add_u32 s43, s43, 2822144
    s_lshl_b32 s44, s20, 9
    s_mul_i32 s26, s22, 72
    s_add_u32 s44, s44, s26
    s_add_u32 s44, s44, 2818072
    s_lshl_b32 s46, s20, 7
    s_lshl_b32 s26, s30, 2
    s_add_u32 s45, s46, s26
    s_add_u32 s45, s45, 2827264
    s_cmp_eq_u32 s22, 0
    s_cselect_b32 s45, s45, 536870912
    s_add_u32 s46, s46, 2828288
    s_mul_i32 s26, s30, 6554
    s_lshr_b32 s26, s26, 16
    s_mul_i32 s27, s26, 10
    s_mul_i32 s55, s20, 1
    s_add_u32 s55, s55, s26
    s_lshl_b32 s55, s55, 10
    s_add_u32 s55, s55, 2753408
    s_sub_u32 s27, s30, s27
    s_or_b32 s27, s27, s22
    s_cselect_b32 s55, 536870912, s55
    v_lshlrev_b32 v20, 13, v0
    v_cmp_gt_u32 vcc, 2, v0
    v_mov_b32 v21, 536870912
    s_nop 0
    v_cndmask_b32 v151, v21, v20, vcc
    v_mov_b32 v236, 1
    s_mov_b32 s47, 0x3dd53b95
    v_bfe_u32 v19, v0, 3, 1
    v_bfe_u32 v20, v0, 2, 1
    v_lshl_add_u32 v19, v20, 4, v19
    v_lshl_add_u32 v19, v18, 2, v19
    v_lshlrev_b32 v19, 7, v19
    v_and_b32 v20, 3, v0
    v_lshl_add_u32 v19, v20, 3, v19
    v_add_u32 v19, s28, v19
    s_waitcnt vmcnt(20)
    ds_read_b64_tr_b16 a[0:1], v19 offset:0
    ds_read_b64_tr_b16 a[2:3], v19 offset:256
    ds_read_b64_tr_b16 a[24:25], v19 offset:32
    ds_read_b64_tr_b16 a[26:27], v19 offset:288
    ds_read_b64_tr_b16 a[48:49], v19 offset:64
    ds_read_b64_tr_b16 a[50:51], v19 offset:320
    ds_read_b64_tr_b16 a[72:73], v19 offset:96
    ds_read_b64_tr_b16 a[74:75], v19 offset:352
    s_waitcnt vmcnt(16)
    ds_read_b64_tr_b16 a[4:5], v19 offset:4096
    ds_read_b64_tr_b16 a[6:7], v19 offset:4352
    ds_read_b64_tr_b16 a[28:29], v19 offset:4128
    ds_read_b64_tr_b16 a[30:31], v19 offset:4384
    ds_read_b64_tr_b16 a[52:53], v19 offset:4160
    ds_read_b64_tr_b16 a[54:55], v19 offset:4416
    ds_read_b64_tr_b16 a[76:77], v19 offset:4192
    ds_read_b64_tr_b16 a[78:79], v19 offset:4448
    s_waitcnt vmcnt(12)
    ds_read_b64_tr_b16 a[8:9], v19 offset:8192
    ds_read_b64_tr_b16 a[10:11], v19 offset:8448
    ds_read_b64_tr_b16 a[32:33], v19 offset:8224
    ds_read_b64_tr_b16 a[34:35], v19 offset:8480
    ds_read_b64_tr_b16 a[56:57], v19 offset:8256
    ds_read_b64_tr_b16 a[58:59], v19 offset:8512
    ds_read_b64_tr_b16 a[80:81], v19 offset:8288
    ds_read_b64_tr_b16 a[82:83], v19 offset:8544
    s_waitcnt vmcnt(8)
    ds_read_b64_tr_b16 a[12:13], v19 offset:12288
    ds_read_b64_tr_b16 a[14:15], v19 offset:12544
    ds_read_b64_tr_b16 a[36:37], v19 offset:12320
    ds_read_b64_tr_b16 a[38:39], v19 offset:12576
    ds_read_b64_tr_b16 a[60:61], v19 offset:12352
    ds_read_b64_tr_b16 a[62:63], v19 offset:12608
    ds_read_b64_tr_b16 a[84:85], v19 offset:12384
    ds_read_b64_tr_b16 a[86:87], v19 offset:12640
    s_waitcnt vmcnt(4)
    ds_read_b64_tr_b16 a[16:17], v19 offset:16384
    ds_read_b64_tr_b16 a[18:19], v19 offset:16640
    ds_read_b64_tr_b16 a[40:41], v19 offset:16416
    ds_read_b64_tr_b16 a[42:43], v19 offset:16672
    ds_read_b64_tr_b16 a[64:65], v19 offset:16448
    ds_read_b64_tr_b16 a[66:67], v19 offset:16704
    ds_read_b64_tr_b16 a[88:89], v19 offset:16480
    ds_read_b64_tr_b16 a[90:91], v19 offset:16736
    s_waitcnt vmcnt(0)
    ds_read_b64_tr_b16 a[20:21], v19 offset:20480
    ds_read_b64_tr_b16 a[22:23], v19 offset:20736
    ds_read_b64_tr_b16 a[44:45], v19 offset:20512
    ds_read_b64_tr_b16 a[46:47], v19 offset:20768
    ds_read_b64_tr_b16 a[68:69], v19 offset:20544
    ds_read_b64_tr_b16 a[70:71], v19 offset:20800
    ds_read_b64_tr_b16 a[92:93], v19 offset:20576
    ds_read_b64_tr_b16 a[94:95], v19 offset:20832
    s_waitcnt lgkmcnt(0)
    s_lshl_b32 s93, s20, 1
    s_add_u32 s93, s93, 16
    s_add_u32 s94, s93, 1
L_loc_18:
    v_lshlrev_b32 v16, 2, v0
    buffer_load_dword v17, v16, s[16:19], 0 offen sc1
    s_sub_u32 s23, s23, 1
    s_movk_i32 s29, 1
    s_cbranch_scc1 L_fail
L_loc1_19:
    s_waitcnt vmcnt(0)
    v_readlane_b32 s26, v17, s93
    v_readlane_b32 s27, v17, s94
    v_readlane_b32 s29, v17, 56
    s_lshr_b32 s28, s27, 24
    s_min_u32 s28, s28, s29
    s_cmp_lt_u32 s28, 32
    s_cbranch_scc1 L_loc_18
    s_lshl_b32 s27, s30, 2
    s_add_u32 s27, s27, s22
    s_mul_i32 s26, s20, 147456
    s_mul_i32 s28, s27, 4096
    s_min_u32 s28, s28, 143360
    s_add_u32 s26, s26, s28
    s_add_u32 s26, s26, 327680
    buffer_load_dwordx4 v[32:35], v1, s[4:7], s26 offen offset:0 sc1
    buffer_load_dwordx4 v[32:35], v1, s[4:7], s26 offen offset:1024 sc1
    buffer_load_dwordx4 v[32:35], v1, s[4:7], s26 offen offset:2048 sc1
    buffer_load_dwordx4 v[32:35], v1, s[4:7], s26 offen offset:3072 sc1
    s_mul_i32 s26, s20, 49152
    s_mul_i32 s28, s27, 2048
    s_min_u32 s28, s28, 47104
    s_add_u32 s26, s26, s28
    s_add_u32 s26, s26, 1507328
    buffer_load_dwordx4 v[32:35], v1, s[4:7], s26 offen offset:0 sc1
    buffer_load_dwordx4 v[32:35], v1, s[4:7], s26 offen offset:1024 sc1
    s_mul_i32 s26, s20, 40960
    s_mul_i32 s28, s27, 1024
    s_min_u32 s28, s28, 39936
    s_add_u32 s26, s26, s28
    s_add_u32 s26, s26, 0
    buffer_load_dwordx4 v[32:35], v1, s[4:7], s26 offen offset:0 sc1
    s_mov_b32 s48, 1
L_xfl_20:
    buffer_load_dword v68, v9, s[4:7], s44 offen sc1
    s_sub_u32 s23, s23, 1
    s_movk_i32 s29, 4
    s_cbranch_scc1 L_fail
    s_waitcnt vmcnt(0)
    v_cmp_gt_u32 vcc, s48, v68
    s_cbranch_vccnz L_xfl_20
L_xflok_21:
    s_add_u32 s37, s38, 24576
    s_add_u32 s53, s37, 4096
    s_add_u32 s54, s37, 8192
    buffer_load_dwordx4 a[144:147], v1, s[4:7], s37 offen offset:0 sc1
    buffer_load_dwordx4 a[168:171], v1, s[4:7], s37 offen offset:1024 sc1
    buffer_load_dwordx4 a[148:151], v1, s[4:7], s37 offen offset:2048 sc1
    buffer_load_dwordx4 a[172:175], v1, s[4:7], s37 offen offset:3072 sc1
    buffer_load_dwordx4 a[152:155], v1, s[4:7], s53 offen offset:0 sc1
    buffer_load_dwordx4 a[176:179], v1, s[4:7], s53 offen offset:1024 sc1
    buffer_load_dwordx4 a[156:159], v1, s[4:7], s53 offen offset:2048 sc1
    buffer_load_dwordx4 a[180:183], v1, s[4:7], s53 offen offset:3072 sc1
    buffer_load_dwordx4 a[160:163], v1, s[4:7], s54 offen offset:0 sc1
    buffer_load_dwordx4 a[184:187], v1, s[4:7], s54 offen offset:1024 sc1
    buffer_load_dwordx4 a[164:167], v1, s[4:7], s54 offen offset:2048 sc1
    buffer_load_dwordx4 a[188:191], v1, s[4:7], s54 offen offset:3072 sc1
    s_mov_b32 s36, s38
    s_mov_b32 s24, -1
    s_mov_b32 s59, 536870912
    v_mov_b32 v150, 0
    s_add_u32 s28, s36, 12288
    s_add_u32 s51, s36, 16384
    s_add_u32 s52, s36, 20480
    buffer_load_dwordx4 a[96:99], v1, s[4:7], s28 offen offset:0 sc1
    buffer_load_dwordx4 a[120:123], v1, s[4:7], s28 offen offset:1024 sc1
    buffer_load_dwordx4 a[100:103], v1, s[4:7], s28 offen offset:2048 sc1
    buffer_load_dwordx4 a[124:127], v1, s[4:7], s28 offen offset:3072 sc1
    buffer_load_dwordx4 a[104:107], v1, s[4:7], s51 offen offset:0 sc1
    buffer_load_dwordx4 a[128:131], v1, s[4:7], s51 offen offset:1024 sc1
    buffer_load_dwordx4 a[108:111], v1, s[4:7], s51 offen offset:2048 sc1
    buffer_load_dwordx4 a[132:135], v1, s[4:7], s51 offen offset:3072 sc1
    buffer_load_dwordx4 a[112:115], v1, s[4:7], s52 offen offset:0 sc1
    buffer_load_dwordx4 a[136:139], v1, s[4:7], s52 offen offset:1024 sc1
    buffer_load_dwordx4 a[116:119], v1, s[4:7], s52 offen offset:2048 sc1
    buffer_load_dwordx4 a[140:143], v1, s[4:7], s52 offen offset:3072 sc1
    s_add_u32 s36, s36, 151552
    s_add_u32 s54, s36, 32768
    s_add_u32 s53, s36, 28672
    s_add_u32 s37, s36, 24576
    s_mov_b32 s33, s35
    s_mov_b32 s31, s32
    s_add_u32 s49, s31, 3072
    s_add_u32 s50, s31, 6144
    s_waitcnt vmcnt(23)
    v_mfma_f32_16x16x32_bf16 v[184:187], a[144:147], a[0:3], 0
    v_mfma_f32_16x16x32_bf16 v[188:191], a[144:147], a[24:27], 0
    v_mfma_f32_16x16x32_bf16 v[192:195], a[144:147], a[48:51], 0
    v_mfma_f32_16x16x32_bf16 v[196:199], a[144:147], a[72:75], 0
    s_waitcnt vmcnt(22)
    v_mfma_f32_16x16x32_bf16 v[200:203], a[168:171], a[0:3], 0
    v_mfma_f32_16x16x32_bf16 v[204:207], a[168:171], a[24:27], 0
    v_mfma_f32_16x16x32_bf16 v[208:211], a[168:171], a[48:51], 0
    v_mfma_f32_16x16x32_bf16 v[212:215], a[168:171], a[72:75], 0
    s_waitcnt vmcnt(21)
    v_mfma_f32_16x16x32_bf16 v[184:187], a[148:151], a[4:7], v[184:187]
    v_mfma_f32_16x16x32_bf16 v[188:191], a[148:151], a[28:31], v[188:191]
    v_mfma_f32_16x16x32_bf16 v[192:195], a[148:151], a[52:55], v[192:195]
    v_mfma_f32_16x16x32_bf16 v[196:199], a[148:151], a[76:79], v[196:199]
    s_waitcnt vmcnt(20)
    v_mfma_f32_16x16x32_bf16 v[200:203], a[172:175], a[4:7], v[200:203]
    v_mfma_f32_16x16x32_bf16 v[204:207], a[172:175], a[28:31], v[204:207]
    v_mfma_f32_16x16x32_bf16 v[208:211], a[172:175], a[52:55], v[208:211]
    v_mfma_f32_16x16x32_bf16 v[212:215], a[172:175], a[76:79], v[212:215]
    s_waitcnt vmcnt(19)
    v_mfma_f32_16x16x32_bf16 v[184:187], a[152:155], a[8:11], v[184:187]
    v_mfma_f32_16x16x32_bf16 v[188:191], a[152:155], a[32:35], v[188:191]
    v_mfma_f32_16x16x32_bf16 v[192:195], a[152:155], a[56:59], v[192:195]
    v_mfma_f32_16x16x32_bf16 v[196:199], a[152:155], a[80:83], v[196:199]
    s_waitcnt vmcnt(18)
    v_mfma_f32_16x16x32_bf16 v[200:203], a[176:179], a[8:11], v[200:203]
    v_mfma_f32_16x16x32_bf16 v[204:207], a[176:179], a[32:35], v[204:207]
    v_mfma_f32_16x16x32_bf16 v[208:211], a[176:179], a[56:59], v[208:211]
    v_mfma_f32_16x16x32_bf16 v[212:215], a[176:179], a[80:83], v[212:215]
    s_waitcnt vmcnt(17)
    v_mfma_f32_16x16x32_bf16 v[184:187], a[156:159], a[12:15], v[184:187]
    v_mfma_f32_16x16x32_bf16 v[188:191], a[156:159], a[36:39], v[188:191]
    v_mfma_f32_16x16x32_bf16 v[192:195], a[156:159], a[60:63], v[192:195]
    v_mfma_f32_16x16x32_bf16 v[196:199], a[156:159], a[84:87], v[196:199]
    s_waitcnt vmcnt(16)
    v_mfma_f32_16x16x32_bf16 v[200:203], a[180:183], a[12:15], v[200:203]
    v_mfma_f32_16x16x32_bf16 v[204:207], a[180:183], a[36:39], v[204:207]
    v_mfma_f32_16x16x32_bf16 v[208:211], a[180:183], a[60:63], v[208:211]
    v_mfma_f32_16x16x32_bf16 v[212:215], a[180:183], a[84:87], v[212:215]
    s_waitcnt vmcnt(15)
    v_mfma_f32_16x16x32_bf16 v[184:187], a[160:163], a[16:19], v[184:187]
    v_mfma_f32_16x16x32_bf16 v[188:191], a[160:163], a[40:43], v[188:191]
    v_mfma_f32_16x16x32_bf16 v[192:195], a[160:163], a[64:67], v[192:195]
    v_mfma_f32_16x16x32_bf16 v[196:199], a[160:163], a[88:91], v[196:199]
    s_waitcnt vmcnt(14)
    v_mfma_f32_16x16x32_bf16 v[200:203], a[184:187], a[16:19], v[200:203]
    v_mfma_f32_16x16x32_bf16 v[204:207], a[184:187], a[40:43], v[204:207]
    v_mfma_f32_16x16x32_bf16 v[208:211], a[184:187], a[64:67], v[208:211]
    v_mfma_f32_16x16x32_bf16 v[212:215], a[184:187], a[88:91], v[212:215]
    s_waitcnt vmcnt(13)
    v_mfma_f32_16x16x32_bf16 v[184:187], a[164:167], a[20:23], v[184:187]
    v_mfma_f32_16x16x32_bf16 v[188:191], a[164:167], a[44:47], v[188:191]
    v_mfma_f32_16x16x32_bf16 v[192:195], a[164:167], a[68:71], v[192:195]
    v_mfma_f32_16x16x32_bf16 v[196:199], a[164:167], a[92:95], v[196:199]
    s_waitcnt vmcnt(12)
    v_mfma_f32_16x16x32_bf16 v[200:203], a[188:191], a[20:23], v[200:203]
    v_mfma_f32_16x16x32_bf16 v[204:207], a[188:191], a[44:47], v[204:207]
    v_mfma_f32_16x16x32_bf16 v[208:211], a[188:191], a[68:71], v[208:211]
    v_mfma_f32_16x16x32_bf16 v[212:215], a[188:191], a[92:95], v[212:215]
    s_mov_b32 s24, 0
    s_nop 5
    v_cvt_pk_bf16_f32 v152, v184, v185
    v_cvt_pk_bf16_f32 v153, v186, v187
    v_cvt_pk_bf16_f32 v154, v200, v201
    v_cvt_pk_bf16_f32 v155, v202, v203
    v_cvt_pk_bf16_f32 v156, v188, v189
    v_cvt_pk_bf16_f32 v157, v190, v191
    v_cvt_pk_bf16_f32 v158, v204, v205
    v_cvt_pk_bf16_f32 v159, v206, v207
    v_cvt_pk_bf16_f32 v160, v192, v193
    v_cvt_pk_bf16_f32 v161, v194, v195
    v_cvt_pk_bf16_f32 v162, v208, v209
    v_cvt_pk_bf16_f32 v163, v210, v211
    v_cvt_pk_bf16_f32 v164, v196, v197
    v_cvt_pk_bf16_f32 v165, v198, v199
    v_cvt_pk_bf16_f32 v166, v212, v213
    v_cvt_pk_bf16_f32 v167, v214, v215
L_s2_top_0:
    s_cmp_lg_u32 s22, 0
    s_cbranch_scc1 L_gate_22
    buffer_load_dword v16, v10, s[4:7], s46 offen sc1
    s_sleep 1
    buffer_load_dword v17, v10, s[4:7], s46 offen sc1
    s_sleep 1
    buffer_load_dword v18, v10, s[4:7], s46 offen sc1
    s_sleep 1
    buffer_load_dword v19, v10, s[4:7], s46 offen sc1
L_dp_23:
    s_waitcnt vmcnt(3)
    v_cmp_ge_i32 vcc, s24, v16
    s_cbranch_vccz L_dpok_24
    buffer_load_dword v16, v10, s[4:7], s46 offen sc1
    s_waitcnt vmcnt(3)
    v_cmp_ge_i32 vcc, s24, v17
    s_cbranch_vccz L_dpok_24
    buffer_load_dword v17, v10, s[4:7], s46 offen sc1
    s_waitcnt vmcnt(3)
    v_cmp_ge_i32 vcc, s24, v18
    s_cbranch_vccz L_dpok_24
    buffer_load_dword v18, v10, s[4:7], s46 offen sc1
    s_waitcnt vmcnt(3)
    v_cmp_ge_i32 vcc, s24, v19
    s_cbranch_vccz L_dpok_24
    buffer_load_dword v19, v10, s[4:7], s46 offen sc1
    s_sub_u32 s23, s23, 1
    s_movk_i32 s29, 5
    s_cbranch_scc1 L_fail
    s_branch L_dp_23
L_dpok_24:
L_gate_22:
    s_barrier
L_s2_att_0:
    buffer_load_dwordx4 v[32:35], v1, s[4:7], s31 offen offset:0 sc1
    v_mov_b32 v100, 0
    v_mov_b32 v101, 0
    v_mov_b32 v102, 0
    v_mov_b32 v103, 0
    buffer_load_dwordx4 v[36:39], v1, s[4:7], s31 offen offset:1024 sc1
    v_mov_b32 v104, 0
    v_mov_b32 v105, 0
    v_mov_b32 v106, 0
    v_mov_b32 v107, 0
    buffer_load_dwordx4 v[40:43], v1, s[4:7], s31 offen offset:2048 sc1
    v_mov_b32 v108, 0
    v_mov_b32 v109, 0
    v_mov_b32 v110, 0
    v_mov_b32 v111, 0
    buffer_load_dwordx4 v[44:47], v1, s[4:7], s49 offen offset:0 sc1
    v_mov_b32 v112, 0
    v_mov_b32 v113, 0
    v_mov_b32 v114, 0
    v_mov_b32 v115, 0
    buffer_load_dwordx4 v[48:51], v1, s[4:7], s49 offen offset:1024 sc1
    s_add_u32 s26, s24, 1
    v_mov_b32 v98, s26
    v_mov_b32 v69, 0
    v_mov_b32 v96, 0xff7fffff
    buffer_load_dwordx4 v[52:55], v1, s[4:7], s49 offen offset:2048 sc1
    v_mov_b32 v97, 0xff7fffff
    s_waitcnt vmcnt(5)
    v_mfma_f32_16x16x32_bf16 v[76:79], a[96:99], v[32:35], 0
    v_max3_u32 v69, v32, v33, v69
    v_mfma_f32_16x16x32_bf16 v[80:83], a[100:103], v[32:35], 0
    v_max3_u32 v69, v34, v35, v69
    v_mfma_f32_16x16x32_bf16 v[84:87], a[120:123], v[32:35], 0
    buffer_load_dwordx4 v[56:59], v1, s[4:7], s50 offen offset:0 sc1
    v_mfma_f32_16x16x32_bf16 v[88:91], a[124:127], v[32:35], 0
    s_waitcnt vmcnt(5)
    v_mfma_f32_16x16x32_bf16 v[76:79], a[104:107], v[36:39], v[76:79]
    v_max3_u32 v69, v36, v37, v69
    v_mfma_f32_16x16x32_bf16 v[80:83], a[108:111], v[36:39], v[80:83]
    v_max3_u32 v69, v38, v39, v69
    v_mfma_f32_16x16x32_bf16 v[84:87], a[128:131], v[36:39], v[84:87]
    buffer_load_dwordx4 v[60:63], v1, s[4:7], s50 offen offset:1024 sc1
    v_mfma_f32_16x16x32_bf16 v[88:91], a[132:135], v[36:39], v[88:91]
    s_waitcnt vmcnt(5)
    v_mfma_f32_16x16x32_bf16 v[76:79], a[112:115], v[40:43], v[76:79]
    v_max3_u32 v69, v40, v41, v69
    v_mfma_f32_16x16x32_bf16 v[80:83], a[116:119], v[40:43], v[80:83]
    v_max3_u32 v69, v42, v43, v69
    v_mfma_f32_16x16x32_bf16 v[84:87], a[136:139], v[40:43], v[84:87]
    buffer_load_dwordx4 v[64:67], v1, s[4:7], s50 offen offset:2048 sc1
    v_mfma_f32_16x16x32_bf16 v[88:91], a[140:143], v[40:43], v[88:91]
    v_cmp_eq_u32 vcc, -1, v69
    s_waitcnt vmcnt(5)
    s_cbranch_vccnz L_qretry_25
L_qback_26:
    s_waitcnt vmcnt(5)
    v_mfma_f32_16x16x32_bf16 v[92:95], v[44:47], v[32:35], 0
    v_max3_u32 v69, v44, v45, v69
    v_max3_u32 v69, v46, v47, v69
    s_waitcnt vmcnt(4)
    v_mfma_f32_16x16x32_bf16 v[92:95], v[48:51], v[36:39], v[92:95]
    v_max3_u32 v69, v48, v49, v69
    v_max3_u32 v69, v50, v51, v69
    v_add_f32_dpp v76, v80, v76 row_ror:8 row_mask:0xf bank_mask:0xf
    v_add_f32_dpp v77, v81, v77 row_ror:8 row_mask:0xf bank_mask:0xf
    v_add_f32_dpp v78, v82, v78 row_ror:8 row_mask:0xf bank_mask:0xf
    v_add_f32_dpp v79, v83, v79 row_ror:8 row_mask:0xf bank_mask:0xf
    s_waitcnt vmcnt(3)
    v_mfma_f32_16x16x32_bf16 v[92:95], v[52:55], v[40:43], v[92:95]
    v_max3_u32 v69, v52, v53, v69
    v_max3_u32 v69, v54, v55, v69
    v_cmp_eq_u32 vcc, -1, v69
    v_add_f32_dpp v76, v84, v88 row_ror:8 row_mask:0xf bank_mask:0xc
    v_add_f32_dpp v77, v85, v89 row_ror:8 row_mask:0xf bank_mask:0xc
    v_add_f32_dpp v78, v86, v90 row_ror:8 row_mask:0xf bank_mask:0xc
    v_add_f32_dpp v79, v87, v91 row_ror:8 row_mask:0xf bank_mask:0xc
    v_max3_f32 v16, v76, v77, v78
    v_permlane32_swap_b32 v92, v93
    v_permlane32_swap_b32 v94, v95
    s_waitcnt vmcnt(2)
    v_smfmac_f32_16x16x64_bf16 v[100:103], v[56:59], a[0:7], v3
    v_add_f32_dpp v96, v93, v92 row_ror:8 row_mask:0xf bank_mask:0x3
    v_add_f32_dpp v97, v95, v94 row_ror:8 row_mask:0xf bank_mask:0x3
    v_smfmac_f32_16x16x64_bf16 v[104:107], v[56:59], a[24:31], v3
    v_max3_f32 v16, v79, v96, v16
    v_max_f32 v16, v97, v16
    v_smfmac_f32_16x16x64_bf16 v[108:111], v[56:59], a[48:55], v3
    s_cbranch_vccnz L_s2_retry_0
    v_max_f32_dpp v16, v16, v16 row_ror:8 row_mask:0xf bank_mask:0xf
    v_mov_b32 v17, v16
    v_smfmac_f32_16x16x64_bf16 v[112:115], v[56:59], a[72:79], v3
    buffer_load_dwordx4 a[144:147], v1, s[4:7], s37 offen offset:0 sc1
    v_permlane32_swap_b32 v16, v17
    v_max_f32 v16, v16, v17
    v_mov_b32 v17, v16
    s_waitcnt vmcnt(2)
    v_smfmac_f32_16x16x64_bf16 v[100:103], v[60:63], a[8:15], v3
    v_permlane16_swap_b32 v16, v17
    v_max_f32 v16, v16, v17
    v_smfmac_f32_16x16x64_bf16 v[104:107], v[60:63], a[32:39], v3
    v_mul_f32 v16, s47, v16
    v_fma_f32 v76, v76, s47, -v16
    v_smfmac_f32_16x16x64_bf16 v[108:111], v[60:63], a[56:63], v3
    v_fma_f32 v77, v77, s47, -v16
    v_fma_f32 v78, v78, s47, -v16
    v_smfmac_f32_16x16x64_bf16 v[112:115], v[60:63], a[80:87], v3
    v_fma_f32 v79, v79, s47, -v16
    s_waitcnt vmcnt(1)
    v_smfmac_f32_16x16x64_bf16 v[100:103], v[64:67], a[16:23], v3
    v_exp_f32 v76, v76
    v_smfmac_f32_16x16x64_bf16 v[104:107], v[64:67], a[40:47], v3
    v_exp_f32 v77, v77
    v_smfmac_f32_16x16x64_bf16 v[108:111], v[64:67], a[64:71], v3
    v_exp_f32 v78, v78
    v_smfmac_f32_16x16x64_bf16 v[112:115], v[64:67], a[88:95], v3
    v_exp_f32 v79, v79
    buffer_store_dword v98, v151, s[4:7], s55 offen sc1
    v_cvt_pk_bf16_f32 v136, v76, v77
    v_cvt_pk_bf16_f32 v137, v78, v79
    v_fma_f32 v96, v96, s47, -v16
    v_mov_b32_dpp v138, v136 row_ror:8 row_mask:0xf bank_mask:0xf
    v_mov_b32_dpp v139, v137 row_ror:8 row_mask:0xf bank_mask:0xf
    v_fma_f32 v97, v97, s47, -v16
    v_exp_f32 v96, v96
    v_mfma_f32_16x16x32_bf16 v[116:119], v[152:155], v[136:139], 0
    v_exp_f32 v97, v97
    v_mfma_f32_16x16x32_bf16 v[132:135], v[70:73], v[136:139], 0
    v_cvt_pk_bf16_f32 v142, v100, v102
    v_cvt_pk_bf16_f32 v143, v101, v103
    v_mfma_f32_16x16x32_bf16 v[124:127], v[160:163], v[136:139], 0
    v_cvt_pk_bf16_f32 v140, v96, v97
    v_mov_b32 v141, v140
    v_mfma_f32_16x16x32_bf16 v[120:123], v[156:159], v[136:139], 0
    v_cvt_pk_bf16_f32 v146, v108, v110
    v_cvt_pk_bf16_f32 v147, v109, v111
    v_mfma_f32_16x16x32_bf16 v[128:131], v[164:167], v[136:139], 0
    v_permlane32_swap_b32 v140, v141
    v_cvt_pk_bf16_f32 v144, v104, v106
    v_cvt_pk_bf16_f32 v145, v105, v107
    v_mfma_f32_16x16x16_bf16 v[132:135], v[74:75], v[140:141], v[132:135]
    v_cvt_pk_bf16_f32 v148, v112, v114
    v_cvt_pk_bf16_f32 v149, v113, v115
    v_mfma_f32_16x16x16_bf16 v[116:119], v[142:143], v[140:141], v[116:119]
    buffer_store_dwordx4 v[24:27], v1, s[4:7], s59 offen sc1
    v_mfma_f32_16x16x16_bf16 v[124:127], v[146:147], v[140:141], v[124:127]
    buffer_load_dwordx4 a[168:171], v1, s[4:7], s37 offen offset:1024 sc1
    buffer_load_dwordx4 a[148:151], v1, s[4:7], s37 offen offset:2048 sc1
    v_mfma_f32_16x16x16_bf16 v[120:123], v[144:145], v[140:141], v[120:123]
    v_rcp_f32 v20, v132
    buffer_load_dwordx4 a[172:175], v1, s[4:7], s37 offen offset:3072 sc1
    v_mfma_f32_16x16x16_bf16 v[128:131], v[148:149], v[140:141], v[128:131]
    v_mov_b32_dpp v20, v20 row_ror:8 row_mask:0xf bank_mask:0xc
    v_cmp_u_f32 vcc, v116, v116
    v_mul_f32 v116, v116, v20
    v_mul_f32 v117, v117, v20
    v_mul_f32 v118, v118, v20
    v_mul_f32 v119, v119, v20
    v_mul_f32_dpp v116, v124, v20 row_ror:8 row_mask:0xf bank_mask:0xc
    v_mul_f32_dpp v117, v125, v20 row_ror:8 row_mask:0xf bank_mask:0xc
    v_mul_f32_dpp v118, v126, v20 row_ror:8 row_mask:0xf bank_mask:0xc
    v_mul_f32_dpp v119, v127, v20 row_ror:8 row_mask:0xf bank_mask:0xc
    s_cbranch_vccnz L_vslow_28
L_vback_29:
    ds_write_b128 v4, v[116:119] offset:0
    v_mul_f32 v120, v120, v20
    v_mul_f32 v121, v121, v20
    v_mul_f32 v122, v122, v20
    v_mul_f32 v123, v123, v20
    v_mul_f32_dpp v120, v128, v20 row_ror:8 row_mask:0xf bank_mask:0xc
    v_mul_f32_dpp v121, v129, v20 row_ror:8 row_mask:0xf bank_mask:0xc
    v_mul_f32_dpp v122, v130, v20 row_ror:8 row_mask:0xf bank_mask:0xc
    v_mul_f32_dpp v123, v131, v20 row_ror:8 row_mask:0xf bank_mask:0xc
    ds_write_b128 v4, v[120:123] offset:1024
    s_waitcnt lgkmcnt(0)
    s_barrier
    ds_read_b128 v[116:119], v5 offset:0
    ds_read_b128 v[120:123], v5 offset:2048
    ds_read_b128 v[124:127], v5 offset:4096
    ds_read_b128 v[128:131], v5 offset:6144
    s_waitcnt lgkmcnt(2)
    v_pk_add_f32 v[116:117], v[116:117], v[120:121]
    v_pk_add_f32 v[118:119], v[118:119], v[122:123]
    s_waitcnt lgkmcnt(0)
    v_pk_add_f32 v[124:125], v[124:125], v[128:129]
    v_pk_add_f32 v[126:127], v[126:127], v[130:131]
    v_pk_add_f32 v[116:117], v[116:117], v[124:125]
    v_pk_add_f32 v[118:119], v[118:119], v[126:127]
    v_cvt_pk_bf16_f32 v116, v116, v117
    v_cvt_pk_bf16_f32 v117, v118, v119
    buffer_store_dwordx2 v[116:117], v6, s[4:7], s33 offen sc1
L_s2_bub_0:
    v_mfma_f32_16x16x32_bf16 v[76:79], v[168:171], v[216:219], 0
    buffer_load_dwordx4 a[152:155], v1, s[4:7], s53 offen offset:0 sc1
    s_add_u32 s28, s36, 12288
    v_mfma_f32_16x16x32_bf16 v[80:83], v[168:171], v[220:223], 0
    s_add_u32 s51, s36, 16384
    s_add_u32 s52, s36, 20480
    v_mfma_f32_16x16x32_bf16 v[84:87], v[172:175], v[216:219], 0
    s_add_u32 s36, s36, 151552
    s_cmp_eq_u32 s36, s39
    v_mfma_f32_16x16x32_bf16 v[88:91], v[172:175], v[220:223], 0
    buffer_load_dwordx4 a[176:179], v1, s[4:7], s53 offen offset:1024 sc1
    s_cselect_b32 s36, s38, s36
    v_mfma_f32_16x16x32_bf16 v[116:119], v[176:179], v[216:219], 0
    s_and_b32 s26, s24, 3
    s_mul_i32 s40, s26, 12288
    v_mfma_f32_16x16x32_bf16 v[120:123], v[176:179], v[220:223], 0
    s_add_u32 s40, s40, s41
    s_add_u32 s26, s24, 1
    v_mfma_f32_16x16x32_bf16 v[124:127], v[180:183], v[216:219], 0
    buffer_load_dwordx4 a[156:159], v1, s[4:7], s53 offen offset:2048 sc1
    s_and_b32 s26, s26, 3
    v_mfma_f32_16x16x32_bf16 v[128:131], v[180:183], v[220:223], 0
    s_mul_i32 s33, s26, 163840
    s_add_u32 s33, s33, s35
    v_mfma_f32_16x16x16_bf16 v[76:79], v[228:229], v[224:225], v[76:79]
    s_mul_i32 s31, s26, 36864
    s_add_u32 s31, s31, s32
    v_mfma_f32_16x16x16_bf16 v[80:83], v[228:229], v[226:227], v[80:83]
    buffer_load_dwordx4 a[180:183], v1, s[4:7], s53 offen offset:3072 sc1
    s_add_u32 s49, s31, 3072
    v_mfma_f32_16x16x16_bf16 v[84:87], v[230:231], v[224:225], v[84:87]
    s_add_u32 s50, s31, 6144
    s_cmp_lt_i32 s24, 1
    v_mfma_f32_16x16x16_bf16 v[88:91], v[230:231], v[226:227], v[88:91]
    s_cselect_b32 s59, 536870912, s42
    s_cselect_b32 s26, 0, 327680
    v_mfma_f32_16x16x16_bf16 v[116:119], v[232:233], v[224:225], v[116:119]
    buffer_load_dwordx4 a[160:163], v1, s[4:7], s54 offen offset:0 sc1
    s_add_u32 s42, s42, s26
    v_mfma_f32_16x16x16_bf16 v[120:123], v[232:233], v[226:227], v[120:123]
    v_mfma_f32_16x16x16_bf16 v[124:127], v[234:235], v[224:225], v[124:127]
    v_mfma_f32_16x16x16_bf16 v[128:131], v[234:235], v[226:227], v[128:131]
    buffer_load_dwordx4 a[184:187], v1, s[4:7], s54 offen offset:1024 sc1
    s_waitcnt vmcnt(12)
    v_mfma_f32_16x16x32_bf16 v[184:187], a[144:147], a[0:3], 0
    v_mfma_f32_16x16x32_bf16 v[188:191], a[144:147], a[24:27], 0
    ds_write_b128 v99, v[76:79] offset:0
    v_mfma_f32_16x16x32_bf16 v[192:195], a[144:147], a[48:51], 0
    buffer_load_dwordx4 a[164:167], v1, s[4:7], s54 offen offset:2048 sc1
    v_mfma_f32_16x16x32_bf16 v[196:199], a[144:147], a[72:75], 0
    ds_write_b128 v99, v[80:83] offset:1024
    s_waitcnt vmcnt(10)
    v_mfma_f32_16x16x32_bf16 v[200:203], a[168:171], a[0:3], 0
    v_mfma_f32_16x16x32_bf16 v[204:207], a[168:171], a[24:27], 0
    buffer_load_dwordx4 a[188:191], v1, s[4:7], s54 offen offset:3072 sc1
    ds_write_b128 v99, v[84:87] offset:2048
    v_mfma_f32_16x16x32_bf16 v[208:211], a[168:171], a[48:51], 0
    v_mfma_f32_16x16x32_bf16 v[212:215], a[168:171], a[72:75], 0
    ds_write_b128 v99, v[88:91] offset:3072
    s_waitcnt vmcnt(10)
    v_mfma_f32_16x16x32_bf16 v[184:187], a[148:151], a[4:7], v[184:187]
    buffer_load_dwordx4 a[96:99], v1, s[4:7], s28 offen offset:0 sc1
    v_mfma_f32_16x16x32_bf16 v[188:191], a[148:151], a[28:31], v[188:191]
    ds_write_b128 v99, v[116:119] offset:4096
    v_mfma_f32_16x16x32_bf16 v[192:195], a[148:151], a[52:55], v[192:195]
    v_mfma_f32_16x16x32_bf16 v[196:199], a[148:151], a[76:79], v[196:199]
    buffer_load_dwordx4 a[120:123], v1, s[4:7], s28 offen offset:1024 sc1
    s_waitcnt vmcnt(11)
    v_mfma_f32_16x16x32_bf16 v[200:203], a[172:175], a[4:7], v[200:203]
    ds_write_b128 v99, v[120:123] offset:5120
    v_mfma_f32_16x16x32_bf16 v[204:207], a[172:175], a[28:31], v[204:207]
    ds_write_b128 v99, v[124:127] offset:6144
    v_mfma_f32_16x16x32_bf16 v[208:211], a[172:175], a[52:55], v[208:211]
    buffer_load_dwordx4 a[100:103], v1, s[4:7], s28 offen offset:2048 sc1
    v_mfma_f32_16x16x32_bf16 v[212:215], a[172:175], a[76:79], v[212:215]
    ds_write_b128 v99, v[128:131] offset:7168
    s_waitcnt vmcnt(10)
    v_mfma_f32_16x16x32_bf16 v[184:187], a[152:155], a[8:11], v[184:187]
    v_mfma_f32_16x16x32_bf16 v[188:191], a[152:155], a[32:35], v[188:191]
    buffer_load_dwordx4 a[124:127], v1, s[4:7], s28 offen offset:3072 sc1
    v_mfma_f32_16x16x32_bf16 v[192:195], a[152:155], a[56:59], v[192:195]
    s_waitcnt lgkmcnt(0)
    s_barrier
    v_mfma_f32_16x16x32_bf16 v[196:199], a[152:155], a[80:83], v[196:199]
    ds_read_b128 v[32:35], v11 offset:0
    s_waitcnt vmcnt(10)
    v_mfma_f32_16x16x32_bf16 v[200:203], a[176:179], a[8:11], v[200:203]
    buffer_load_dwordx4 a[104:107], v1, s[4:7], s51 offen offset:0 sc1
    ds_read_b128 v[36:39], v11 offset:8192
    v_mfma_f32_16x16x32_bf16 v[204:207], a[176:179], a[32:35], v[204:207]
    ds_read_b128 v[40:43], v11 offset:16384
    ds_read_b128 v[44:47], v11 offset:24576
    v_mfma_f32_16x16x32_bf16 v[208:211], a[176:179], a[56:59], v[208:211]
    ds_read_b128 v[48:51], v11 offset:1024
    ds_read_b128 v[52:55], v11 offset:9216
    v_mfma_f32_16x16x32_bf16 v[212:215], a[176:179], a[80:83], v[212:215]
    buffer_load_dwordx4 a[128:131], v1, s[4:7], s51 offen offset:1024 sc1
    s_waitcnt vmcnt(11)
    v_mfma_f32_16x16x32_bf16 v[184:187], a[156:159], a[12:15], v[184:187]
    ds_read_b128 v[56:59], v11 offset:17408
    ds_read_b128 v[60:63], v11 offset:25600
    v_mfma_f32_16x16x32_bf16 v[188:191], a[156:159], a[36:39], v[188:191]
    v_mfma_f32_16x16x32_bf16 v[192:195], a[156:159], a[60:63], v[192:195]
    buffer_load_dwordx4 a[108:111], v1, s[4:7], s51 offen offset:2048 sc1
    v_mfma_f32_16x16x32_bf16 v[196:199], a[156:159], a[84:87], v[196:199]
    s_waitcnt vmcnt(11)
    v_mfma_f32_16x16x32_bf16 v[200:203], a[180:183], a[12:15], v[200:203]
    s_waitcnt lgkmcnt(0)
    v_add_f32 v32, v32, v36
    v_mfma_f32_16x16x32_bf16 v[204:207], a[180:183], a[36:39], v[204:207]
    buffer_load_dwordx4 a[132:135], v1, s[4:7], s51 offen offset:3072 sc1
    v_add_f32 v33, v33, v37
    v_mfma_f32_16x16x32_bf16 v[208:211], a[180:183], a[60:63], v[208:211]
    v_add_f32 v34, v34, v38
    v_add_f32 v35, v35, v39
    v_mfma_f32_16x16x32_bf16 v[212:215], a[180:183], a[84:87], v[212:215]
    v_add_f32 v40, v40, v44
    s_waitcnt vmcnt(11)
    v_mfma_f32_16x16x32_bf16 v[184:187], a[160:163], a[16:19], v[184:187]
    buffer_load_dwordx4 v[216:219], v1, s[4:7], s40 offen offset:0 sc1
    v_add_f32 v41, v41, v45
    v_mfma_f32_16x16x32_bf16 v[188:191], a[160:163], a[40:43], v[188:191]
    v_add_f32 v42, v42, v46
    v_add_f32 v43, v43, v47
    v_mfma_f32_16x16x32_bf16 v[192:195], a[160:163], a[64:67], v[192:195]
    v_add_f32 v32, v32, v40
    v_add_f32 v33, v33, v41
    v_mfma_f32_16x16x32_bf16 v[196:199], a[160:163], a[88:91], v[196:199]
    buffer_load_dwordx4 v[220:223], v1, s[4:7], s40 offen offset:1024 sc1
    s_waitcnt vmcnt(12)
    v_mfma_f32_16x16x32_bf16 v[200:203], a[184:187], a[16:19], v[200:203]
    v_add_f32 v34, v34, v42
    v_add_f32 v35, v35, v43
    v_mfma_f32_16x16x32_bf16 v[204:207], a[184:187], a[40:43], v[204:207]
    v_cvt_pk_bf16_f32 v24, v32, v33
    v_cvt_pk_bf16_f32 v25, v34, v35
    v_mfma_f32_16x16x32_bf16 v[208:211], a[184:187], a[64:67], v[208:211]
    buffer_load_dwordx4 v[224:227], v1, s[4:7], s40 offen offset:2048 sc1
    v_add_f32 v48, v48, v52
    v_mfma_f32_16x16x32_bf16 v[212:215], a[184:187], a[88:91], v[212:215]
    v_add_f32 v49, v49, v53
    s_waitcnt vmcnt(12)
    v_mfma_f32_16x16x32_bf16 v[184:187], a[164:167], a[20:23], v[184:187]
    v_add_f32 v50, v50, v54
    v_add_f32 v51, v51, v55
    v_mfma_f32_16x16x32_bf16 v[188:191], a[164:167], a[44:47], v[188:191]
    buffer_load_dwordx4 a[112:115], v1, s[4:7], s52 offen offset:0 sc1
    v_add_f32 v56, v56, v60
    v_mfma_f32_16x16x32_bf16 v[192:195], a[164:167], a[68:71], v[192:195]
    v_add_f32 v57, v57, v61
    v_add_f32 v58, v58, v62
    v_mfma_f32_16x16x32_bf16 v[196:199], a[164:167], a[92:95], v[196:199]
    v_add_f32 v59, v59, v63
    s_waitcnt vmcnt(12)
    v_mfma_f32_16x16x32_bf16 v[200:203], a[188:191], a[20:23], v[200:203]
    buffer_load_dwordx4 a[136:139], v1, s[4:7], s52 offen offset:1024 sc1
    v_add_f32 v48, v48, v56
    v_mfma_f32_16x16x32_bf16 v[204:207], a[188:191], a[44:47], v[204:207]
    v_add_f32 v49, v49, v57
    v_add_f32 v50, v50, v58
    v_mfma_f32_16x16x32_bf16 v[208:211], a[188:191], a[68:71], v[208:211]
    v_add_f32 v51, v51, v59
    v_cvt_pk_bf16_f32 v26, v48, v49
    v_mfma_f32_16x16x32_bf16 v[212:215], a[188:191], a[92:95], v[212:215]
    buffer_load_dwordx4 a[116:119], v1, s[4:7], s52 offen offset:2048 sc1
    v_cvt_pk_bf16_f32 v27, v50, v51
    buffer_load_dwordx4 a[140:143], v1, s[4:7], s52 offen offset:3072 sc1
    s_add_u32 s54, s36, 32768
    s_add_u32 s53, s36, 28672
    s_add_u32 s37, s36, 24576
    s_nop 0
    v_cvt_pk_bf16_f32 v168, v184, v185
    v_cvt_pk_bf16_f32 v169, v186, v187
    v_cvt_pk_bf16_f32 v170, v200, v201
    v_cvt_pk_bf16_f32 v171, v202, v203
    v_cvt_pk_bf16_f32 v172, v188, v189
    v_cvt_pk_bf16_f32 v173, v190, v191
    v_cvt_pk_bf16_f32 v174, v204, v205
    v_cvt_pk_bf16_f32 v175, v206, v207
    v_cvt_pk_bf16_f32 v176, v192, v193
    v_cvt_pk_bf16_f32 v177, v194, v195
    v_cvt_pk_bf16_f32 v178, v208, v209
    v_cvt_pk_bf16_f32 v179, v210, v211
    v_cvt_pk_bf16_f32 v180, v196, v197
    v_cvt_pk_bf16_f32 v181, v198, v199
    v_cvt_pk_bf16_f32 v182, v212, v213
    v_cvt_pk_bf16_f32 v183, v214, v215
    s_waitcnt vmcnt(4)
    s_cmp_lt_i32 s24, 0
    s_cbranch_scc1 L_s2_nox_0
L_px_30:
    v_max3_u32 v69, v216, v217, v218
    v_max3_u32 v69, v219, v220, v69
    v_max3_u32 v69, v221, v222, v69
    v_max3_u32 v69, v223, v224, v69
    v_max3_u32 v69, v225, v226, v69
    v_max_u32 v69, v227, v69
    v_cmp_eq_u32 vcc, -1, v69
    s_cbranch_vccnz L_pxr_31
L_s2_nox_0:
    s_add_u32 s24, s24, 1
    s_cmp_lg_u32 s24, 63
    s_cbranch_scc1 L_s2_top_1
    s_branch L_s2_fin
L_kretry_27:
    s_nop 3
    v_mov_b32 v100, 0
    v_mov_b32 v101, 0
    v_mov_b32 v102, 0
    v_mov_b32 v103, 0
    v_mov_b32 v104, 0
    v_mov_b32 v105, 0
    v_mov_b32 v106, 0
    v_mov_b32 v107, 0
    v_mov_b32 v108, 0
    v_mov_b32 v109, 0
    v_mov_b32 v110, 0
    v_mov_b32 v111, 0
    v_mov_b32 v112, 0
    v_mov_b32 v113, 0
    v_mov_b32 v114, 0
    v_mov_b32 v115, 0
    v_mov_b32 v96, 0xff7fffff
    v_mov_b32 v97, 0xff7fffff
L_qretry_25:
    s_sub_u32 s23, s23, 1
    s_movk_i32 s29, 6
    s_cbranch_scc1 L_fail
    buffer_load_dwordx4 v[32:35], v1, s[4:7], s31 offen offset:0 sc1
    buffer_load_dwordx4 v[36:39], v1, s[4:7], s31 offen offset:1024 sc1
    buffer_load_dwordx4 v[40:43], v1, s[4:7], s31 offen offset:2048 sc1
    buffer_load_dwordx4 v[44:47], v1, s[4:7], s49 offen offset:0 sc1
    buffer_load_dwordx4 v[48:51], v1, s[4:7], s49 offen offset:1024 sc1
    buffer_load_dwordx4 v[52:55], v1, s[4:7], s49 offen offset:2048 sc1
    v_mov_b32 v69, 0
    s_waitcnt vmcnt(5)
    v_mfma_f32_16x16x32_bf16 v[76:79], a[96:99], v[32:35], 0
    v_max3_u32 v69, v32, v33, v69
    v_mfma_f32_16x16x32_bf16 v[80:83], a[100:103], v[32:35], 0
    v_max3_u32 v69, v34, v35, v69
    v_mfma_f32_16x16x32_bf16 v[84:87], a[120:123], v[32:35], 0
    v_mfma_f32_16x16x32_bf16 v[88:91], a[124:127], v[32:35], 0
    s_waitcnt vmcnt(4)
    v_mfma_f32_16x16x32_bf16 v[76:79], a[104:107], v[36:39], v[76:79]
    v_max3_u32 v69, v36, v37, v69
    v_mfma_f32_16x16x32_bf16 v[80:83], a[108:111], v[36:39], v[80:83]
    v_max3_u32 v69, v38, v39, v69
    v_mfma_f32_16x16x32_bf16 v[84:87], a[128:131], v[36:39], v[84:87]
    v_mfma_f32_16x16x32_bf16 v[88:91], a[132:135], v[36:39], v[88:91]
    s_waitcnt vmcnt(3)
    v_mfma_f32_16x16x32_bf16 v[76:79], a[112:115], v[40:43], v[76:79]
    v_max3_u32 v69, v40, v41, v69
    v_mfma_f32_16x16x32_bf16 v[80:83], a[116:119], v[40:43], v[80:83]
    v_max3_u32 v69, v42, v43, v69
    v_mfma_f32_16x16x32_bf16 v[84:87], a[136:139], v[40:43], v[84:87]
    v_mfma_f32_16x16x32_bf16 v[88:91], a[140:143], v[40:43], v[88:91]
    v_cmp_eq_u32 vcc, -1, v69
    s_waitcnt vmcnt(0)
    s_cbranch_vccnz L_qretry_25
    s_branch L_qback_26
L_vslow_28:
    v_mov_b32 v69, 0
    v_max3_u32 v69, v56, v57, v69
    v_max3_u32 v69, v58, v59, v69
    v_max3_u32 v69, v60, v61, v69
    v_max3_u32 v69, v62, v63, v69
    v_max3_u32 v69, v64, v65, v69
    v_max3_u32 v69, v66, v67, v69
    v_cmp_eq_u32 vcc, -1, v69
    s_cbranch_vccz L_vback_29
L_s2_retry_0:
    s_sub_u32 s23, s23, 1
    s_movk_i32 s29, 6
    s_cbranch_scc1 L_fail
    s_branch L_s2_att_0
L_pxr_31:
    s_sub_u32 s23, s23, 1
    s_movk_i32 s29, 7
    s_cbranch_scc1 L_fail
    buffer_load_dwordx4 v[216:219], v1, s[4:7], s40 offen offset:0 sc1
    buffer_load_dwordx4 v[220:223], v1, s[4:7], s40 offen offset:1024 sc1
    buffer_load_dwordx4 v[224:227], v1, s[4:7], s40 offen offset:2048 sc1
    s_waitcnt vmcnt(0)
    s_branch L_px_30
L_s2_top_1:
    s_cmp_lg_u32 s22, 0
    s_cbranch_scc1 L_gate_32
    buffer_load_dword v16, v10, s[4:7], s46 offen sc1
    s_sleep 1
    buffer_load_dword v17, v10, s[4:7], s46 offen sc1
    s_sleep 1
    buffer_load_dword v18, v10, s[4:7], s46 offen sc1
    s_sleep 1
    buffer_load_dword v19, v10, s[4:7], s46 offen sc1
L_dp_33:
    s_waitcnt vmcnt(3)
    v_cmp_ge_i32 vcc, s24, v16
    s_cbranch_vccz L_dpok_34
    buffer_load_dword v16, v10, s[4:7], s46 offen sc1
    s_waitcnt vmcnt(3)
    v_cmp_ge_i32 vcc, s24, v17
    s_cbranch_vccz L_dpok_34
    buffer_load_dword v17, v10, s[4:7], s46 offen sc1
    s_waitcnt vmcnt(3)
    v_cmp_ge_i32 vcc, s24, v18
    s_cbranch_vccz L_dpok_34
    buffer_load_dword v18, v10, s[4:7], s46 offen sc1
    s_waitcnt vmcnt(3)
    v_cmp_ge_i32 vcc, s24, v19
    s_cbranch_vccz L_dpok_34
    buffer_load_dword v19, v10, s[4:7], s46 offen sc1
    s_sub_u32 s23, s23, 1
    s_movk_i32 s29, 5
    s_cbranch_scc1 L_fail
    s_branch L_dp_33
L_dpok_34:
L_gate_32:
    s_barrier
L_s2_att_1:
    buffer_load_dwordx4 v[32:35], v1, s[4:7], s31 offen offset:0 sc1
    v_mov_b32 v100, 0
    v_mov_b32 v101, 0
    v_mov_b32 v102, 0
    v_mov_b32 v103, 0
    buffer_load_dwordx4 v[36:39], v1, s[4:7], s31 offen offset:1024 sc1
    v_mov_b32 v104, 0
    v_mov_b32 v105, 0
    v_mov_b32 v106, 0
    v_mov_b32 v107, 0
    buffer_load_dwordx4 v[40:43], v1, s[4:7], s31 offen offset:2048 sc1
    v_mov_b32 v108, 0
    v_mov_b32 v109, 0
    v_mov_b32 v110, 0
    v_mov_b32 v111, 0
    buffer_load_dwordx4 v[44:47], v1, s[4:7], s49 offen offset:0 sc1
    v_mov_b32 v112, 0
    v_mov_b32 v113, 0
    v_mov_b32 v114, 0
    v_mov_b32 v115, 0
    buffer_load_dwordx4 v[48:51], v1, s[4:7], s49 offen offset:1024 sc1
    s_add_u32 s26, s24, 1
    v_mov_b32 v98, s26
    v_mov_b32 v69, 0
    v_mov_b32 v96, 0xff7fffff
    buffer_load_dwordx4 v[52:55], v1, s[4:7], s49 offen offset:2048 sc1
    v_mov_b32 v97, 0xff7fffff
    s_waitcnt vmcnt(5)
    v_mfma_f32_16x16x32_bf16 v[76:79], a[96:99], v[32:35], 0
    v_max3_u32 v69, v32, v33, v69
    v_mfma_f32_16x16x32_bf16 v[80:83], a[100:103], v[32:35], 0
    v_max3_u32 v69, v34, v35, v69
    v_mfma_f32_16x16x32_bf16 v[84:87], a[120:123], v[32:35], 0
    buffer_load_dwordx4 v[56:59], v1, s[4:7], s50 offen offset:0 sc1
    v_mfma_f32_16x16x32_bf16 v[88:91], a[124:127], v[32:35], 0
    s_waitcnt vmcnt(5)
    v_mfma_f32_16x16x32_bf16 v[76:79], a[104:107], v[36:39], v[76:79]
    v_max3_u32 v69, v36, v37, v69
    v_mfma_f32_16x16x32_bf16 v[80:83], a[108:111], v[36:39], v[80:83]
    v_max3_u32 v69, v38, v39, v69
    v_mfma_f32_16x16x32_bf16 v[84:87], a[128:131], v[36:39], v[84:87]
    buffer_load_dwordx4 v[60:63], v1, s[4:7], s50 offen offset:1024 sc1
    v_mfma_f32_16x16x32_bf16 v[88:91], a[132:135], v[36:39], v[88:91]
    s_waitcnt vmcnt(5)
    v_mfma_f32_16x16x32_bf16 v[76:79], a[112:115], v[40:43], v[76:79]
    v_max3_u32 v69, v40, v41, v69
    v_mfma_f32_16x16x32_bf16 v[80:83], a[116:119], v[40:43], v[80:83]
    v_max3_u32 v69, v42, v43, v69
    v_mfma_f32_16x16x32_bf16 v[84:87], a[136:139], v[40:43], v[84:87]
    buffer_load_dwordx4 v[64:67], v1, s[4:7], s50 offen offset:2048 sc1
    v_mfma_f32_16x16x32_bf16 v[88:91], a[140:143], v[40:43], v[88:91]
    v_cmp_eq_u32 vcc, -1, v69
    s_waitcnt vmcnt(5)
    s_cbranch_vccnz L_qretry_35
L_qback_36:
    s_waitcnt vmcnt(5)
    v_mfma_f32_16x16x32_bf16 v[92:95], v[44:47], v[32:35], 0
    v_max3_u32 v69, v44, v45, v69
    v_max3_u32 v69, v46, v47, v69
    s_waitcnt vmcnt(4)
    v_mfma_f32_16x16x32_bf16 v[92:95], v[48:51], v[36:39], v[92:95]
    v_max3_u32 v69, v48, v49, v69
    v_max3_u32 v69, v50, v51, v69
    v_add_f32_dpp v76, v80, v76 row_ror:8 row_mask:0xf bank_mask:0xf
    v_add_f32_dpp v77, v81, v77 row_ror:8 row_mask:0xf bank_mask:0xf
    v_add_f32_dpp v78, v82, v78 row_ror:8 row_mask:0xf bank_mask:0xf
    v_add_f32_dpp v79, v83, v79 row_ror:8 row_mask:0xf bank_mask:0xf
    s_waitcnt vmcnt(3)
    v_mfma_f32_16x16x32_bf16 v[92:95], v[52:55], v[40:43], v[92:95]
    v_max3_u32 v69, v52, v53, v69
    v_max3_u32 v69, v54, v55, v69
    v_cmp_eq_u32 vcc, -1, v69
    v_add_f32_dpp v76, v84, v88 row_ror:8 row_mask:0xf bank_mask:0xc
    v_add_f32_dpp v77, v85, v89 row_ror:8 row_mask:0xf bank_mask:0xc
    v_add_f32_dpp v78, v86, v90 row_ror:8 row_mask:0xf bank_mask:0xc
    v_add_f32_dpp v79, v87, v91 row_ror:8 row_mask:0xf bank_mask:0xc
    v_max3_f32 v16, v76, v77, v78
    v_permlane32_swap_b32 v92, v93
    v_permlane32_swap_b32 v94, v95
    s_waitcnt vmcnt(2)
    v_smfmac_f32_16x16x64_bf16 v[100:103], v[56:59], a[0:7], v3
    v_add_f32_dpp v96, v93, v92 row_ror:8 row_mask:0xf bank_mask:0x3
    v_add_f32_dpp v97, v95, v94 row_ror:8 row_mask:0xf bank_mask:0x3
    v_smfmac_f32_16x16x64_bf16 v[104:107], v[56:59], a[24:31], v3
    v_max3_f32 v16, v79, v96, v16
    v_max_f32 v16, v97, v16
    v_smfmac_f32_16x16x64_bf16 v[108:111], v[56:59], a[48:55], v3
    s_cbranch_vccnz L_s2_retry_1
    v_max_f32_dpp v16, v16, v16 row_ror:8 row_mask:0xf bank_mask:0xf
    v_mov_b32 v17, v16
    v_smfmac_f32_16x16x64_bf16 v[112:115], v[56:59], a[72:79], v3
    buffer_load_dwordx4 a[144:147], v1, s[4:7], s37 offen offset:0 sc1
    v_permlane32_swap_b32 v16, v17
    v_max_f32 v16, v16, v17
    v_mov_b32 v17, v16
    s_waitcnt vmcnt(2)
    v_smfmac_f32_16x16x64_bf16 v[100:103], v[60:63], a[8:15], v3
    v_permlane16_swap_b32 v16, v17
    v_max_f32 v16, v16, v17
    v_smfmac_f32_16x16x64_bf16 v[104:107], v[60:63], a[32:39], v3
    v_mul_f32 v16, s47, v16
    v_fma_f32 v76, v76, s47, -v16
    v_smfmac_f32_16x16x64_bf16 v[108:111], v[60:63], a[56:63], v3
    v_fma_f32 v77, v77, s47, -v16
    v_fma_f32 v78, v78, s47, -v16
    v_smfmac_f32_16x16x64_bf16 v[112:115], v[60:63], a[80:87], v3
    v_fma_f32 v79, v79, s47, -v16
    s_waitcnt vmcnt(1)
    v_smfmac_f32_16x16x64_bf16 v[100:103], v[64:67], a[16:23], v3
    v_exp_f32 v76, v76
    v_smfmac_f32_16x16x64_bf16 v[104:107], v[64:67], a[40:47], v3
    v_exp_f32 v77, v77
    v_smfmac_f32_16x16x64_bf16 v[108:111], v[64:67], a[64:71], v3
    v_exp_f32 v78, v78
    v_smfmac_f32_16x16x64_bf16 v[112:115], v[64:67], a[88:95], v3
    v_exp_f32 v79, v79
    buffer_store_dword v98, v151, s[4:7], s55 offen sc1
    v_cvt_pk_bf16_f32 v136, v76, v77
    v_cvt_pk_bf16_f32 v137, v78, v79
    v_fma_f32 v96, v96, s47, -v16
    v_mov_b32_dpp v138, v136 row_ror:8 row_mask:0xf bank_mask:0xf
    v_mov_b32_dpp v139, v137 row_ror:8 row_mask:0xf bank_mask:0xf
    v_fma_f32 v97, v97, s47, -v16
    v_exp_f32 v96, v96
    v_mfma_f32_16x16x32_bf16 v[116:119], v[168:171], v[136:139], 0
    v_exp_f32 v97, v97
    v_mfma_f32_16x16x32_bf16 v[132:135], v[70:73], v[136:139], 0
    v_cvt_pk_bf16_f32 v228, v100, v102
    v_cvt_pk_bf16_f32 v229, v101, v103
    v_mfma_f32_16x16x32_bf16 v[124:127], v[176:179], v[136:139], 0
    v_cvt_pk_bf16_f32 v140, v96, v97
    v_mov_b32 v141, v140
    v_mfma_f32_16x16x32_bf16 v[120:123], v[172:175], v[136:139], 0
    v_cvt_pk_bf16_f32 v232, v108, v110
    v_cvt_pk_bf16_f32 v233, v109, v111
    v_mfma_f32_16x16x32_bf16 v[128:131], v[180:183], v[136:139], 0
    v_permlane32_swap_b32 v140, v141
    v_cvt_pk_bf16_f32 v230, v104, v106
    v_cvt_pk_bf16_f32 v231, v105, v107
    v_mfma_f32_16x16x16_bf16 v[132:135], v[74:75], v[140:141], v[132:135]
    v_cvt_pk_bf16_f32 v234, v112, v114
    v_cvt_pk_bf16_f32 v235, v113, v115
    v_mfma_f32_16x16x16_bf16 v[116:119], v[228:229], v[140:141], v[116:119]
    buffer_store_dwordx4 v[24:27], v1, s[4:7], s59 offen sc1
    v_mfma_f32_16x16x16_bf16 v[124:127], v[232:233], v[140:141], v[124:127]
    buffer_load_dwordx4 a[168:171], v1, s[4:7], s37 offen offset:1024 sc1
    buffer_load_dwordx4 a[148:151], v1, s[4:7], s37 offen offset:2048 sc1
    v_mfma_f32_16x16x16_bf16 v[120:123], v[230:231], v[140:141], v[120:123]
    v_rcp_f32 v20, v132
    buffer_load_dwordx4 a[172:175], v1, s[4:7], s37 offen offset:3072 sc1
    v_mfma_f32_16x16x16_bf16 v[128:131], v[234:235], v[140:141], v[128:131]
    v_mov_b32_dpp v20, v20 row_ror:8 row_mask:0xf bank_mask:0xc
    v_cmp_u_f32 vcc, v116, v116
    v_mul_f32 v116, v116, v20
    v_mul_f32 v117, v117, v20
    v_mul_f32 v118, v118, v20
    v_mul_f32 v119, v119, v20
    v_mul_f32_dpp v116, v124, v20 row_ror:8 row_mask:0xf bank_mask:0xc
    v_mul_f32_dpp v117, v125, v20 row_ror:8 row_mask:0xf bank_mask:0xc
    v_mul_f32_dpp v118, v126, v20 row_ror:8 row_mask:0xf bank_mask:0xc
    v_mul_f32_dpp v119, v127, v20 row_ror:8 row_mask:0xf bank_mask:0xc
    s_cbranch_vccnz L_vslow_38
L_vback_39:
    ds_write_b128 v4, v[116:119] offset:0
    v_mul_f32 v120, v120, v20
    v_mul_f32 v121, v121, v20
    v_mul_f32 v122, v122, v20
    v_mul_f32 v123, v123, v20
    v_mul_f32_dpp v120, v128, v20 row_ror:8 row_mask:0xf bank_mask:0xc
    v_mul_f32_dpp v121, v129, v20 row_ror:8 row_mask:0xf bank_mask:0xc
    v_mul_f32_dpp v122, v130, v20 row_ror:8 row_mask:0xf bank_mask:0xc
    v_mul_f32_dpp v123, v131, v20 row_ror:8 row_mask:0xf bank_mask:0xc
    ds_write_b128 v4, v[120:123] offset:1024
    s_waitcnt lgkmcnt(0)
    s_barrier
    ds_read_b128 v[116:119], v5 offset:0
    ds_read_b128 v[120:123], v5 offset:2048
    ds_read_b128 v[124:127], v5 offset:4096
    ds_read_b128 v[128:131], v5 offset:6144
    s_waitcnt lgkmcnt(2)
    v_pk_add_f32 v[116:117], v[116:117], v[120:121]
    v_pk_add_f32 v[118:119], v[118:119], v[122:123]
    s_waitcnt lgkmcnt(0)
    v_pk_add_f32 v[124:125], v[124:125], v[128:129]
    v_pk_add_f32 v[126:127], v[126:127], v[130:131]
    v_pk_add_f32 v[116:117], v[116:117], v[124:125]
    v_pk_add_f32 v[118:119], v[118:119], v[126:127]
    v_cvt_pk_bf16_f32 v116, v116, v117
    v_cvt_pk_bf16_f32 v117, v118, v119
    buffer_store_dwordx2 v[116:117], v6, s[4:7], s33 offen sc1
L_s2_bub_1:
    v_mfma_f32_16x16x32_bf16 v[76:79], v[152:155], v[216:219], 0
    buffer_load_dwordx4 a[152:155], v1, s[4:7], s53 offen offset:0 sc1
    s_add_u32 s28, s36, 12288
    v_mfma_f32_16x16x32_bf16 v[80:83], v[152:155], v[220:223], 0
    s_add_u32 s51, s36, 16384
    s_add_u32 s52, s36, 20480
    v_mfma_f32_16x16x32_bf16 v[84:87], v[156:159], v[216:219], 0
    s_add_u32 s36, s36, 151552
    s_cmp_eq_u32 s36, s39
    v_mfma_f32_16x16x32_bf16 v[88:91], v[156:159], v[220:223], 0
    buffer_load_dwordx4 a[176:179], v1, s[4:7], s53 offen offset:1024 sc1
    s_cselect_b32 s36, s38, s36
    v_mfma_f32_16x16x32_bf16 v[116:119], v[160:163], v[216:219], 0
    s_and_b32 s26, s24, 3
    s_mul_i32 s40, s26, 12288
    v_mfma_f32_16x16x32_bf16 v[120:123], v[160:163], v[220:223], 0
    s_add_u32 s40, s40, s41
    s_add_u32 s26, s24, 1
    v_mfma_f32_16x16x32_bf16 v[124:127], v[164:167], v[216:219], 0
    buffer_load_dwordx4 a[156:159], v1, s[4:7], s53 offen offset:2048 sc1
    s_and_b32 s26, s26, 3
    v_mfma_f32_16x16x32_bf16 v[128:131], v[164:167], v[220:223], 0
    s_mul_i32 s33, s26, 163840
    s_add_u32 s33, s33, s35
    v_mfma_f32_16x16x16_bf16 v[76:79], v[142:143], v[224:225], v[76:79]
    s_mul_i32 s31, s26, 36864
    s_add_u32 s31, s31, s32
    v_mfma_f32_16x16x16_bf16 v[80:83], v[142:143], v[226:227], v[80:83]
    buffer_load_dwordx4 a[180:183], v1, s[4:7], s53 offen offset:3072 sc1
    s_add_u32 s49, s31, 3072
    v_mfma_f32_16x16x16_bf16 v[84:87], v[144:145], v[224:225], v[84:87]
    s_add_u32 s50, s31, 6144
    s_cmp_lt_i32 s24, 1
    v_mfma_f32_16x16x16_bf16 v[88:91], v[144:145], v[226:227], v[88:91]
    s_cselect_b32 s59, 536870912, s42
    s_cselect_b32 s26, 0, 327680
    v_mfma_f32_16x16x16_bf16 v[116:119], v[146:147], v[224:225], v[116:119]
    buffer_load_dwordx4 a[160:163], v1, s[4:7], s54 offen offset:0 sc1
    s_add_u32 s42, s42, s26
    v_mfma_f32_16x16x16_bf16 v[120:123], v[146:147], v[226:227], v[120:123]
    v_mfma_f32_16x16x16_bf16 v[124:127], v[148:149], v[224:225], v[124:127]
    v_mfma_f32_16x16x16_bf16 v[128:131], v[148:149], v[226:227], v[128:131]
    buffer_load_dwordx4 a[184:187], v1, s[4:7], s54 offen offset:1024 sc1
    s_waitcnt vmcnt(12)
    v_mfma_f32_16x16x32_bf16 v[184:187], a[144:147], a[0:3], 0
    v_mfma_f32_16x16x32_bf16 v[188:191], a[144:147], a[24:27], 0
    ds_write_b128 v99, v[76:79] offset:0
    v_mfma_f32_16x16x32_bf16 v[192:195], a[144:147], a[48:51], 0
    buffer_load_dwordx4 a[164:167], v1, s[4:7], s54 offen offset:2048 sc1
    v_mfma_f32_16x16x32_bf16 v[196:199], a[144:147], a[72:75], 0
    ds_write_b128 v99, v[80:83] offset:1024
    s_waitcnt vmcnt(10)
    v_mfma_f32_16x16x32_bf16 v[200:203], a[168:171], a[0:3], 0
    v_mfma_f32_16x16x32_bf16 v[204:207], a[168:171], a[24:27], 0
    buffer_load_dwordx4 a[188:191], v1, s[4:7], s54 offen offset:3072 sc1
    ds_write_b128 v99, v[84:87] offset:2048
    v_mfma_f32_16x16x32_bf16 v[208:211], a[168:171], a[48:51], 0
    v_mfma_f32_16x16x32_bf16 v[212:215], a[168:171], a[72:75], 0
    ds_write_b128 v99, v[88:91] offset:3072
    s_waitcnt vmcnt(10)
    v_mfma_f32_16x16x32_bf16 v[184:187], a[148:151], a[4:7], v[184:187]
    buffer_load_dwordx4 a[96:99], v1, s[4:7], s28 offen offset:0 sc1
    v_mfma_f32_16x16x32_bf16 v[188:191], a[148:151], a[28:31], v[188:191]
    ds_write_b128 v99, v[116:119] offset:4096
    v_mfma_f32_16x16x32_bf16 v[192:195], a[148:151], a[52:55], v[192:195]
    v_mfma_f32_16x16x32_bf16 v[196:199], a[148:151], a[76:79], v[196:199]
    buffer_load_dwordx4 a[120:123], v1, s[4:7], s28 offen offset:1024 sc1
    s_waitcnt vmcnt(11)
    v_mfma_f32_16x16x32_bf16 v[200:203], a[172:175], a[4:7], v[200:203]
    ds_write_b128 v99, v[120:123] offset:5120
    v_mfma_f32_16x16x32_bf16 v[204:207], a[172:175], a[28:31], v[204:207]
    ds_write_b128 v99, v[124:127] offset:6144
    v_mfma_f32_16x16x32_bf16 v[208:211], a[172:175], a[52:55], v[208:211]
    buffer_load_dwordx4 a[100:103], v1, s[4:7], s28 offen offset:2048 sc1
    v_mfma_f32_16x16x32_bf16 v[212:215], a[172:175], a[76:79], v[212:215]
    ds_write_b128 v99, v[128:131] offset:7168
    s_waitcnt vmcnt(10)
    v_mfma_f32_16x16x32_bf16 v[184:187], a[152:155], a[8:11], v[184:187]
    v_mfma_f32_16x16x32_bf16 v[188:191], a[152:155], a[32:35], v[188:191]
    buffer_load_dwordx4 a[124:127], v1, s[4:7], s28 offen offset:3072 sc1
    v_mfma_f32_16x16x32_bf16 v[192:195], a[152:155], a[56:59], v[192:195]
    s_waitcnt lgkmcnt(0)
    s_barrier
    v_mfma_f32_16x16x32_bf16 v[196:199], a[152:155], a[80:83], v[196:199]
    ds_read_b128 v[32:35], v11 offset:0
    s_waitcnt vmcnt(10)
    v_mfma_f32_16x16x32_bf16 v[200:203], a[176:179], a[8:11], v[200:203]
    buffer_load_dwordx4 a[104:107], v1, s[4:7], s51 offen offset:0 sc1
    ds_read_b128 v[36:39], v11 offset:8192
    v_mfma_f32_16x16x32_bf16 v[204:207], a[176:179], a[32:35], v[204:207]
    ds_read_b128 v[40:43], v11 offset:16384
    ds_read_b128 v[44:47], v11 offset:24576
    v_mfma_f32_16x16x32_bf16 v[208:211], a[176:179], a[56:59], v[208:211]
    ds_read_b128 v[48:51], v11 offset:1024
    ds_read_b128 v[52:55], v11 offset:9216
    v_mfma_f32_16x16x32_bf16 v[212:215], a[176:179], a[80:83], v[212:215]
    buffer_load_dwordx4 a[128:131], v1, s[4:7], s51 offen offset:1024 sc1
    s_waitcnt vmcnt(11)
    v_mfma_f32_16x16x32_bf16 v[184:187], a[156:159], a[12:15], v[184:187]
    ds_read_b128 v[56:59], v11 offset:17408
    ds_read_b128 v[60:63], v11 offset:25600
    v_mfma_f32_16x16x32_bf16 v[188:191], a[156:159], a[36:39], v[188:191]
    v_mfma_f32_16x16x32_bf16 v[192:195], a[156:159], a[60:63], v[192:195]
    buffer_load_dwordx4 a[108:111], v1, s[4:7], s51 offen offset:2048 sc1
    v_mfma_f32_16x16x32_bf16 v[196:199], a[156:159], a[84:87], v[196:199]
    s_waitcnt vmcnt(11)
    v_mfma_f32_16x16x32_bf16 v[200:203], a[180:183], a[12:15], v[200:203]
    s_waitcnt lgkmcnt(0)
    v_add_f32 v32, v32, v36
    v_mfma_f32_16x16x32_bf16 v[204:207], a[180:183], a[36:39], v[204:207]
    buffer_load_dwordx4 a[132:135], v1, s[4:7], s51 offen offset:3072 sc1
    v_add_f32 v33, v33, v37
    v_mfma_f32_16x16x32_bf16 v[208:211], a[180:183], a[60:63], v[208:211]
    v_add_f32 v34, v34, v38
    v_add_f32 v35, v35, v39
    v_mfma_f32_16x16x32_bf16 v[212:215], a[180:183], a[84:87], v[212:215]
    v_add_f32 v40, v40, v44
    s_waitcnt vmcnt(11)
    v_mfma_f32_16x16x32_bf16 v[184:187], a[160:163], a[16:19], v[184:187]
    buffer_load_dwordx4 v[216:219], v1, s[4:7], s40 offen offset:0 sc1
    v_add_f32 v41, v41, v45
    v_mfma_f32_16x16x32_bf16 v[188:191], a[160:163], a[40:43], v[188:191]
    v_add_f32 v42, v42, v46
    v_add_f32 v43, v43, v47
    v_mfma_f32_16x16x32_bf16 v[192:195], a[160:163], a[64:67], v[192:195]
    v_add_f32 v32, v32, v40
    v_add_f32 v33, v33, v41
    v_mfma_f32_16x16x32_bf16 v[196:199], a[160:163], a[88:91], v[196:199]
    buffer_load_dwordx4 v[220:223], v1, s[4:7], s40 offen offset:1024 sc1
    s_waitcnt vmcnt(12)
    v_mfma_f32_16x16x32_bf16 v[200:203], a[184:187], a[16:19], v[200:203]
    v_add_f32 v34, v34, v42
    v_add_f32 v35, v35, v43
    v_mfma_f32_16x16x32_bf16 v[204:207], a[184:187], a[40:43], v[204:207]
    v_cvt_pk_bf16_f32 v24, v32, v33
    v_cvt_pk_bf16_f32 v25, v34, v35
    v_mfma_f32_16x16x32_bf16 v[208:211], a[184:187], a[64:67], v[208:211]
    buffer_load_dwordx4 v[224:227], v1, s[4:7], s40 offen offset:2048 sc1
    v_add_f32 v48, v48, v52
    v_mfma_f32_16x16x32_bf16 v[212:215], a[184:187], a[88:91], v[212:215]
    v_add_f32 v49, v49, v53
    s_waitcnt vmcnt(12)
    v_mfma_f32_16x16x32_bf16 v[184:187], a[164:167], a[20:23], v[184:187]
    v_add_f32 v50, v50, v54
    v_add_f32 v51, v51, v55
    v_mfma_f32_16x16x32_bf16 v[188:191], a[164:167], a[44:47], v[188:191]
    buffer_load_dwordx4 a[112:115], v1, s[4:7], s52 offen offset:0 sc1
    v_add_f32 v56, v56, v60
    v_mfma_f32_16x16x32_bf16 v[192:195], a[164:167], a[68:71], v[192:195]
    v_add_f32 v57, v57, v61
    v_add_f32 v58, v58, v62
    v_mfma_f32_16x16x32_bf16 v[196:199], a[164:167], a[92:95], v[196:199]
    v_add_f32 v59, v59, v63
    s_waitcnt vmcnt(12)
    v_mfma_f32_16x16x32_bf16 v[200:203], a[188:191], a[20:23], v[200:203]
    buffer_load_dwordx4 a[136:139], v1, s[4:7], s52 offen offset:1024 sc1
    v_add_f32 v48, v48, v56
    v_mfma_f32_16x16x32_bf16 v[204:207], a[188:191], a[44:47], v[204:207]
    v_add_f32 v49, v49, v57
    v_add_f32 v50, v50, v58
    v_mfma_f32_16x16x32_bf16 v[208:211], a[188:191], a[68:71], v[208:211]
    v_add_f32 v51, v51, v59
    v_cvt_pk_bf16_f32 v26, v48, v49
    v_mfma_f32_16x16x32_bf16 v[212:215], a[188:191], a[92:95], v[212:215]
    buffer_load_dwordx4 a[116:119], v1, s[4:7], s52 offen offset:2048 sc1
    v_cvt_pk_bf16_f32 v27, v50, v51
    buffer_load_dwordx4 a[140:143], v1, s[4:7], s52 offen offset:3072 sc1
    s_add_u32 s54, s36, 32768
    s_add_u32 s53, s36, 28672
    s_add_u32 s37, s36, 24576
    s_nop 0
    v_cvt_pk_bf16_f32 v152, v184, v185
    v_cvt_pk_bf16_f32 v153, v186, v187
    v_cvt_pk_bf16_f32 v154, v200, v201
    v_cvt_pk_bf16_f32 v155, v202, v203
    v_cvt_pk_bf16_f32 v156, v188, v189
    v_cvt_pk_bf16_f32 v157, v190, v191
    v_cvt_pk_bf16_f32 v158, v204, v205
    v_cvt_pk_bf16_f32 v159, v206, v207
    v_cvt_pk_bf16_f32 v160, v192, v193
    v_cvt_pk_bf16_f32 v161, v194, v195
    v_cvt_pk_bf16_f32 v162, v208, v209
    v_cvt_pk_bf16_f32 v163, v210, v211
    v_cvt_pk_bf16_f32 v164, v196, v197
    v_cvt_pk_bf16_f32 v165, v198, v199
    v_cvt_pk_bf16_f32 v166, v212, v213
    v_cvt_pk_bf16_f32 v167, v214, v215
    s_waitcnt vmcnt(4)
    s_cmp_lt_i32 s24, 0
    s_cbranch_scc1 L_s2_nox_1
L_px_40:
    v_max3_u32 v69, v216, v217, v218
    v_max3_u32 v69, v219, v220, v69
    v_max3_u32 v69, v221, v222, v69
    v_max3_u32 v69, v223, v224, v69
    v_max3_u32 v69, v225, v226, v69
    v_max_u32 v69, v227, v69
    v_cmp_eq_u32 vcc, -1, v69
    s_cbranch_vccnz L_pxr_41
L_s2_nox_1:
    s_add_u32 s24, s24, 1
    s_cmp_lg_u32 s24, 63
    s_cbranch_scc1 L_s2_top_0
    s_branch L_s2_fin
L_kretry_37:
    s_nop 3
    v_mov_b32 v100, 0
    v_mov_b32 v101, 0
    v_mov_b32 v102, 0
    v_mov_b32 v103, 0
    v_mov_b32 v104, 0
    v_mov_b32 v105, 0
    v_mov_b32 v106, 0
    v_mov_b32 v107, 0
    v_mov_b32 v108, 0
    v_mov_b32 v109, 0
    v_mov_b32 v110, 0
    v_mov_b32 v111, 0
    v_mov_b32 v112, 0
    v_mov_b32 v113, 0
    v_mov_b32 v114, 0
    v_mov_b32 v115, 0
    v_mov_b32 v96, 0xff7fffff
    v_mov_b32 v97, 0xff7fffff
L_qretry_35:
    s_sub_u32 s23, s23, 1
    s_movk_i32 s29, 6
    s_cbranch_scc1 L_fail
    buffer_load_dwordx4 v[32:35], v1, s[4:7], s31 offen offset:0 sc1
    buffer_load_dwordx4 v[36:39], v1, s[4:7], s31 offen offset:1024 sc1
    buffer_load_dwordx4 v[40:43], v1, s[4:7], s31 offen offset:2048 sc1
    buffer_load_dwordx4 v[44:47], v1, s[4:7], s49 offen offset:0 sc1
    buffer_load_dwordx4 v[48:51], v1, s[4:7], s49 offen offset:1024 sc1
    buffer_load_dwordx4 v[52:55], v1, s[4:7], s49 offen offset:2048 sc1
    v_mov_b32 v69, 0
    s_waitcnt vmcnt(5)
    v_mfma_f32_16x16x32_bf16 v[76:79], a[96:99], v[32:35], 0
    v_max3_u32 v69, v32, v33, v69
    v_mfma_f32_16x16x32_bf16 v[80:83], a[100:103], v[32:35], 0
    v_max3_u32 v69, v34, v35, v69
    v_mfma_f32_16x16x32_bf16 v[84:87], a[120:123], v[32:35], 0
    v_mfma_f32_16x16x32_bf16 v[88:91], a[124:127], v[32:35], 0
    s_waitcnt vmcnt(4)
    v_mfma_f32_16x16x32_bf16 v[76:79], a[104:107], v[36:39], v[76:79]
    v_max3_u32 v69, v36, v37, v69
    v_mfma_f32_16x16x32_bf16 v[80:83], a[108:111], v[36:39], v[80:83]
    v_max3_u32 v69, v38, v39, v69
    v_mfma_f32_16x16x32_bf16 v[84:87], a[128:131], v[36:39], v[84:87]
    v_mfma_f32_16x16x32_bf16 v[88:91], a[132:135], v[36:39], v[88:91]
    s_waitcnt vmcnt(3)
    v_mfma_f32_16x16x32_bf16 v[76:79], a[112:115], v[40:43], v[76:79]
    v_max3_u32 v69, v40, v41, v69
    v_mfma_f32_16x16x32_bf16 v[80:83], a[116:119], v[40:43], v[80:83]
    v_max3_u32 v69, v42, v43, v69
    v_mfma_f32_16x16x32_bf16 v[84:87], a[136:139], v[40:43], v[84:87]
    v_mfma_f32_16x16x32_bf16 v[88:91], a[140:143], v[40:43], v[88:91]
    v_cmp_eq_u32 vcc, -1, v69
    s_waitcnt vmcnt(0)
    s_cbranch_vccnz L_qretry_35
    s_branch L_qback_36
L_vslow_38:
    v_mov_b32 v69, 0
    v_max3_u32 v69, v56, v57, v69
    v_max3_u32 v69, v58, v59, v69
    v_max3_u32 v69, v60, v61, v69
    v_max3_u32 v69, v62, v63, v69
    v_max3_u32 v69, v64, v65, v69
    v_max3_u32 v69, v66, v67, v69
    v_cmp_eq_u32 vcc, -1, v69
    s_cbranch_vccz L_vback_39
L_s2_retry_1:
    s_sub_u32 s23, s23, 1
    s_movk_i32 s29, 6
    s_cbranch_scc1 L_fail
    s_branch L_s2_att_1
L_pxr_41:
    s_sub_u32 s23, s23, 1
    s_movk_i32 s29, 7
    s_cbranch_scc1 L_fail
    buffer_load_dwordx4 v[216:219], v1, s[4:7], s40 offen offset:0 sc1
    buffer_load_dwordx4 v[220:223], v1, s[4:7], s40 offen offset:1024 sc1
    buffer_load_dwordx4 v[224:227], v1, s[4:7], s40 offen offset:2048 sc1
    s_waitcnt vmcnt(0)
    s_branch L_px_40
L_s2_fin:
    buffer_store_dwordx4 v[24:27], v1, s[4:7], s59 offen sc1
    s_add_u32 s59, s59, 327680
    v_mov_b32 v150, 61
    buffer_store_dword v150, v8, s[4:7], s43 offen sc1
    v_mfma_f32_16x16x32_bf16 v[76:79], v[152:155], v[216:219], 0
    v_mfma_f32_16x16x32_bf16 v[80:83], v[152:155], v[220:223], 0
    v_mfma_f32_16x16x32_bf16 v[84:87], v[156:159], v[216:219], 0
    v_mfma_f32_16x16x32_bf16 v[88:91], v[156:159], v[220:223], 0
    v_mfma_f32_16x16x32_bf16 v[116:119], v[160:163], v[216:219], 0
    v_mfma_f32_16x16x32_bf16 v[120:123], v[160:163], v[220:223], 0
    v_mfma_f32_16x16x32_bf16 v[124:127], v[164:167], v[216:219], 0
    v_mfma_f32_16x16x32_bf16 v[128:131], v[164:167], v[220:223], 0
    v_mfma_f32_16x16x16_bf16 v[76:79], v[142:143], v[224:225], v[76:79]
    v_mfma_f32_16x16x16_bf16 v[80:83], v[142:143], v[226:227], v[80:83]
    v_mfma_f32_16x16x16_bf16 v[84:87], v[144:145], v[224:225], v[84:87]
    v_mfma_f32_16x16x16_bf16 v[88:91], v[144:145], v[226:227], v[88:91]
    v_mfma_f32_16x16x16_bf16 v[116:119], v[146:147], v[224:225], v[116:119]
    v_mfma_f32_16x16x16_bf16 v[120:123], v[146:147], v[226:227], v[120:123]
    v_mfma_f32_16x16x16_bf16 v[124:127], v[148:149], v[224:225], v[124:127]
    v_mfma_f32_16x16x16_bf16 v[128:131], v[148:149], v[226:227], v[128:131]
    s_barrier
    ds_write_b128 v99, v[76:79] offset:0
    ds_write_b128 v99, v[80:83] offset:1024
    ds_write_b128 v99, v[84:87] offset:2048
    ds_write_b128 v99, v[88:91] offset:3072
    ds_write_b128 v99, v[116:119] offset:4096
    ds_write_b128 v99, v[120:123] offset:5120
    ds_write_b128 v99, v[124:127] offset:6144
    ds_write_b128 v99, v[128:131] offset:7168
    s_waitcnt lgkmcnt(0)
    s_barrier
    ds_read_b128 v[32:35], v11 offset:0
    ds_read_b128 v[36:39], v11 offset:8192
    ds_read_b128 v[40:43], v11 offset:16384
    ds_read_b128 v[44:47], v11 offset:24576
    ds_read_b128 v[48:51], v11 offset:1024
    ds_read_b128 v[52:55], v11 offset:9216
    ds_read_b128 v[56:59], v11 offset:17408
    ds_read_b128 v[60:63], v11 offset:25600
    s_waitcnt lgkmcnt(0)
    v_add_f32 v32, v32, v36
    v_add_f32 v33, v33, v37
    v_add_f32 v34, v34, v38
    v_add_f32 v35, v35, v39
    v_add_f32 v40, v40, v44
    v_add_f32 v41, v41, v45
    v_add_f32 v42, v42, v46
    v_add_f32 v43, v43, v47
    v_add_f32 v32, v32, v40
    v_add_f32 v33, v33, v41
    v_add_f32 v34, v34, v42
    v_add_f32 v35, v35, v43
    v_cvt_pk_bf16_f32 v24, v32, v33
    v_cvt_pk_bf16_f32 v25, v34, v35
    v_add_f32 v48, v48, v52
    v_add_f32 v49, v49, v53
    v_add_f32 v50, v50, v54
    v_add_f32 v51, v51, v55
    v_add_f32 v56, v56, v60
    v_add_f32 v57, v57, v61
    v_add_f32 v58, v58, v62
    v_add_f32 v59, v59, v63
    v_add_f32 v48, v48, v56
    v_add_f32 v49, v49, v57
    v_add_f32 v50, v50, v58
    v_add_f32 v51, v51, v59
    v_cvt_pk_bf16_f32 v26, v48, v49
    v_cvt_pk_bf16_f32 v27, v50, v51
    buffer_store_dwordx4 v[24:27], v1, s[4:7], s59 offen sc1
    s_add_u32 s59, s59, 327680
    s_and_b32 s26, s24, 3
    s_mul_i32 s40, s26, 12288
    s_add_u32 s40, s40, s41
    v_mov_b32 v100, 0
    v_mov_b32 v101, 0
    v_mov_b32 v102, 0
    v_mov_b32 v103, 0
    v_mov_b32 v104, 0
    v_mov_b32 v105, 0
    v_mov_b32 v106, 0
    v_mov_b32 v107, 0
    v_mov_b32 v108, 0
    v_mov_b32 v109, 0
    v_mov_b32 v110, 0
    v_mov_b32 v111, 0
    v_mov_b32 v112, 0
    v_mov_b32 v113, 0
    v_mov_b32 v114, 0
    v_mov_b32 v115, 0
L_sp_42:
    buffer_load_dwordx4 v[56:59], v1, s[4:7], s50 offen offset:0 sc1
    buffer_load_dwordx4 v[60:63], v1, s[4:7], s50 offen offset:1024 sc1
    buffer_load_dwordx4 v[64:67], v1, s[4:7], s50 offen offset:2048 sc1
    s_sub_u32 s23, s23, 1
    s_movk_i32 s29, 6
    s_cbranch_scc1 L_fail
    s_waitcnt vmcnt(0)
    v_max3_u32 v69, v56, v57, v58
    v_max3_u32 v69, v59, v60, v69
    v_max3_u32 v69, v61, v62, v69
    v_max3_u32 v69, v63, v64, v69
    v_max3_u32 v69, v65, v66, v69
    v_max_u32 v69, v67, v69
    v_cmp_eq_u32 vcc, -1, v69
    s_cbranch_vccnz L_sp_42
    v_mov_b32 v150, 63
    buffer_store_dword v150, v8, s[4:7], s43 offen sc1
    v_smfmac_f32_16x16x64_bf16 v[100:103], v[56:59], a[0:7], v3
    v_smfmac_f32_16x16x64_bf16 v[104:107], v[56:59], a[24:31], v3
    v_smfmac_f32_16x16x64_bf16 v[108:111], v[56:59], a[48:55], v3
    v_smfmac_f32_16x16x64_bf16 v[112:115], v[56:59], a[72:79], v3
    v_smfmac_f32_16x16x64_bf16 v[100:103], v[60:63], a[8:15], v3
    v_smfmac_f32_16x16x64_bf16 v[104:107], v[60:63], a[32:39], v3
    v_smfmac_f32_16x16x64_bf16 v[108:111], v[60:63], a[56:63], v3
    v_smfmac_f32_16x16x64_bf16 v[112:115], v[60:63], a[80:87], v3
    v_smfmac_f32_16x16x64_bf16 v[100:103], v[64:67], a[16:23], v3
    v_smfmac_f32_16x16x64_bf16 v[104:107], v[64:67], a[40:47], v3
    v_smfmac_f32_16x16x64_bf16 v[108:111], v[64:67], a[64:71], v3
    v_smfmac_f32_16x16x64_bf16 v[112:115], v[64:67], a[88:95], v3
    s_nop 7
    v_cvt_pk_bf16_f32 v228, v100, v102
    v_cvt_pk_bf16_f32 v229, v101, v103
    v_cvt_pk_bf16_f32 v230, v104, v106
    v_cvt_pk_bf16_f32 v231, v105, v107
    v_cvt_pk_bf16_f32 v232, v108, v110
    v_cvt_pk_bf16_f32 v233, v109, v111
    v_cvt_pk_bf16_f32 v234, v112, v114
    v_cvt_pk_bf16_f32 v235, v113, v115
L_sp_43:
    buffer_load_dwordx4 v[216:219], v1, s[4:7], s40 offen offset:0 sc1
    buffer_load_dwordx4 v[220:223], v1, s[4:7], s40 offen offset:1024 sc1
    buffer_load_dwordx4 v[224:227], v1, s[4:7], s40 offen offset:2048 sc1
    s_sub_u32 s23, s23, 1
    s_movk_i32 s29, 7
    s_cbranch_scc1 L_fail
    s_waitcnt vmcnt(0)
    v_max3_u32 v69, v216, v217, v218
    v_max3_u32 v69, v219, v220, v69
    v_max3_u32 v69, v221, v222, v69
    v_max3_u32 v69, v223, v224, v69
    v_max3_u32 v69, v225, v226, v69
    v_max_u32 v69, v227, v69
    v_cmp_eq_u32 vcc, -1, v69
    s_cbranch_vccnz L_sp_43
    v_mfma_f32_16x16x32_bf16 v[76:79], v[168:171], v[216:219], 0
    v_mfma_f32_16x16x32_bf16 v[80:83], v[168:171], v[220:223], 0
    v_mfma_f32_16x16x32_bf16 v[84:87], v[172:175], v[216:219], 0
    v_mfma_f32_16x16x32_bf16 v[88:91], v[172:175], v[220:223], 0
    v_mfma_f32_16x16x32_bf16 v[116:119], v[176:179], v[216:219], 0
    v_mfma_f32_16x16x32_bf16 v[120:123], v[176:179], v[220:223], 0
    v_mfma_f32_16x16x32_bf16 v[124:127], v[180:183], v[216:219], 0
    v_mfma_f32_16x16x32_bf16 v[128:131], v[180:183], v[220:223], 0
    v_mfma_f32_16x16x16_bf16 v[76:79], v[228:229], v[224:225], v[76:79]
    v_mfma_f32_16x16x16_bf16 v[80:83], v[228:229], v[226:227], v[80:83]
    v_mfma_f32_16x16x16_bf16 v[84:87], v[230:231], v[224:225], v[84:87]
    v_mfma_f32_16x16x16_bf16 v[88:91], v[230:231], v[226:227], v[88:91]
    v_mfma_f32_16x16x16_bf16 v[116:119], v[232:233], v[224:225], v[116:119]
    v_mfma_f32_16x16x16_bf16 v[120:123], v[232:233], v[226:227], v[120:123]
    v_mfma_f32_16x16x16_bf16 v[124:127], v[234:235], v[224:225], v[124:127]
    v_mfma_f32_16x16x16_bf16 v[128:131], v[234:235], v[226:227], v[128:131]
    s_barrier
    ds_write_b128 v99, v[76:79] offset:0
    ds_write_b128 v99, v[80:83] offset:1024
    ds_write_b128 v99, v[84:87] offset:2048
    ds_write_b128 v99, v[88:91] offset:3072
    ds_write_b128 v99, v[116:119] offset:4096
    ds_write_b128 v99, v[120:123] offset:5120
    ds_write_b128 v99, v[124:127] offset:6144
    ds_write_b128 v99, v[128:131] offset:7168
    s_waitcnt lgkmcnt(0)
    s_barrier
    ds_read_b128 v[32:35], v11 offset:0
    ds_read_b128 v[36:39], v11 offset:8192
    ds_read_b128 v[40:43], v11 offset:16384
    ds_read_b128 v[44:47], v11 offset:24576
    ds_read_b128 v[48:51], v11 offset:1024
    ds_read_b128 v[52:55], v11 offset:9216
    ds_read_b128 v[56:59], v11 offset:17408
    ds_read_b128 v[60:63], v11 offset:25600
    s_waitcnt lgkmcnt(0)
    v_add_f32 v32, v32, v36
    v_add_f32 v33, v33, v37
    v_add_f32 v34, v34, v38
    v_add_f32 v35, v35, v39
    v_add_f32 v40, v40, v44
    v_add_f32 v41, v41, v45
    v_add_f32 v42, v42, v46
    v_add_f32 v43, v43, v47
    v_add_f32 v32, v32, v40
    v_add_f32 v33, v33, v41
    v_add_f32 v34, v34, v42
    v_add_f32 v35, v35, v43
    v_cvt_pk_bf16_f32 v24, v32, v33
    v_cvt_pk_bf16_f32 v25, v34, v35
    v_add_f32 v48, v48, v52
    v_add_f32 v49, v49, v53
    v_add_f32 v50, v50, v54
    v_add_f32 v51, v51, v55
    v_add_f32 v56, v56, v60
    v_add_f32 v57, v57, v61
    v_add_f32 v58, v58, v62
    v_add_f32 v59, v59, v63
    v_add_f32 v48, v48, v56
    v_add_f32 v49, v49, v57
    v_add_f32 v50, v50, v58
    v_add_f32 v51, v51, v59
    v_cvt_pk_bf16_f32 v26, v48, v49
    v_cvt_pk_bf16_f32 v27, v50, v51
    buffer_store_dwordx4 v[24:27], v1, s[4:7], s59 offen sc1
    s_add_u32 s59, s59, 327680
    s_waitcnt vmcnt(0)
    v_mov_b32 v150, 64
    buffer_store_dword v150, v8, s[4:7], s43 offen sc1
    s_branch L_end
L_xs:
    s_setprio 3
    s_sub_u32 s30, s21, 28
    s_lshl_b32 s30, s30, 1
    s_lshr_b32 s26, s22, 1
    s_add_u32 s30, s30, s26
    s_and_b32 s66, s22, 1
    v_lshlrev_b32 v1, 4, v0
    v_lshlrev_b32 v3, 3, v0
    v_and_b32 v2, 0x37, v0
    v_lshlrev_b32 v2, 4, v2
    v_min_u32 v4, 11, v0
    v_lshlrev_b32 v4, 2, v4
    v_min_u32 v6, 17, v0
    v_lshlrev_b32 v6, 2, v6
    s_lshl_b32 s65, s20, 7
    s_add_u32 s65, s65, 2828288
    v_mov_b32 v8, -1
    v_mov_b32 v9, -1
    v_mov_b32 v10, -1
    v_mov_b32 v11, -1
    v_mov_b32 v5, 0xd04e79ff
    v_and_b32 v12, 15, v0
    s_lshl_b32 s26, s66, 4
    v_add_u32 v12, s26, v12
    v_lshrrev_b32 v13, 4, v0
    v_lshlrev_b32 v13, 2, v13
    v_add_u32 v14, 0, v13
    v_cmp_le_u32 s[48:49], v14, v12
    v_add_u32 v14, 1, v13
    v_cmp_le_u32 s[50:51], v14, v12
    v_add_u32 v14, 2, v13
    v_cmp_le_u32 s[52:53], v14, v12
    v_add_u32 v14, 3, v13
    v_cmp_le_u32 s[54:55], v14, v12
    v_add_u32 v14, 16, v13
    v_cmp_le_u32 s[56:57], v14, v12
    v_add_u32 v14, 17, v13
    v_cmp_le_u32 s[58:59], v14, v12
    v_add_u32 v14, 18, v13
    v_cmp_le_u32 s[60:61], v14, v12
    v_add_u32 v14, 19, v13
    v_cmp_le_u32 s[62:63], v14, v12
    s_mul_i32 s32, s20, 147456
    s_mul_i32 s26, s30, 9216
    s_add_u32 s32, s32, s26
    s_add_u32 s32, s32, 330752
    s_mul_i32 s34, s20, 606208
    s_mul_i32 s26, s30, 37888
    s_add_u32 s34, s34, s26
    s_add_u32 s34, s34, 2883584
    s_add_u32 s35, s34, 606208
    s_mov_b32 s33, s34
    s_mul_i32 s38, s20, 49152
    s_mul_i32 s26, s30, 3072
    s_add_u32 s38, s38, s26
    s_lshl_b32 s26, s66, 10
    s_add_u32 s38, s38, s26
    s_mul_i32 s26, s66, 1016
    s_sub_u32 s26, 2048, s26
    v_add_u32 v3, s26, v1
    s_add_u32 s38, s38, 1507328
    s_lshl_b32 s39, s20, 9
    s_mul_i32 s26, s30, 72
    s_add_u32 s39, s39, s26
    s_add_u32 s39, s39, 2818048
    s_mov_b32 s40, 0x3dd53b95
    s_mov_b32 s24, 0
    s_lshl_b32 s64, s30, 1
    s_add_u32 s64, s64, s66
    s_lshl_b32 s64, s64, 3
    s_add_u32 s64, s64, s20
    s_lshl_b32 s64, s64, 12
    s_add_u32 s64, s64, 81920
    buffer_load_dwordx4 v[140:143], v1, s[8:11], s64 offen offset:0
    buffer_load_dwordx4 v[140:143], v1, s[8:11], s64 offen offset:1024
    buffer_load_dwordx4 v[140:143], v1, s[8:11], s64 offen offset:2048
    buffer_load_dwordx4 v[140:143], v1, s[8:11], s64 offen offset:3072
    s_lshl_b32 s64, s30, 1
    s_add_u32 s64, s64, s66
    s_mul_i32 s64, s64, 5120
    s_lshl_b32 s93, s20, 1
    s_add_u32 s93, s93, 16
    s_add_u32 s94, s93, 1
L_loc_44:
    v_lshlrev_b32 v12, 2, v0
    buffer_load_dword v13, v12, s[16:19], 0 offen sc1
    s_sub_u32 s23, s23, 1
    s_movk_i32 s29, 1
    s_cbranch_scc1 L_fail
L_loc1_45:
    s_waitcnt vmcnt(0)
    v_readlane_b32 s26, v13, s93
    v_readlane_b32 s27, v13, s94
    v_readlane_b32 s29, v13, 56
    s_lshr_b32 s28, s27, 24
    s_min_u32 s28, s28, s29
    s_cmp_lt_u32 s28, 32
    s_cbranch_scc1 L_loc_44
    s_and_b32 s27, s27, 0xffffff
    s_mul_i32 s28, s25, 6
    s_lshl_b64 s[28:29], 32, s28
    s_cmp_eq_u64 s[26:27], s[28:29]
    s_cbranch_scc0 L_xs_glb
    s_cmp_lt_u32 s25, 8
    s_cbranch_scc0 L_xs_glb
    s_branch L_xs_loc
L_xs_loc:
    s_add_u32 s41, s24, 1
L_xsf_46:
    buffer_load_dword v20, v4, s[4:7], s39 offen sc1
    s_sub_u32 s23, s23, 1
    s_movk_i32 s29, 8
    s_cbranch_scc1 L_fail
    s_waitcnt vmcnt(0)
    v_cmp_gt_u32 vcc, s41, v20
    s_cbranch_vccnz L_xsf_46
    s_lshl_b32 s26, s66, 10
    s_add_u32 s42, s33, s26
    s_add_u32 s43, s42, 4096
    s_add_u32 s44, s42, 8192
    s_add_u32 s45, s33, 12288
    s_add_u32 s46, s33, 16384
    s_add_u32 s47, s33, 20480
    buffer_load_dwordx4 v[24:27], v1, s[4:7], s42 offen offset:0 sc1
    buffer_load_dwordx4 v[48:51], v1, s[4:7], s45 offen offset:0 sc1
    buffer_load_dwordx4 v[72:75], v1, s[4:7], s45 offen offset:1024 sc1
    buffer_load_dwordx4 v[28:31], v1, s[4:7], s42 offen offset:2048 sc1
    buffer_load_dwordx4 v[52:55], v1, s[4:7], s45 offen offset:2048 sc1
    buffer_load_dwordx4 v[76:79], v1, s[4:7], s45 offen offset:3072 sc1
    buffer_load_dwordx4 v[32:35], v1, s[4:7], s43 offen offset:0 sc1
    buffer_load_dwordx4 v[56:59], v1, s[4:7], s46 offen offset:0 sc1
    buffer_load_dwordx4 v[80:83], v1, s[4:7], s46 offen offset:1024 sc1
    buffer_load_dwordx4 v[36:39], v1, s[4:7], s43 offen offset:2048 sc1
    buffer_load_dwordx4 v[60:63], v1, s[4:7], s46 offen offset:2048 sc1
    buffer_load_dwordx4 v[84:87], v1, s[4:7], s46 offen offset:3072 sc1
    buffer_load_dwordx4 v[40:43], v1, s[4:7], s44 offen offset:0 sc1
    buffer_load_dwordx4 v[64:67], v1, s[4:7], s47 offen offset:0 sc1
    buffer_load_dwordx4 v[88:91], v1, s[4:7], s47 offen offset:1024 sc1
    buffer_load_dwordx4 v[44:47], v1, s[4:7], s44 offen offset:2048 sc1
    buffer_load_dwordx4 v[68:71], v1, s[4:7], s47 offen offset:2048 sc1
    buffer_load_dwordx4 v[92:95], v1, s[4:7], s47 offen offset:3072 sc1
    s_add_u32 s33, s33, 151552
    s_cmp_eq_u32 s33, s35
    s_cselect_b32 s33, s34, s33
    s_and_b32 s26, s24, 3
    s_mul_i32 s31, s26, 36864
    s_add_u32 s31, s31, s32
    s_mul_i32 s36, s26, 12288
    s_add_u32 s36, s36, s38
    s_add_u32 s26, s24, 2
    s_and_b32 s26, s26, 3
    s_mul_i32 s37, s26, 12288
    s_add_u32 s37, s37, s38
    s_waitcnt vmcnt(15)
    v_mfma_f32_16x16x32_bf16 v[120:123], v[48:51], v[24:27], 0
    v_mfma_f32_16x16x32_bf16 v[124:127], v[72:75], v[24:27], 0
    s_waitcnt vmcnt(12)
    v_mfma_f32_16x16x32_bf16 v[120:123], v[52:55], v[28:31], v[120:123]
    v_mfma_f32_16x16x32_bf16 v[124:127], v[76:79], v[28:31], v[124:127]
    s_waitcnt vmcnt(9)
    v_mfma_f32_16x16x32_bf16 v[120:123], v[56:59], v[32:35], v[120:123]
    v_mfma_f32_16x16x32_bf16 v[124:127], v[80:83], v[32:35], v[124:127]
    s_waitcnt vmcnt(6)
    v_mfma_f32_16x16x32_bf16 v[120:123], v[60:63], v[36:39], v[120:123]
    v_mfma_f32_16x16x32_bf16 v[124:127], v[84:87], v[36:39], v[124:127]
    s_waitcnt vmcnt(3)
    v_mfma_f32_16x16x32_bf16 v[120:123], v[64:67], v[40:43], v[120:123]
    v_mfma_f32_16x16x32_bf16 v[124:127], v[88:91], v[40:43], v[124:127]
    s_waitcnt vmcnt(0)
    v_mfma_f32_16x16x32_bf16 v[120:123], v[68:71], v[44:47], v[120:123]
    v_mfma_f32_16x16x32_bf16 v[124:127], v[92:95], v[44:47], v[124:127]
L_xsk_47:
    buffer_load_dword v21, v6, s[4:7], s65 offen sc1
    s_sub_u32 s23, s23, 1
    s_movk_i32 s29, 9
    s_cbranch_scc1 L_fail
    s_waitcnt vmcnt(0)
    v_cmp_ge_i32 vcc, s24, v21
    s_cbranch_vccnz L_xsk_47
    buffer_load_dwordx4 v[96:99], v2, s[4:7], s31 offen offset:0 sc1
    buffer_load_dwordx4 v[100:103], v2, s[4:7], s31 offen offset:128 sc1
    buffer_load_dwordx4 v[104:107], v2, s[4:7], s31 offen offset:1024 sc1
    buffer_load_dwordx4 v[108:111], v2, s[4:7], s31 offen offset:1152 sc1
    buffer_load_dwordx4 v[112:115], v2, s[4:7], s31 offen offset:2048 sc1
    buffer_load_dwordx4 v[116:119], v2, s[4:7], s31 offen offset:2176 sc1
    s_waitcnt vmcnt(0)
    v_max3_u32 v21, v96, v97, v98
    v_max3_u32 v21, v99, v100, v21
    v_max3_u32 v21, v101, v102, v21
    v_max3_u32 v21, v103, v104, v21
    v_max3_u32 v21, v105, v106, v21
    v_max3_u32 v21, v107, v108, v21
    v_max3_u32 v21, v109, v110, v21
    v_max3_u32 v21, v111, v112, v21
    v_max3_u32 v21, v113, v114, v21
    v_max3_u32 v21, v115, v116, v21
    v_max3_u32 v21, v117, v118, v21
    v_max_u32 v21, v119, v21
    v_cmp_eq_u32 vcc, -1, v21
    s_cbranch_vccnz L_xsk_47
    v_mfma_f32_16x16x32_bf16 v[128:131], v[96:99], v[24:27], 0
    v_mfma_f32_16x16x32_bf16 v[128:131], v[100:103], v[28:31], v[128:131]
    v_mfma_f32_16x16x32_bf16 v[128:131], v[104:107], v[32:35], v[128:131]
    v_mfma_f32_16x16x32_bf16 v[128:131], v[108:111], v[36:39], v[128:131]
    v_mfma_f32_16x16x32_bf16 v[128:131], v[112:115], v[40:43], v[128:131]
    v_mfma_f32_16x16x32_bf16 v[128:131], v[116:119], v[44:47], v[128:131]
    buffer_store_dwordx4 v[8:11], v1, s[4:7], s37 offen
    buffer_store_dwordx2 v[8:9], v3, s[4:7], s37 offen
    v_cndmask_b32 v120, v5, v120, s[48:49]
    v_cndmask_b32 v121, v5, v121, s[50:51]
    v_cndmask_b32 v122, v5, v122, s[52:53]
    v_cndmask_b32 v123, v5, v123, s[54:55]
    v_cndmask_b32 v124, v5, v124, s[56:57]
    v_cndmask_b32 v125, v5, v125, s[58:59]
    v_cndmask_b32 v126, v5, v126, s[60:61]
    v_cndmask_b32 v127, v5, v127, s[62:63]
    v_max3_f32 v12, v120, v121, v122
    v_max3_f32 v12, v123, v124, v12
    v_max3_f32 v12, v125, v126, v12
    v_max3_f32 v12, v127, v128, v12
    v_max3_f32 v12, v129, v130, v12
    v_max_f32 v12, v131, v12
    v_mov_b32 v13, v12
    s_nop 1
    v_permlane32_swap_b32 v12, v13
    v_max_f32 v12, v12, v13
    v_mov_b32 v13, v12
    s_nop 1
    v_permlane16_swap_b32 v12, v13
    v_max_f32 v12, v12, v13
    v_mul_f32 v12, s40, v12
    v_fma_f32 v120, v120, s40, -v12
    v_fma_f32 v121, v121, s40, -v12
    v_fma_f32 v122, v122, s40, -v12
    v_fma_f32 v123, v123, s40, -v12
    v_fma_f32 v124, v124, s40, -v12
    v_fma_f32 v125, v125, s40, -v12
    v_fma_f32 v126, v126, s40, -v12
    v_fma_f32 v127, v127, s40, -v12
    v_fma_f32 v128, v128, s40, -v12
    v_fma_f32 v129, v129, s40, -v12
    v_fma_f32 v130, v130, s40, -v12
    v_fma_f32 v131, v131, s40, -v12
    v_exp_f32 v120, v120
    v_exp_f32 v121, v121
    v_exp_f32 v122, v122
    v_exp_f32 v123, v123
    v_exp_f32 v124, v124
    v_exp_f32 v125, v125
    v_exp_f32 v126, v126
    v_exp_f32 v127, v127
    v_exp_f32 v128, v128
    v_exp_f32 v129, v129
    v_exp_f32 v130, v130
    v_exp_f32 v131, v131
    v_add_f32 v14, v128, v129
    v_add_f32 v15, v120, v121
    v_add_f32 v14, v14, v130
    v_add_f32 v14, v14, v131
    v_add_f32 v15, v15, v122
    v_add_f32 v15, v15, v123
    v_add_f32 v15, v15, v124
    v_add_f32 v15, v15, v125
    v_add_f32 v15, v15, v126
    v_add_f32 v15, v15, v127
    v_fma_f32 v12, v14, 0.5, v15
    v_mov_b32 v13, v12
    s_nop 1
    v_permlane32_swap_b32 v12, v13
    v_add_f32 v12, v12, v13
    v_mov_b32 v13, v12
    s_nop 1
    v_permlane16_swap_b32 v12, v13
    v_add_f32 v12, v12, v13
    v_rcp_f32 v12, v12
    s_nop 0
    v_mul_f32 v120, v120, v12
    v_mul_f32 v121, v121, v12
    v_mul_f32 v122, v122, v12
    v_mul_f32 v123, v123, v12
    v_mul_f32 v124, v124, v12
    v_mul_f32 v125, v125, v12
    v_mul_f32 v126, v126, v12
    v_mul_f32 v127, v127, v12
    v_mul_f32 v128, v128, v12
    v_mul_f32 v129, v129, v12
    v_mul_f32 v130, v130, v12
    v_mul_f32 v131, v131, v12
    v_cvt_pk_bf16_f32 v132, v120, v121
    v_cvt_pk_bf16_f32 v133, v122, v123
    v_cvt_pk_bf16_f32 v134, v124, v125
    v_cvt_pk_bf16_f32 v135, v126, v127
    v_cvt_pk_bf16_f32 v136, v128, v130
    v_cvt_pk_bf16_f32 v137, v129, v131
    buffer_store_dwordx4 v[132:135], v1, s[4:7], s36 offen
    buffer_store_dwordx2 v[136:137], v3, s[4:7], s36 offen
    s_add_u32 s26, s24, 5
    s_mul_i32 s26, s26, 40960
    s_add_u32 s26, s26, s64
    buffer_load_dwordx4 v[140:143], v1, s[8:11], s26 offen offset:0
    buffer_load_dwordx4 v[140:143], v1, s[8:11], s26 offen offset:1024
    buffer_load_dwordx4 v[140:143], v1, s[8:11], s26 offen offset:2048
    buffer_load_dwordx4 v[140:143], v1, s[8:11], s26 offen offset:3072
    s_add_u32 s26, s26, 4096
    buffer_load_dwordx4 v[140:143], v1, s[8:11], s26 offen
    s_add_u32 s24, s24, 1
    s_cmp_lg_u32 s24, 64
    s_cbranch_scc1 L_xs_loc
    s_branch L_end
L_xs_glb:
    s_add_u32 s41, s24, 1
L_xsf_48:
    buffer_load_dword v20, v4, s[4:7], s39 offen sc1
    s_sub_u32 s23, s23, 1
    s_movk_i32 s29, 8
    s_cbranch_scc1 L_fail
    s_waitcnt vmcnt(0)
    v_cmp_gt_u32 vcc, s41, v20
    s_cbranch_vccnz L_xsf_48
    s_lshl_b32 s26, s66, 10
    s_add_u32 s42, s33, s26
    s_add_u32 s43, s42, 4096
    s_add_u32 s44, s42, 8192
    s_add_u32 s45, s33, 12288
    s_add_u32 s46, s33, 16384
    s_add_u32 s47, s33, 20480
    buffer_load_dwordx4 v[24:27], v1, s[4:7], s42 offen offset:0 sc1
    buffer_load_dwordx4 v[48:51], v1, s[4:7], s45 offen offset:0 sc1
    buffer_load_dwordx4 v[72:75], v1, s[4:7], s45 offen offset:1024 sc1
    buffer_load_dwordx4 v[28:31], v1, s[4:7], s42 offen offset:2048 sc1
    buffer_load_dwordx4 v[52:55], v1, s[4:7], s45 offen offset:2048 sc1
    buffer_load_dwordx4 v[76:79], v1, s[4:7], s45 offen offset:3072 sc1
    buffer_load_dwordx4 v[32:35], v1, s[4:7], s43 offen offset:0 sc1
    buffer_load_dwordx4 v[56:59], v1, s[4:7], s46 offen offset:0 sc1
    buffer_load_dwordx4 v[80:83], v1, s[4:7], s46 offen offset:1024 sc1
    buffer_load_dwordx4 v[36:39], v1, s[4:7], s43 offen offset:2048 sc1
    buffer_load_dwordx4 v[60:63], v1, s[4:7], s46 offen offset:2048 sc1
    buffer_load_dwordx4 v[84:87], v1, s[4:7], s46 offen offset:3072 sc1
    buffer_load_dwordx4 v[40:43], v1, s[4:7], s44 offen offset:0 sc1
    buffer_load_dwordx4 v[64:67], v1, s[4:7], s47 offen offset:0 sc1
    buffer_load_dwordx4 v[88:91], v1, s[4:7], s47 offen offset:1024 sc1
    buffer_load_dwordx4 v[44:47], v1, s[4:7], s44 offen offset:2048 sc1
    buffer_load_dwordx4 v[68:71], v1, s[4:7], s47 offen offset:2048 sc1
    buffer_load_dwordx4 v[92:95], v1, s[4:7], s47 offen offset:3072 sc1
    s_add_u32 s33, s33, 151552
    s_cmp_eq_u32 s33, s35
    s_cselect_b32 s33, s34, s33
    s_and_b32 s26, s24, 3
    s_mul_i32 s31, s26, 36864
    s_add_u32 s31, s31, s32
    s_mul_i32 s36, s26, 12288
    s_add_u32 s36, s36, s38
    s_add_u32 s26, s24, 2
    s_and_b32 s26, s26, 3
    s_mul_i32 s37, s26, 12288
    s_add_u32 s37, s37, s38
    s_waitcnt vmcnt(15)
    v_mfma_f32_16x16x32_bf16 v[120:123], v[48:51], v[24:27], 0
    v_mfma_f32_16x16x32_bf16 v[124:127], v[72:75], v[24:27], 0
    s_waitcnt vmcnt(12)
    v_mfma_f32_16x16x32_bf16 v[120:123], v[52:55], v[28:31], v[120:123]
    v_mfma_f32_16x16x32_bf16 v[124:127], v[76:79], v[28:31], v[124:127]
    s_waitcnt vmcnt(9)
    v_mfma_f32_16x16x32_bf16 v[120:123], v[56:59], v[32:35], v[120:123]
    v_mfma_f32_16x16x32_bf16 v[124:127], v[80:83], v[32:35], v[124:127]
    s_waitcnt vmcnt(6)
    v_mfma_f32_16x16x32_bf16 v[120:123], v[60:63], v[36:39], v[120:123]
    v_mfma_f32_16x16x32_bf16 v[124:127], v[84:87], v[36:39], v[124:127]
    s_waitcnt vmcnt(3)
    v_mfma_f32_16x16x32_bf16 v[120:123], v[64:67], v[40:43], v[120:123]
    v_mfma_f32_16x16x32_bf16 v[124:127], v[88:91], v[40:43], v[124:127]
    s_waitcnt vmcnt(0)
    v_mfma_f32_16x16x32_bf16 v[120:123], v[68:71], v[44:47], v[120:123]
    v_mfma_f32_16x16x32_bf16 v[124:127], v[92:95], v[44:47], v[124:127]
L_xsk_49:
    buffer_load_dword v21, v6, s[4:7], s65 offen sc1
    s_sub_u32 s23, s23, 1
    s_movk_i32 s29, 9
    s_cbranch_scc1 L_fail
    s_waitcnt vmcnt(0)
    v_cmp_ge_i32 vcc, s24, v21
    s_cbranch_vccnz L_xsk_49
    buffer_load_dwordx4 v[96:99], v2, s[4:7], s31 offen offset:0 sc1
    buffer_load_dwordx4 v[100:103], v2, s[4:7], s31 offen offset:128 sc1
    buffer_load_dwordx4 v[104:107], v2, s[4:7], s31 offen offset:1024 sc1
    buffer_load_dwordx4 v[108:111], v2, s[4:7], s31 offen offset:1152 sc1
    buffer_load_dwordx4 v[112:115], v2, s[4:7], s31 offen offset:2048 sc1
    buffer_load_dwordx4 v[116:119], v2, s[4:7], s31 offen offset:2176 sc1
    s_waitcnt vmcnt(0)
    v_max3_u32 v21, v96, v97, v98
    v_max3_u32 v21, v99, v100, v21
    v_max3_u32 v21, v101, v102, v21
    v_max3_u32 v21, v103, v104, v21
    v_max3_u32 v21, v105, v106, v21
    v_max3_u32 v21, v107, v108, v21
    v_max3_u32 v21, v109, v110, v21
    v_max3_u32 v21, v111, v112, v21
    v_max3_u32 v21, v113, v114, v21
    v_max3_u32 v21, v115, v116, v21
    v_max3_u32 v21, v117, v118, v21
    v_max_u32 v21, v119, v21
    v_cmp_eq_u32 vcc, -1, v21
    s_cbranch_vccnz L_xsk_49
    v_mfma_f32_16x16x32_bf16 v[128:131], v[96:99], v[24:27], 0
    v_mfma_f32_16x16x32_bf16 v[128:131], v[100:103], v[28:31], v[128:131]
    v_mfma_f32_16x16x32_bf16 v[128:131], v[104:107], v[32:35], v[128:131]
    v_mfma_f32_16x16x32_bf16 v[128:131], v[108:111], v[36:39], v[128:131]
    v_mfma_f32_16x16x32_bf16 v[128:131], v[112:115], v[40:43], v[128:131]
    v_mfma_f32_16x16x32_bf16 v[128:131], v[116:119], v[44:47], v[128:131]
    buffer_store_dwordx4 v[8:11], v1, s[4:7], s37 offen sc1
    buffer_store_dwordx2 v[8:9], v3, s[4:7], s37 offen sc1
    v_cndmask_b32 v120, v5, v120, s[48:49]
    v_cndmask_b32 v121, v5, v121, s[50:51]
    v_cndmask_b32 v122, v5, v122, s[52:53]
    v_cndmask_b32 v123, v5, v123, s[54:55]
    v_cndmask_b32 v124, v5, v124, s[56:57]
    v_cndmask_b32 v125, v5, v125, s[58:59]
    v_cndmask_b32 v126, v5, v126, s[60:61]
    v_cndmask_b32 v127, v5, v127, s[62:63]
    v_max3_f32 v12, v120, v121, v122
    v_max3_f32 v12, v123, v124, v12
    v_max3_f32 v12, v125, v126, v12
    v_max3_f32 v12, v127, v128, v12
    v_max3_f32 v12, v129, v130, v12
    v_max_f32 v12, v131, v12
    v_mov_b32 v13, v12
    s_nop 1
    v_permlane32_swap_b32 v12, v13
    v_max_f32 v12, v12, v13
    v_mov_b32 v13, v12
    s_nop 1
    v_permlane16_swap_b32 v12, v13
    v_max_f32 v12, v12, v13
    v_mul_f32 v12, s40, v12
    v_fma_f32 v120, v120, s40, -v12
    v_fma_f32 v121, v121, s40, -v12
    v_fma_f32 v122, v122, s40, -v12
    v_fma_f32 v123, v123, s40, -v12
    v_fma_f32 v124, v124, s40, -v12
    v_fma_f32 v125, v125, s40, -v12
    v_fma_f32 v126, v126, s40, -v12
    v_fma_f32 v127, v127, s40, -v12
    v_fma_f32 v128, v128, s40, -v12
    v_fma_f32 v129, v129, s40, -v12
    v_fma_f32 v130, v130, s40, -v12
    v_fma_f32 v131, v131, s40, -v12
    v_exp_f32 v120, v120
    v_exp_f32 v121, v121
    v_exp_f32 v122, v122
    v_exp_f32 v123, v123
    v_exp_f32 v124, v124
    v_exp_f32 v125, v125
    v_exp_f32 v126, v126
    v_exp_f32 v127, v127
    v_exp_f32 v128, v128
    v_exp_f32 v129, v129
    v_exp_f32 v130, v130
    v_exp_f32 v131, v131
    v_add_f32 v14, v128, v129
    v_add_f32 v15, v120, v121
    v_add_f32 v14, v14, v130
    v_add_f32 v14, v14, v131
    v_add_f32 v15, v15, v122
    v_add_f32 v15, v15, v123
    v_add_f32 v15, v15, v124
    v_add_f32 v15, v15, v125
    v_add_f32 v15, v15, v126
    v_add_f32 v15, v15, v127
    v_fma_f32 v12, v14, 0.5, v15
    v_mov_b32 v13, v12
    s_nop 1
    v_permlane32_swap_b32 v12, v13
    v_add_f32 v12, v12, v13
    v_mov_b32 v13, v12
    s_nop 1
    v_permlane16_swap_b32 v12, v13
    v_add_f32 v12, v12, v13
    v_rcp_f32 v12, v12
    s_nop 0
    v_mul_f32 v120, v120, v12
    v_mul_f32 v121, v121, v12
    v_mul_f32 v122, v122, v12
    v_mul_f32 v123, v123, v12
    v_mul_f32 v124, v124, v12
    v_mul_f32 v125, v125, v12
    v_mul_f32 v126, v126, v12
    v_mul_f32 v127, v127, v12
    v_mul_f32 v128, v128, v12
    v_mul_f32 v129, v129, v12
    v_mul_f32 v130, v130, v12
    v_mul_f32 v131, v131, v12
    v_cvt_pk_bf16_f32 v132, v120, v121
    v_cvt_pk_bf16_f32 v133, v122, v123
    v_cvt_pk_bf16_f32 v134, v124, v125
    v_cvt_pk_bf16_f32 v135, v126, v127
    v_cvt_pk_bf16_f32 v136, v128, v130
    v_cvt_pk_bf16_f32 v137, v129, v131
    buffer_store_dwordx4 v[132:135], v1, s[4:7], s36 offen sc1
    buffer_store_dwordx2 v[136:137], v3, s[4:7], s36 offen sc1
    s_add_u32 s26, s24, 5
    s_mul_i32 s26, s26, 40960
    s_add_u32 s26, s26, s64
    buffer_load_dwordx4 v[140:143], v1, s[8:11], s26 offen offset:0
    buffer_load_dwordx4 v[140:143], v1, s[8:11], s26 offen offset:1024
    buffer_load_dwordx4 v[140:143], v1, s[8:11], s26 offen offset:2048
    buffer_load_dwordx4 v[140:143], v1, s[8:11], s26 offen offset:3072
    s_add_u32 s26, s26, 4096
    buffer_load_dwordx4 v[140:143], v1, s[8:11], s26 offen
    s_add_u32 s24, s24, 1
    s_cmp_lg_u32 s24, 64
    s_cbranch_scc1 L_xs_glb
    s_branch L_end
L_bg:
    s_sub_u32 s26, s21, 30
    s_lshl_b32 s26, s26, 3
    s_add_u32 s26, s26, s20
    s_lshl_b32 s26, s26, 2
    s_add_u32 s30, s26, s22
    s_mul_i32 s32, s22, 37888
    s_load_dwordx4 s[52:55], s[0:1], 64
    s_load_dwordx4 s[56:59], s[0:1], 80
    s_load_dwordx4 s[60:63], s[0:1], 96
    s_load_dwordx2 s[64:65], s[0:1], 112
    s_mov_b32 s35, 0xffff0000
    s_mov_b32 s24, 0
    v_lshlrev_b32 v1, 4, v0
    v_cmp_eq_u32 vcc, 0, v0
    v_mov_b32 v4, 536870912
    s_nop 0
    v_cndmask_b32 v2, v4, v0, vcc
    s_waitcnt lgkmcnt(0)
    s_lshl_b32 s93, s20, 1
    s_add_u32 s93, s93, 16
    s_add_u32 s94, s93, 1
L_loc_50:
    v_lshlrev_b32 v4, 2, v0
    buffer_load_dword v5, v4, s[16:19], 0 offen sc1
    s_sub_u32 s23, s23, 1
    s_movk_i32 s29, 1
    s_cbranch_scc1 L_fail
L_loc1_51:
    s_waitcnt vmcnt(0)
    v_readlane_b32 s26, v5, s93
    v_readlane_b32 s27, v5, s94
    v_readlane_b32 s29, v5, 56
    s_lshr_b32 s28, s27, 24
    s_min_u32 s28, s28, s29
    s_cmp_lt_u32 s28, 32
    s_cbranch_scc1 L_loc_50
    s_lshl_b32 s26, s20, 9
    s_add_u32 s26, s26, 2818048
    v_lshlrev_b32 v5, 2, v0
L_bgw_52:
    s_sleep 16
    buffer_load_dword v4, v5, s[4:7], s26 offen sc1
    s_sub_u32 s23, s23, 1
    s_movk_i32 s29, 12
    s_cbranch_scc1 L_fail
    s_waitcnt vmcnt(0)
    v_cmp_eq_u32 vcc, 0, v4
    s_cbranch_vccnz L_bgw_52
    s_cmp_eq_u32 s21, 31
    s_cbranch_scc1 L_touch_53
    s_cmp_lg_u32 s22, 0
    s_cbranch_scc1 L_nomeas_55
    s_lshl_b32 s26, s20, 10
    s_add_u32 s26, s26, 2768896
    v_mov_b32 v5, s26
    s_mov_b32 s86, -1
    s_mov_b32 s87, -1
    s_memtime s[82:83]
    s_waitcnt lgkmcnt(0)
    s_mov_b32 s27, 0
    buffer_load_dword v6, v5, s[4:7], s27 offen sc1
    s_waitcnt vmcnt(0)
    s_memtime s[84:85]
    s_waitcnt lgkmcnt(0)
    s_sub_u32 s84, s84, s82
    s_min_u32 s86, s86, s84
    s_memtime s[82:83]
    s_waitcnt lgkmcnt(0)
    s_mov_b32 s27, 8192
    buffer_load_dword v6, v5, s[4:7], s27 offen sc1
    s_waitcnt vmcnt(0)
    s_memtime s[84:85]
    s_waitcnt lgkmcnt(0)
    s_sub_u32 s84, s84, s82
    s_min_u32 s87, s87, s84
    s_memtime s[82:83]
    s_waitcnt lgkmcnt(0)
    s_mov_b32 s27, 128
    buffer_load_dword v6, v5, s[4:7], s27 offen sc1
    s_waitcnt vmcnt(0)
    s_memtime s[84:85]
    s_waitcnt lgkmcnt(0)
    s_sub_u32 s84, s84, s82
    s_min_u32 s86, s86, s84
    s_memtime s[82:83]
    s_waitcnt lgkmcnt(0)
    s_mov_b32 s27, 8320
    buffer_load_dword v6, v5, s[4:7], s27 offen sc1
    s_waitcnt vmcnt(0)
    s_memtime s[84:85]
    s_waitcnt lgkmcnt(0)
    s_sub_u32 s84, s84, s82
    s_min_u32 s87, s87, s84
    s_memtime s[82:83]
    s_waitcnt lgkmcnt(0)
    s_mov_b32 s27, 256
    buffer_load_dword v6, v5, s[4:7], s27 offen sc1
    s_waitcnt vmcnt(0)
    s_memtime s[84:85]
    s_waitcnt lgkmcnt(0)
    s_sub_u32 s84, s84, s82
    s_min_u32 s86, s86, s84
    s_memtime s[82:83]
    s_waitcnt lgkmcnt(0)
    s_mov_b32 s27, 8448
    buffer_load_dword v6, v5, s[4:7], s27 offen sc1
    s_waitcnt vmcnt(0)
    s_memtime s[84:85]
    s_waitcnt lgkmcnt(0)
    s_sub_u32 s84, s84, s82
    s_min_u32 s87, s87, s84
    s_memtime s[82:83]
    s_waitcnt lgkmcnt(0)
    s_mov_b32 s27, 384
    buffer_load_dword v6, v5, s[4:7], s27 offen sc1
    s_waitcnt vmcnt(0)
    s_memtime s[84:85]
    s_waitcnt lgkmcnt(0)
    s_sub_u32 s84, s84, s82
    s_min_u32 s86, s86, s84
    s_memtime s[82:83]
    s_waitcnt lgkmcnt(0)
    s_mov_b32 s27, 8576
    buffer_load_dword v6, v5, s[4:7], s27 offen sc1
    s_waitcnt vmcnt(0)
    s_memtime s[84:85]
    s_waitcnt lgkmcnt(0)
    s_sub_u32 s84, s84, s82
    s_min_u32 s87, s87, s84
    s_memtime s[82:83]
    s_waitcnt lgkmcnt(0)
    s_mov_b32 s27, 512
    buffer_load_dword v6, v5, s[4:7], s27 offen sc1
    s_waitcnt vmcnt(0)
    s_memtime s[84:85]
    s_waitcnt lgkmcnt(0)
    s_sub_u32 s84, s84, s82
    s_min_u32 s86, s86, s84
    s_memtime s[82:83]
    s_waitcnt lgkmcnt(0)
    s_mov_b32 s27, 8704
    buffer_load_dword v6, v5, s[4:7], s27 offen sc1
    s_waitcnt vmcnt(0)
    s_memtime s[84:85]
    s_waitcnt lgkmcnt(0)
    s_sub_u32 s84, s84, s82
    s_min_u32 s87, s87, s84
    s_memtime s[82:83]
    s_waitcnt lgkmcnt(0)
    s_mov_b32 s27, 640
    buffer_load_dword v6, v5, s[4:7], s27 offen sc1
    s_waitcnt vmcnt(0)
    s_memtime s[84:85]
    s_waitcnt lgkmcnt(0)
    s_sub_u32 s84, s84, s82
    s_min_u32 s86, s86, s84
    s_memtime s[82:83]
    s_waitcnt lgkmcnt(0)
    s_mov_b32 s27, 8832
    buffer_load_dword v6, v5, s[4:7], s27 offen sc1
    s_waitcnt vmcnt(0)
    s_memtime s[84:85]
    s_waitcnt lgkmcnt(0)
    s_sub_u32 s84, s84, s82
    s_min_u32 s87, s87, s84
    s_memtime s[82:83]
    s_waitcnt lgkmcnt(0)
    s_mov_b32 s27, 768
    buffer_load_dword v6, v5, s[4:7], s27 offen sc1
    s_waitcnt vmcnt(0)
    s_memtime s[84:85]
    s_waitcnt lgkmcnt(0)
    s_sub_u32 s84, s84, s82
    s_min_u32 s86, s86, s84
    s_memtime s[82:83]
    s_waitcnt lgkmcnt(0)
    s_mov_b32 s27, 8960
    buffer_load_dword v6, v5, s[4:7], s27 offen sc1
    s_waitcnt vmcnt(0)
    s_memtime s[84:85]
    s_waitcnt lgkmcnt(0)
    s_sub_u32 s84, s84, s82
    s_min_u32 s87, s87, s84
    s_cmp_lt_u32 s87, s86
    s_cselect_b32 s27, 2, 1
    v_mov_b32 v6, s27
    s_lshl_b32 s26, s20, 2
    s_add_u32 s26, s26, 128
    v_mov_b32 v5, s26
    buffer_store_dword v6, v5, s[16:19], 0 offen sc1
L_nomeas_55:
    s_barrier
    s_branch L_touched_54
L_touch_53:
L_touched_54:
    s_mov_b64 s[36:37], s[52:53]
    s_and_b32 s37, s37, 0xffff
    s_mov_b32 s38, 2621440
    s_mov_b32 s39, 0x20000
    s_mov_b64 s[40:41], s[54:55]
    s_and_b32 s41, s41, 0xffff
    s_mov_b32 s42, 2621440
    s_mov_b32 s43, 0x20000
    s_mov_b64 s[48:49], s[62:63]
    s_and_b32 s49, s49, 0xffff
    s_mov_b32 s50, 1280
    s_mov_b32 s51, 0x20000
    v_and_b32 v4, 15, v0
    v_lshlrev_b32 v4, 4, v4
    buffer_load_dwordx4 v[64:67], v4, s[48:51], 0 offen offset:0
    buffer_load_dwordx4 v[68:71], v4, s[48:51], 0 offen offset:256
    buffer_load_dwordx4 v[72:75], v4, s[48:51], 0 offen offset:512
    buffer_load_dwordx4 v[76:79], v4, s[48:51], 0 offen offset:768
    buffer_load_dwordx4 v[80:83], v4, s[48:51], 0 offen offset:1024
    v_lshrrev_b32 v5, 4, v0
    v_mul_u32_u24 v85, 1280, v5
    v_add_u32 v85, v85, v4
    v_lshlrev_b32 v5, 2, v5
    v_cmp_eq_u32 vcc, 0, v4
    v_mov_b32 v6, 536870912
    s_nop 0
    v_cndmask_b32 v86, v6, v5, vcc
    s_mul_i32 s77, s30, 40960
    s_lshl_b32 s78, s30, 7
    s_add_u32 s78, s78, 55574528
    s_waitcnt vmcnt(0)
    v_lshlrev_b32 v24, 16, v64
    v_and_b32 v25, s35, v64
    v_lshlrev_b32 v26, 16, v65
    v_and_b32 v27, s35, v65
    v_lshlrev_b32 v28, 16, v66
    v_and_b32 v29, s35, v66
    v_lshlrev_b32 v30, 16, v67
    v_and_b32 v31, s35, v67
    v_lshlrev_b32 v32, 16, v68
    v_and_b32 v33, s35, v68
    v_lshlrev_b32 v34, 16, v69
    v_and_b32 v35, s35, v69
    v_lshlrev_b32 v36, 16, v70
    v_and_b32 v37, s35, v70
    v_lshlrev_b32 v38, 16, v71
    v_and_b32 v39, s35, v71
    v_lshlrev_b32 v40, 16, v72
    v_and_b32 v41, s35, v72
    v_lshlrev_b32 v42, 16, v73
    v_and_b32 v43, s35, v73
    v_lshlrev_b32 v44, 16, v74
    v_and_b32 v45, s35, v74
    v_lshlrev_b32 v46, 16, v75
    v_and_b32 v47, s35, v75
    v_lshlrev_b32 v48, 16, v76
    v_and_b32 v49, s35, v76
    v_lshlrev_b32 v50, 16, v77
    v_and_b32 v51, s35, v77
    v_lshlrev_b32 v52, 16, v78
    v_and_b32 v53, s35, v78
    v_lshlrev_b32 v54, 16, v79
    v_and_b32 v55, s35, v79
    v_lshlrev_b32 v56, 16, v80
    v_and_b32 v57, s35, v80
    v_lshlrev_b32 v58, 16, v81
    v_and_b32 v59, s35, v81
    v_lshlrev_b32 v60, 16, v82
    v_and_b32 v61, s35, v82
    v_lshlrev_b32 v62, 16, v83
    v_and_b32 v63, s35, v83
    s_mov_b32 s33, 8
L_gate_56:
    buffer_load_dwordx4 v[64:67], v85, s[8:11], s77 offen offset:0
    buffer_load_dwordx4 v[68:71], v85, s[8:11], s77 offen offset:256
    buffer_load_dwordx4 v[72:75], v85, s[8:11], s77 offen offset:512
    buffer_load_dwordx4 v[76:79], v85, s[8:11], s77 offen offset:768
    buffer_load_dwordx4 v[80:83], v85, s[8:11], s77 offen offset:1024
    v_mov_b32 v84, 0
    s_waitcnt vmcnt(4)
    v_lshlrev_b32 v4, 16, v64
    v_and_b32 v5, s35, v64
    v_pk_mul_f32 v[4:5], v[4:5], v[24:25]
    v_cvt_pk_bf16_f32 v6, v4, v5
    v_lshlrev_b32 v4, 16, v6
    v_and_b32 v5, s35, v6
    v_add_f32 v84, v84, v4
    v_add_f32 v84, v84, v5
    v_lshlrev_b32 v4, 16, v65
    v_and_b32 v5, s35, v65
    v_pk_mul_f32 v[4:5], v[4:5], v[26:27]
    v_cvt_pk_bf16_f32 v6, v4, v5
    v_lshlrev_b32 v4, 16, v6
    v_and_b32 v5, s35, v6
    v_add_f32 v84, v84, v4
    v_add_f32 v84, v84, v5
    v_lshlrev_b32 v4, 16, v66
    v_and_b32 v5, s35, v66
    v_pk_mul_f32 v[4:5], v[4:5], v[28:29]
    v_cvt_pk_bf16_f32 v6, v4, v5
    v_lshlrev_b32 v4, 16, v6
    v_and_b32 v5, s35, v6
    v_add_f32 v84, v84, v4
    v_add_f32 v84, v84, v5
    v_lshlrev_b32 v4, 16, v67
    v_and_b32 v5, s35, v67
    v_pk_mul_f32 v[4:5], v[4:5], v[30:31]
    v_cvt_pk_bf16_f32 v6, v4, v5
    v_lshlrev_b32 v4, 16, v6
    v_and_b32 v5, s35, v6
    v_add_f32 v84, v84, v4
    v_add_f32 v84, v84, v5
    s_waitcnt vmcnt(3)
    v_lshlrev_b32 v4, 16, v68
    v_and_b32 v5, s35, v68
    v_pk_mul_f32 v[4:5], v[4:5], v[32:33]
    v_cvt_pk_bf16_f32 v6, v4, v5
    v_lshlrev_b32 v4, 16, v6
    v_and_b32 v5, s35, v6
    v_add_f32 v84, v84, v4
    v_add_f32 v84, v84, v5
    v_lshlrev_b32 v4, 16, v69
    v_and_b32 v5, s35, v69
    v_pk_mul_f32 v[4:5], v[4:5], v[34:35]
    v_cvt_pk_bf16_f32 v6, v4, v5
    v_lshlrev_b32 v4, 16, v6
    v_and_b32 v5, s35, v6
    v_add_f32 v84, v84, v4
    v_add_f32 v84, v84, v5
    v_lshlrev_b32 v4, 16, v70
    v_and_b32 v5, s35, v70
    v_pk_mul_f32 v[4:5], v[4:5], v[36:37]
    v_cvt_pk_bf16_f32 v6, v4, v5
    v_lshlrev_b32 v4, 16, v6
    v_and_b32 v5, s35, v6
    v_add_f32 v84, v84, v4
    v_add_f32 v84, v84, v5
    v_lshlrev_b32 v4, 16, v71
    v_and_b32 v5, s35, v71
    v_pk_mul_f32 v[4:5], v[4:5], v[38:39]
    v_cvt_pk_bf16_f32 v6, v4, v5
    v_lshlrev_b32 v4, 16, v6
    v_and_b32 v5, s35, v6
    v_add_f32 v84, v84, v4
    v_add_f32 v84, v84, v5
    s_waitcnt vmcnt(2)
    v_lshlrev_b32 v4, 16, v72
    v_and_b32 v5, s35, v72
    v_pk_mul_f32 v[4:5], v[4:5], v[40:41]
    v_cvt_pk_bf16_f32 v6, v4, v5
    v_lshlrev_b32 v4, 16, v6
    v_and_b32 v5, s35, v6
    v_add_f32 v84, v84, v4
    v_add_f32 v84, v84, v5
    v_lshlrev_b32 v4, 16, v73
    v_and_b32 v5, s35, v73
    v_pk_mul_f32 v[4:5], v[4:5], v[42:43]
    v_cvt_pk_bf16_f32 v6, v4, v5
    v_lshlrev_b32 v4, 16, v6
    v_and_b32 v5, s35, v6
    v_add_f32 v84, v84, v4
    v_add_f32 v84, v84, v5
    v_lshlrev_b32 v4, 16, v74
    v_and_b32 v5, s35, v74
    v_pk_mul_f32 v[4:5], v[4:5], v[44:45]
    v_cvt_pk_bf16_f32 v6, v4, v5
    v_lshlrev_b32 v4, 16, v6
    v_and_b32 v5, s35, v6
    v_add_f32 v84, v84, v4
    v_add_f32 v84, v84, v5
    v_lshlrev_b32 v4, 16, v75
    v_and_b32 v5, s35, v75
    v_pk_mul_f32 v[4:5], v[4:5], v[46:47]
    v_cvt_pk_bf16_f32 v6, v4, v5
    v_lshlrev_b32 v4, 16, v6
    v_and_b32 v5, s35, v6
    v_add_f32 v84, v84, v4
    v_add_f32 v84, v84, v5
    s_waitcnt vmcnt(1)
    v_lshlrev_b32 v4, 16, v76
    v_and_b32 v5, s35, v76
    v_pk_mul_f32 v[4:5], v[4:5], v[48:49]
    v_cvt_pk_bf16_f32 v6, v4, v5
    v_lshlrev_b32 v4, 16, v6
    v_and_b32 v5, s35, v6
    v_add_f32 v84, v84, v4
    v_add_f32 v84, v84, v5
    v_lshlrev_b32 v4, 16, v77
    v_and_b32 v5, s35, v77
    v_pk_mul_f32 v[4:5], v[4:5], v[50:51]
    v_cvt_pk_bf16_f32 v6, v4, v5
    v_lshlrev_b32 v4, 16, v6
    v_and_b32 v5, s35, v6
    v_add_f32 v84, v84, v4
    v_add_f32 v84, v84, v5
    v_lshlrev_b32 v4, 16, v78
    v_and_b32 v5, s35, v78
    v_pk_mul_f32 v[4:5], v[4:5], v[52:53]
    v_cvt_pk_bf16_f32 v6, v4, v5
    v_lshlrev_b32 v4, 16, v6
    v_and_b32 v5, s35, v6
    v_add_f32 v84, v84, v4
    v_add_f32 v84, v84, v5
    v_lshlrev_b32 v4, 16, v79
    v_and_b32 v5, s35, v79
    v_pk_mul_f32 v[4:5], v[4:5], v[54:55]
    v_cvt_pk_bf16_f32 v6, v4, v5
    v_lshlrev_b32 v4, 16, v6
    v_and_b32 v5, s35, v6
    v_add_f32 v84, v84, v4
    v_add_f32 v84, v84, v5
    s_waitcnt vmcnt(0)
    v_lshlrev_b32 v4, 16, v80
    v_and_b32 v5, s35, v80
    v_pk_mul_f32 v[4:5], v[4:5], v[56:57]
    v_cvt_pk_bf16_f32 v6, v4, v5
    v_lshlrev_b32 v4, 16, v6
    v_and_b32 v5, s35, v6
    v_add_f32 v84, v84, v4
    v_add_f32 v84, v84, v5
    v_lshlrev_b32 v4, 16, v81
    v_and_b32 v5, s35, v81
    v_pk_mul_f32 v[4:5], v[4:5], v[58:59]
    v_cvt_pk_bf16_f32 v6, v4, v5
    v_lshlrev_b32 v4, 16, v6
    v_and_b32 v5, s35, v6
    v_add_f32 v84, v84, v4
    v_add_f32 v84, v84, v5
    v_lshlrev_b32 v4, 16, v82
    v_and_b32 v5, s35, v82
    v_pk_mul_f32 v[4:5], v[4:5], v[60:61]
    v_cvt_pk_bf16_f32 v6, v4, v5
    v_lshlrev_b32 v4, 16, v6
    v_and_b32 v5, s35, v6
    v_add_f32 v84, v84, v4
    v_add_f32 v84, v84, v5
    v_lshlrev_b32 v4, 16, v83
    v_and_b32 v5, s35, v83
    v_pk_mul_f32 v[4:5], v[4:5], v[62:63]
    v_cvt_pk_bf16_f32 v6, v4, v5
    v_lshlrev_b32 v4, 16, v6
    v_and_b32 v5, s35, v6
    v_add_f32 v84, v84, v4
    v_add_f32 v84, v84, v5
    s_nop 1
    v_add_f32_dpp v84, v84, v84 row_ror:8 row_mask:0xf bank_mask:0xf
    s_nop 1
    v_add_f32_dpp v84, v84, v84 row_ror:4 row_mask:0xf bank_mask:0xf
    s_nop 1
    v_add_f32_dpp v84, v84, v84 row_ror:2 row_mask:0xf bank_mask:0xf
    s_nop 1
    v_add_f32_dpp v84, v84, v84 row_ror:1 row_mask:0xf bank_mask:0xf
    v_cvt_pk_bf16_f32 v84, v84, v84
    v_lshlrev_b32 v84, 16, v84
    v_mul_f32 v84, 0xbfb8aa3b, v84
    v_exp_f32 v84, v84
    s_nop 0
    v_add_f32 v84, 1.0, v84
    v_rcp_f32 v84, v84
    s_nop 0
    v_cvt_pk_bf16_f32 v84, v84, v84
    v_lshlrev_b32 v84, 16, v84
    buffer_store_dword v84, v86, s[4:7], s78 offen sc1
    s_add_u32 s77, s77, 5120
    s_add_u32 s78, s78, 16
    s_sub_u32 s33, s33, 1
    s_cmp_lg_u32 s33, 0
    s_cbranch_scc1 L_gate_56
    v_lshlrev_b32 v20, 2, v0
    v_lshrrev_b32 v21, 4, v0
    v_lshlrev_b32 v21, 12, v21
    v_and_b32 v4, 15, v0
    v_lshl_add_u32 v21, v4, 4, v21
    s_sub_u32 s26, 3, s22
    s_lshl_b32 s26, s26, 6
    v_mul_u32_u24 v22, 544, v0
    v_add_u32 v22, s26, v22
    v_lshrrev_b32 v23, 4, v0
    v_mul_u32_u24 v23, 272, v23
    v_lshl_add_u32 v23, v4, 4, v23
    s_mul_i32 s26, s22, 8704
    v_add_u32 v23, s26, v23
    s_mov_b64 s[48:49], s[56:57]
    s_and_b32 s49, s49, 0xffff
    s_mov_b32 s50, 5120
    s_mov_b32 s51, 0x20000
    s_mul_i32 s77, s30, 40960
    s_lshr_b32 s78, s30, 2
    s_lshl_b32 s78, s78, 8
    s_sub_u32 s78, 52432640, s78
    s_lshl_b32 s26, s22, 17
    s_add_u32 s78, s78, s26
    s_mov_b32 s34, 0
    s_sub_u32 s26, s77, 3840
    v_add_u32 v5, s26, v20
    s_mov_b32 s33, 5
L_kv_57:
    buffer_load_dwordx4 v[144:147], v1, s[48:51], s34 offen
    buffer_load_dword v40, v5, s[36:39], 0 offen offset:0
    buffer_load_dword v41, v5, s[36:39], 0 offen offset:1280
    buffer_load_dword v42, v5, s[36:39], 0 offen offset:2560
    s_add_u32 s26, s77, 0
    buffer_load_dword v43, v20, s[36:39], s26 offen
    buffer_load_dword v76, v20, s[40:43], s26 offen
    s_add_u32 s26, s77, 1280
    buffer_load_dword v44, v20, s[36:39], s26 offen
    buffer_load_dword v77, v20, s[40:43], s26 offen
    s_add_u32 s26, s77, 2560
    buffer_load_dword v45, v20, s[36:39], s26 offen
    buffer_load_dword v78, v20, s[40:43], s26 offen
    s_add_u32 s26, s77, 3840
    buffer_load_dword v46, v20, s[36:39], s26 offen
    buffer_load_dword v79, v20, s[40:43], s26 offen
    s_add_u32 s26, s77, 5120
    buffer_load_dword v47, v20, s[36:39], s26 offen
    buffer_load_dword v80, v20, s[40:43], s26 offen
    s_add_u32 s26, s77, 6400
    buffer_load_dword v48, v20, s[36:39], s26 offen
    buffer_load_dword v81, v20, s[40:43], s26 offen
    s_add_u32 s26, s77, 7680
    buffer_load_dword v49, v20, s[36:39], s26 offen
    buffer_load_dword v82, v20, s[40:43], s26 offen
    s_add_u32 s26, s77, 8960
    buffer_load_dword v50, v20, s[36:39], s26 offen
    buffer_load_dword v83, v20, s[40:43], s26 offen
    s_add_u32 s26, s77, 10240
    buffer_load_dword v51, v20, s[36:39], s26 offen
    buffer_load_dword v84, v20, s[40:43], s26 offen
    s_add_u32 s26, s77, 11520
    buffer_load_dword v52, v20, s[36:39], s26 offen
    buffer_load_dword v85, v20, s[40:43], s26 offen
    s_add_u32 s26, s77, 12800
    buffer_load_dword v53, v20, s[36:39], s26 offen
    buffer_load_dword v86, v20, s[40:43], s26 offen
    s_add_u32 s26, s77, 14080
    buffer_load_dword v54, v20, s[36:39], s26 offen
    buffer_load_dword v87, v20, s[40:43], s26 offen
    s_add_u32 s26, s77, 15360
    buffer_load_dword v55, v20, s[36:39], s26 offen
    buffer_load_dword v88, v20, s[40:43], s26 offen
    s_add_u32 s26, s77, 16640
    buffer_load_dword v56, v20, s[36:39], s26 offen
    buffer_load_dword v89, v20, s[40:43], s26 offen
    s_add_u32 s26, s77, 17920
    buffer_load_dword v57, v20, s[36:39], s26 offen
    buffer_load_dword v90, v20, s[40:43], s26 offen
    s_add_u32 s26, s77, 19200
    buffer_load_dword v58, v20, s[36:39], s26 offen
    buffer_load_dword v91, v20, s[40:43], s26 offen
    s_waitcnt vmcnt(32)
    v_lshlrev_b32 v24, 16, v144
    v_and_b32 v26, s35, v144
    v_lshlrev_b32 v28, 16, v145
    v_and_b32 v30, s35, v145
    v_lshlrev_b32 v25, 16, v146
    v_and_b32 v27, s35, v146
    v_lshlrev_b32 v29, 16, v147
    v_and_b32 v31, s35, v147
    v_lshlrev_b32 v34, 16, v40
    v_and_b32 v35, s35, v40
    v_lshlrev_b32 v36, 16, v41
    v_and_b32 v37, s35, v41
    v_lshlrev_b32 v38, 16, v42
    v_and_b32 v39, s35, v42
    s_add_u32 s26, s77, 20480
    buffer_load_dword v59, v20, s[36:39], s26 offen
    buffer_load_dword v92, v20, s[40:43], s26 offen
    s_waitcnt vmcnt(32)
    v_lshlrev_b32 v32, 16, v43
    v_and_b32 v33, s35, v43
    v_lshlrev_b32 v108, 16, v76
    v_and_b32 v109, s35, v76
    v_pk_mul_f32 v[8:9], v[34:35], v[30:31]
    v_cvt_pk_bf16_f32 v6, v8, v9
    v_lshlrev_b32 v8, 16, v6
    v_and_b32 v9, s35, v6
    v_pk_mul_f32 v[10:11], v[36:37], v[28:29]
    v_cvt_pk_bf16_f32 v6, v10, v11
    v_lshlrev_b32 v10, 16, v6
    v_and_b32 v11, s35, v6
    v_pk_add_f32 v[8:9], v[8:9], v[10:11]
    v_cvt_pk_bf16_f32 v6, v8, v9
    v_lshlrev_b32 v8, 16, v6
    v_and_b32 v9, s35, v6
    v_pk_mul_f32 v[10:11], v[38:39], v[26:27]
    v_cvt_pk_bf16_f32 v6, v10, v11
    v_lshlrev_b32 v10, 16, v6
    v_and_b32 v11, s35, v6
    v_pk_add_f32 v[8:9], v[8:9], v[10:11]
    v_cvt_pk_bf16_f32 v6, v8, v9
    v_lshlrev_b32 v8, 16, v6
    v_and_b32 v9, s35, v6
    v_pk_mul_f32 v[10:11], v[32:33], v[24:25]
    v_cvt_pk_bf16_f32 v6, v10, v11
    v_lshlrev_b32 v10, 16, v6
    v_and_b32 v11, s35, v6
    v_pk_add_f32 v[8:9], v[8:9], v[10:11]
    v_cvt_pk_bf16_f32 v6, v8, v9
    v_lshlrev_b32 v8, 16, v6
    v_and_b32 v9, s35, v6
    v_pk_mul_f32 v[108:109], v[8:9], v[108:109]
    s_add_u32 s26, s77, 21760
    buffer_load_dword v60, v20, s[36:39], s26 offen
    buffer_load_dword v93, v20, s[40:43], s26 offen
    s_waitcnt vmcnt(32)
    v_lshlrev_b32 v34, 16, v44
    v_and_b32 v35, s35, v44
    v_lshlrev_b32 v110, 16, v77
    v_and_b32 v111, s35, v77
    v_pk_mul_f32 v[8:9], v[36:37], v[30:31]
    v_cvt_pk_bf16_f32 v6, v8, v9
    v_lshlrev_b32 v8, 16, v6
    v_and_b32 v9, s35, v6
    v_pk_mul_f32 v[10:11], v[38:39], v[28:29]
    v_cvt_pk_bf16_f32 v6, v10, v11
    v_lshlrev_b32 v10, 16, v6
    v_and_b32 v11, s35, v6
    v_pk_add_f32 v[8:9], v[8:9], v[10:11]
    v_cvt_pk_bf16_f32 v6, v8, v9
    v_lshlrev_b32 v8, 16, v6
    v_and_b32 v9, s35, v6
    v_pk_mul_f32 v[10:11], v[32:33], v[26:27]
    v_cvt_pk_bf16_f32 v6, v10, v11
    v_lshlrev_b32 v10, 16, v6
    v_and_b32 v11, s35, v6
    v_pk_add_f32 v[8:9], v[8:9], v[10:11]
    v_cvt_pk_bf16_f32 v6, v8, v9
    v_lshlrev_b32 v8, 16, v6
    v_and_b32 v9, s35, v6
    v_pk_mul_f32 v[10:11], v[34:35], v[24:25]
    v_cvt_pk_bf16_f32 v6, v10, v11
    v_lshlrev_b32 v10, 16, v6
    v_and_b32 v11, s35, v6
    v_pk_add_f32 v[8:9], v[8:9], v[10:11]
    v_cvt_pk_bf16_f32 v6, v8, v9
    v_lshlrev_b32 v8, 16, v6
    v_and_b32 v9, s35, v6
    v_pk_mul_f32 v[110:111], v[8:9], v[110:111]
    v_cvt_pk_bf16_f32 v127, v110, v108
    v_cvt_pk_bf16_f32 v143, v111, v109
    s_add_u32 s26, s77, 23040
    buffer_load_dword v61, v20, s[36:39], s26 offen
    buffer_load_dword v94, v20, s[40:43], s26 offen
    s_waitcnt vmcnt(32)
    v_lshlrev_b32 v36, 16, v45
    v_and_b32 v37, s35, v45
    v_lshlrev_b32 v108, 16, v78
    v_and_b32 v109, s35, v78
    v_pk_mul_f32 v[8:9], v[38:39], v[30:31]
    v_cvt_pk_bf16_f32 v6, v8, v9
    v_lshlrev_b32 v8, 16, v6
    v_and_b32 v9, s35, v6
    v_pk_mul_f32 v[10:11], v[32:33], v[28:29]
    v_cvt_pk_bf16_f32 v6, v10, v11
    v_lshlrev_b32 v10, 16, v6
    v_and_b32 v11, s35, v6
    v_pk_add_f32 v[8:9], v[8:9], v[10:11]
    v_cvt_pk_bf16_f32 v6, v8, v9
    v_lshlrev_b32 v8, 16, v6
    v_and_b32 v9, s35, v6
    v_pk_mul_f32 v[10:11], v[34:35], v[26:27]
    v_cvt_pk_bf16_f32 v6, v10, v11
    v_lshlrev_b32 v10, 16, v6
    v_and_b32 v11, s35, v6
    v_pk_add_f32 v[8:9], v[8:9], v[10:11]
    v_cvt_pk_bf16_f32 v6, v8, v9
    v_lshlrev_b32 v8, 16, v6
    v_and_b32 v9, s35, v6
    v_pk_mul_f32 v[10:11], v[36:37], v[24:25]
    v_cvt_pk_bf16_f32 v6, v10, v11
    v_lshlrev_b32 v10, 16, v6
    v_and_b32 v11, s35, v6
    v_pk_add_f32 v[8:9], v[8:9], v[10:11]
    v_cvt_pk_bf16_f32 v6, v8, v9
    v_lshlrev_b32 v8, 16, v6
    v_and_b32 v9, s35, v6
    v_pk_mul_f32 v[108:109], v[8:9], v[108:109]
    s_add_u32 s26, s77, 24320
    buffer_load_dword v62, v20, s[36:39], s26 offen
    buffer_load_dword v95, v20, s[40:43], s26 offen
    s_waitcnt vmcnt(32)
    v_lshlrev_b32 v38, 16, v46
    v_and_b32 v39, s35, v46
    v_lshlrev_b32 v110, 16, v79
    v_and_b32 v111, s35, v79
    v_pk_mul_f32 v[8:9], v[32:33], v[30:31]
    v_cvt_pk_bf16_f32 v6, v8, v9
    v_lshlrev_b32 v8, 16, v6
    v_and_b32 v9, s35, v6
    v_pk_mul_f32 v[10:11], v[34:35], v[28:29]
    v_cvt_pk_bf16_f32 v6, v10, v11
    v_lshlrev_b32 v10, 16, v6
    v_and_b32 v11, s35, v6
    v_pk_add_f32 v[8:9], v[8:9], v[10:11]
    v_cvt_pk_bf16_f32 v6, v8, v9
    v_lshlrev_b32 v8, 16, v6
    v_and_b32 v9, s35, v6
    v_pk_mul_f32 v[10:11], v[36:37], v[26:27]
    v_cvt_pk_bf16_f32 v6, v10, v11
    v_lshlrev_b32 v10, 16, v6
    v_and_b32 v11, s35, v6
    v_pk_add_f32 v[8:9], v[8:9], v[10:11]
    v_cvt_pk_bf16_f32 v6, v8, v9
    v_lshlrev_b32 v8, 16, v6
    v_and_b32 v9, s35, v6
    v_pk_mul_f32 v[10:11], v[38:39], v[24:25]
    v_cvt_pk_bf16_f32 v6, v10, v11
    v_lshlrev_b32 v10, 16, v6
    v_and_b32 v11, s35, v6
    v_pk_add_f32 v[8:9], v[8:9], v[10:11]
    v_cvt_pk_bf16_f32 v6, v8, v9
    v_lshlrev_b32 v8, 16, v6
    v_and_b32 v9, s35, v6
    v_pk_mul_f32 v[110:111], v[8:9], v[110:111]
    v_cvt_pk_bf16_f32 v126, v110, v108
    v_cvt_pk_bf16_f32 v142, v111, v109
    s_add_u32 s26, s77, 25600
    buffer_load_dword v63, v20, s[36:39], s26 offen
    buffer_load_dword v96, v20, s[40:43], s26 offen
    s_waitcnt vmcnt(32)
    v_lshlrev_b32 v32, 16, v47
    v_and_b32 v33, s35, v47
    v_lshlrev_b32 v108, 16, v80
    v_and_b32 v109, s35, v80
    v_pk_mul_f32 v[8:9], v[34:35], v[30:31]
    v_cvt_pk_bf16_f32 v6, v8, v9
    v_lshlrev_b32 v8, 16, v6
    v_and_b32 v9, s35, v6
    v_pk_mul_f32 v[10:11], v[36:37], v[28:29]
    v_cvt_pk_bf16_f32 v6, v10, v11
    v_lshlrev_b32 v10, 16, v6
    v_and_b32 v11, s35, v6
    v_pk_add_f32 v[8:9], v[8:9], v[10:11]
    v_cvt_pk_bf16_f32 v6, v8, v9
    v_lshlrev_b32 v8, 16, v6
    v_and_b32 v9, s35, v6
    v_pk_mul_f32 v[10:11], v[38:39], v[26:27]
    v_cvt_pk_bf16_f32 v6, v10, v11
    v_lshlrev_b32 v10, 16, v6
    v_and_b32 v11, s35, v6
    v_pk_add_f32 v[8:9], v[8:9], v[10:11]
    v_cvt_pk_bf16_f32 v6, v8, v9
    v_lshlrev_b32 v8, 16, v6
    v_and_b32 v9, s35, v6
    v_pk_mul_f32 v[10:11], v[32:33], v[24:25]
    v_cvt_pk_bf16_f32 v6, v10, v11
    v_lshlrev_b32 v10, 16, v6
    v_and_b32 v11, s35, v6
    v_pk_add_f32 v[8:9], v[8:9], v[10:11]
    v_cvt_pk_bf16_f32 v6, v8, v9
    v_lshlrev_b32 v8, 16, v6
    v_and_b32 v9, s35, v6
    v_pk_mul_f32 v[108:109], v[8:9], v[108:109]
    s_add_u32 s26, s77, 26880
    buffer_load_dword v64, v20, s[36:39], s26 offen
    buffer_load_dword v97, v20, s[40:43], s26 offen
    s_waitcnt vmcnt(32)
    v_lshlrev_b32 v34, 16, v48
    v_and_b32 v35, s35, v48
    v_lshlrev_b32 v110, 16, v81
    v_and_b32 v111, s35, v81
    v_pk_mul_f32 v[8:9], v[36:37], v[30:31]
    v_cvt_pk_bf16_f32 v6, v8, v9
    v_lshlrev_b32 v8, 16, v6
    v_and_b32 v9, s35, v6
    v_pk_mul_f32 v[10:11], v[38:39], v[28:29]
    v_cvt_pk_bf16_f32 v6, v10, v11
    v_lshlrev_b32 v10, 16, v6
    v_and_b32 v11, s35, v6
    v_pk_add_f32 v[8:9], v[8:9], v[10:11]
    v_cvt_pk_bf16_f32 v6, v8, v9
    v_lshlrev_b32 v8, 16, v6
    v_and_b32 v9, s35, v6
    v_pk_mul_f32 v[10:11], v[32:33], v[26:27]
    v_cvt_pk_bf16_f32 v6, v10, v11
    v_lshlrev_b32 v10, 16, v6
    v_and_b32 v11, s35, v6
    v_pk_add_f32 v[8:9], v[8:9], v[10:11]
    v_cvt_pk_bf16_f32 v6, v8, v9
    v_lshlrev_b32 v8, 16, v6
    v_and_b32 v9, s35, v6
    v_pk_mul_f32 v[10:11], v[34:35], v[24:25]
    v_cvt_pk_bf16_f32 v6, v10, v11
    v_lshlrev_b32 v10, 16, v6
    v_and_b32 v11, s35, v6
    v_pk_add_f32 v[8:9], v[8:9], v[10:11]
    v_cvt_pk_bf16_f32 v6, v8, v9
    v_lshlrev_b32 v8, 16, v6
    v_and_b32 v9, s35, v6
    v_pk_mul_f32 v[110:111], v[8:9], v[110:111]
    v_cvt_pk_bf16_f32 v125, v110, v108
    v_cvt_pk_bf16_f32 v141, v111, v109
    s_add_u32 s26, s77, 28160
    buffer_load_dword v65, v20, s[36:39], s26 offen
    buffer_load_dword v98, v20, s[40:43], s26 offen
    s_waitcnt vmcnt(32)
    v_lshlrev_b32 v36, 16, v49
    v_and_b32 v37, s35, v49
    v_lshlrev_b32 v108, 16, v82
    v_and_b32 v109, s35, v82
    v_pk_mul_f32 v[8:9], v[38:39], v[30:31]
    v_cvt_pk_bf16_f32 v6, v8, v9
    v_lshlrev_b32 v8, 16, v6
    v_and_b32 v9, s35, v6
    v_pk_mul_f32 v[10:11], v[32:33], v[28:29]
    v_cvt_pk_bf16_f32 v6, v10, v11
    v_lshlrev_b32 v10, 16, v6
    v_and_b32 v11, s35, v6
    v_pk_add_f32 v[8:9], v[8:9], v[10:11]
    v_cvt_pk_bf16_f32 v6, v8, v9
    v_lshlrev_b32 v8, 16, v6
    v_and_b32 v9, s35, v6
    v_pk_mul_f32 v[10:11], v[34:35], v[26:27]
    v_cvt_pk_bf16_f32 v6, v10, v11
    v_lshlrev_b32 v10, 16, v6
    v_and_b32 v11, s35, v6
    v_pk_add_f32 v[8:9], v[8:9], v[10:11]
    v_cvt_pk_bf16_f32 v6, v8, v9
    v_lshlrev_b32 v8, 16, v6
    v_and_b32 v9, s35, v6
    v_pk_mul_f32 v[10:11], v[36:37], v[24:25]
    v_cvt_pk_bf16_f32 v6, v10, v11
    v_lshlrev_b32 v10, 16, v6
    v_and_b32 v11, s35, v6
    v_pk_add_f32 v[8:9], v[8:9], v[10:11]
    v_cvt_pk_bf16_f32 v6, v8, v9
    v_lshlrev_b32 v8, 16, v6
    v_and_b32 v9, s35, v6
    v_pk_mul_f32 v[108:109], v[8:9], v[108:109]
    s_add_u32 s26, s77, 29440
    buffer_load_dword v66, v20, s[36:39], s26 offen
    buffer_load_dword v99, v20, s[40:43], s26 offen
    s_waitcnt vmcnt(32)
    v_lshlrev_b32 v38, 16, v50
    v_and_b32 v39, s35, v50
    v_lshlrev_b32 v110, 16, v83
    v_and_b32 v111, s35, v83
    v_pk_mul_f32 v[8:9], v[32:33], v[30:31]
    v_cvt_pk_bf16_f32 v6, v8, v9
    v_lshlrev_b32 v8, 16, v6
    v_and_b32 v9, s35, v6
    v_pk_mul_f32 v[10:11], v[34:35], v[28:29]
    v_cvt_pk_bf16_f32 v6, v10, v11
    v_lshlrev_b32 v10, 16, v6
    v_and_b32 v11, s35, v6
    v_pk_add_f32 v[8:9], v[8:9], v[10:11]
    v_cvt_pk_bf16_f32 v6, v8, v9
    v_lshlrev_b32 v8, 16, v6
    v_and_b32 v9, s35, v6
    v_pk_mul_f32 v[10:11], v[36:37], v[26:27]
    v_cvt_pk_bf16_f32 v6, v10, v11
    v_lshlrev_b32 v10, 16, v6
    v_and_b32 v11, s35, v6
    v_pk_add_f32 v[8:9], v[8:9], v[10:11]
    v_cvt_pk_bf16_f32 v6, v8, v9
    v_lshlrev_b32 v8, 16, v6
    v_and_b32 v9, s35, v6
    v_pk_mul_f32 v[10:11], v[38:39], v[24:25]
    v_cvt_pk_bf16_f32 v6, v10, v11
    v_lshlrev_b32 v10, 16, v6
    v_and_b32 v11, s35, v6
    v_pk_add_f32 v[8:9], v[8:9], v[10:11]
    v_cvt_pk_bf16_f32 v6, v8, v9
    v_lshlrev_b32 v8, 16, v6
    v_and_b32 v9, s35, v6
    v_pk_mul_f32 v[110:111], v[8:9], v[110:111]
    v_cvt_pk_bf16_f32 v124, v110, v108
    v_cvt_pk_bf16_f32 v140, v111, v109
    s_add_u32 s26, s77, 30720
    buffer_load_dword v67, v20, s[36:39], s26 offen
    buffer_load_dword v100, v20, s[40:43], s26 offen
    s_waitcnt vmcnt(32)
    v_lshlrev_b32 v32, 16, v51
    v_and_b32 v33, s35, v51
    v_lshlrev_b32 v108, 16, v84
    v_and_b32 v109, s35, v84
    v_pk_mul_f32 v[8:9], v[34:35], v[30:31]
    v_cvt_pk_bf16_f32 v6, v8, v9
    v_lshlrev_b32 v8, 16, v6
    v_and_b32 v9, s35, v6
    v_pk_mul_f32 v[10:11], v[36:37], v[28:29]
    v_cvt_pk_bf16_f32 v6, v10, v11
    v_lshlrev_b32 v10, 16, v6
    v_and_b32 v11, s35, v6
    v_pk_add_f32 v[8:9], v[8:9], v[10:11]
    v_cvt_pk_bf16_f32 v6, v8, v9
    v_lshlrev_b32 v8, 16, v6
    v_and_b32 v9, s35, v6
    v_pk_mul_f32 v[10:11], v[38:39], v[26:27]
    v_cvt_pk_bf16_f32 v6, v10, v11
    v_lshlrev_b32 v10, 16, v6
    v_and_b32 v11, s35, v6
    v_pk_add_f32 v[8:9], v[8:9], v[10:11]
    v_cvt_pk_bf16_f32 v6, v8, v9
    v_lshlrev_b32 v8, 16, v6
    v_and_b32 v9, s35, v6
    v_pk_mul_f32 v[10:11], v[32:33], v[24:25]
    v_cvt_pk_bf16_f32 v6, v10, v11
    v_lshlrev_b32 v10, 16, v6
    v_and_b32 v11, s35, v6
    v_pk_add_f32 v[8:9], v[8:9], v[10:11]
    v_cvt_pk_bf16_f32 v6, v8, v9
    v_lshlrev_b32 v8, 16, v6
    v_and_b32 v9, s35, v6
    v_pk_mul_f32 v[108:109], v[8:9], v[108:109]
    s_add_u32 s26, s77, 32000
    buffer_load_dword v68, v20, s[36:39], s26 offen
    buffer_load_dword v101, v20, s[40:43], s26 offen
    s_waitcnt vmcnt(32)
    v_lshlrev_b32 v34, 16, v52
    v_and_b32 v35, s35, v52
    v_lshlrev_b32 v110, 16, v85
    v_and_b32 v111, s35, v85
    v_pk_mul_f32 v[8:9], v[36:37], v[30:31]
    v_cvt_pk_bf16_f32 v6, v8, v9
    v_lshlrev_b32 v8, 16, v6
    v_and_b32 v9, s35, v6
    v_pk_mul_f32 v[10:11], v[38:39], v[28:29]
    v_cvt_pk_bf16_f32 v6, v10, v11
    v_lshlrev_b32 v10, 16, v6
    v_and_b32 v11, s35, v6
    v_pk_add_f32 v[8:9], v[8:9], v[10:11]
    v_cvt_pk_bf16_f32 v6, v8, v9
    v_lshlrev_b32 v8, 16, v6
    v_and_b32 v9, s35, v6
    v_pk_mul_f32 v[10:11], v[32:33], v[26:27]
    v_cvt_pk_bf16_f32 v6, v10, v11
    v_lshlrev_b32 v10, 16, v6
    v_and_b32 v11, s35, v6
    v_pk_add_f32 v[8:9], v[8:9], v[10:11]
    v_cvt_pk_bf16_f32 v6, v8, v9
    v_lshlrev_b32 v8, 16, v6
    v_and_b32 v9, s35, v6
    v_pk_mul_f32 v[10:11], v[34:35], v[24:25]
    v_cvt_pk_bf16_f32 v6, v10, v11
    v_lshlrev_b32 v10, 16, v6
    v_and_b32 v11, s35, v6
    v_pk_add_f32 v[8:9], v[8:9], v[10:11]
    v_cvt_pk_bf16_f32 v6, v8, v9
    v_lshlrev_b32 v8, 16, v6
    v_and_b32 v9, s35, v6
    v_pk_mul_f32 v[110:111], v[8:9], v[110:111]
    v_cvt_pk_bf16_f32 v123, v110, v108
    v_cvt_pk_bf16_f32 v139, v111, v109
    s_add_u32 s26, s77, 33280
    buffer_load_dword v69, v20, s[36:39], s26 offen
    buffer_load_dword v102, v20, s[40:43], s26 offen
    s_waitcnt vmcnt(32)
    v_lshlrev_b32 v36, 16, v53
    v_and_b32 v37, s35, v53
    v_lshlrev_b32 v108, 16, v86
    v_and_b32 v109, s35, v86
    v_pk_mul_f32 v[8:9], v[38:39], v[30:31]
    v_cvt_pk_bf16_f32 v6, v8, v9
    v_lshlrev_b32 v8, 16, v6
    v_and_b32 v9, s35, v6
    v_pk_mul_f32 v[10:11], v[32:33], v[28:29]
    v_cvt_pk_bf16_f32 v6, v10, v11
    v_lshlrev_b32 v10, 16, v6
    v_and_b32 v11, s35, v6
    v_pk_add_f32 v[8:9], v[8:9], v[10:11]
    v_cvt_pk_bf16_f32 v6, v8, v9
    v_lshlrev_b32 v8, 16, v6
    v_and_b32 v9, s35, v6
    v_pk_mul_f32 v[10:11], v[34:35], v[26:27]
    v_cvt_pk_bf16_f32 v6, v10, v11
    v_lshlrev_b32 v10, 16, v6
    v_and_b32 v11, s35, v6
    v_pk_add_f32 v[8:9], v[8:9], v[10:11]
    v_cvt_pk_bf16_f32 v6, v8, v9
    v_lshlrev_b32 v8, 16, v6
    v_and_b32 v9, s35, v6
    v_pk_mul_f32 v[10:11], v[36:37], v[24:25]
    v_cvt_pk_bf16_f32 v6, v10, v11
    v_lshlrev_b32 v10, 16, v6
    v_and_b32 v11, s35, v6
    v_pk_add_f32 v[8:9], v[8:9], v[10:11]
    v_cvt_pk_bf16_f32 v6, v8, v9
    v_lshlrev_b32 v8, 16, v6
    v_and_b32 v9, s35, v6
    v_pk_mul_f32 v[108:109], v[8:9], v[108:109]
    s_add_u32 s26, s77, 34560
    buffer_load_dword v70, v20, s[36:39], s26 offen
    buffer_load_dword v103, v20, s[40:43], s26 offen
    s_waitcnt vmcnt(32)
    v_lshlrev_b32 v38, 16, v54
    v_and_b32 v39, s35, v54
    v_lshlrev_b32 v110, 16, v87
    v_and_b32 v111, s35, v87
    v_pk_mul_f32 v[8:9], v[32:33], v[30:31]
    v_cvt_pk_bf16_f32 v6, v8, v9
    v_lshlrev_b32 v8, 16, v6
    v_and_b32 v9, s35, v6
    v_pk_mul_f32 v[10:11], v[34:35], v[28:29]
    v_cvt_pk_bf16_f32 v6, v10, v11
    v_lshlrev_b32 v10, 16, v6
    v_and_b32 v11, s35, v6
    v_pk_add_f32 v[8:9], v[8:9], v[10:11]
    v_cvt_pk_bf16_f32 v6, v8, v9
    v_lshlrev_b32 v8, 16, v6
    v_and_b32 v9, s35, v6
    v_pk_mul_f32 v[10:11], v[36:37], v[26:27]
    v_cvt_pk_bf16_f32 v6, v10, v11
    v_lshlrev_b32 v10, 16, v6
    v_and_b32 v11, s35, v6
    v_pk_add_f32 v[8:9], v[8:9], v[10:11]
    v_cvt_pk_bf16_f32 v6, v8, v9
    v_lshlrev_b32 v8, 16, v6
    v_and_b32 v9, s35, v6
    v_pk_mul_f32 v[10:11], v[38:39], v[24:25]
    v_cvt_pk_bf16_f32 v6, v10, v11
    v_lshlrev_b32 v10, 16, v6
    v_and_b32 v11, s35, v6
    v_pk_add_f32 v[8:9], v[8:9], v[10:11]
    v_cvt_pk_bf16_f32 v6, v8, v9
    v_lshlrev_b32 v8, 16, v6
    v_and_b32 v9, s35, v6
    v_pk_mul_f32 v[110:111], v[8:9], v[110:111]
    v_cvt_pk_bf16_f32 v122, v110, v108
    v_cvt_pk_bf16_f32 v138, v111, v109
    s_add_u32 s26, s77, 35840
    buffer_load_dword v71, v20, s[36:39], s26 offen
    buffer_load_dword v104, v20, s[40:43], s26 offen
    s_waitcnt vmcnt(32)
    v_lshlrev_b32 v32, 16, v55
    v_and_b32 v33, s35, v55
    v_lshlrev_b32 v108, 16, v88
    v_and_b32 v109, s35, v88
    v_pk_mul_f32 v[8:9], v[34:35], v[30:31]
    v_cvt_pk_bf16_f32 v6, v8, v9
    v_lshlrev_b32 v8, 16, v6
    v_and_b32 v9, s35, v6
    v_pk_mul_f32 v[10:11], v[36:37], v[28:29]
    v_cvt_pk_bf16_f32 v6, v10, v11
    v_lshlrev_b32 v10, 16, v6
    v_and_b32 v11, s35, v6
    v_pk_add_f32 v[8:9], v[8:9], v[10:11]
    v_cvt_pk_bf16_f32 v6, v8, v9
    v_lshlrev_b32 v8, 16, v6
    v_and_b32 v9, s35, v6
    v_pk_mul_f32 v[10:11], v[38:39], v[26:27]
    v_cvt_pk_bf16_f32 v6, v10, v11
    v_lshlrev_b32 v10, 16, v6
    v_and_b32 v11, s35, v6
    v_pk_add_f32 v[8:9], v[8:9], v[10:11]
    v_cvt_pk_bf16_f32 v6, v8, v9
    v_lshlrev_b32 v8, 16, v6
    v_and_b32 v9, s35, v6
    v_pk_mul_f32 v[10:11], v[32:33], v[24:25]
    v_cvt_pk_bf16_f32 v6, v10, v11
    v_lshlrev_b32 v10, 16, v6
    v_and_b32 v11, s35, v6
    v_pk_add_f32 v[8:9], v[8:9], v[10:11]
    v_cvt_pk_bf16_f32 v6, v8, v9
    v_lshlrev_b32 v8, 16, v6
    v_and_b32 v9, s35, v6
    v_pk_mul_f32 v[108:109], v[8:9], v[108:109]
    s_add_u32 s26, s77, 37120
    buffer_load_dword v72, v20, s[36:39], s26 offen
    buffer_load_dword v105, v20, s[40:43], s26 offen
    s_waitcnt vmcnt(32)
    v_lshlrev_b32 v34, 16, v56
    v_and_b32 v35, s35, v56
    v_lshlrev_b32 v110, 16, v89
    v_and_b32 v111, s35, v89
    v_pk_mul_f32 v[8:9], v[36:37], v[30:31]
    v_cvt_pk_bf16_f32 v6, v8, v9
    v_lshlrev_b32 v8, 16, v6
    v_and_b32 v9, s35, v6
    v_pk_mul_f32 v[10:11], v[38:39], v[28:29]
    v_cvt_pk_bf16_f32 v6, v10, v11
    v_lshlrev_b32 v10, 16, v6
    v_and_b32 v11, s35, v6
    v_pk_add_f32 v[8:9], v[8:9], v[10:11]
    v_cvt_pk_bf16_f32 v6, v8, v9
    v_lshlrev_b32 v8, 16, v6
    v_and_b32 v9, s35, v6
    v_pk_mul_f32 v[10:11], v[32:33], v[26:27]
    v_cvt_pk_bf16_f32 v6, v10, v11
    v_lshlrev_b32 v10, 16, v6
    v_and_b32 v11, s35, v6
    v_pk_add_f32 v[8:9], v[8:9], v[10:11]
    v_cvt_pk_bf16_f32 v6, v8, v9
    v_lshlrev_b32 v8, 16, v6
    v_and_b32 v9, s35, v6
    v_pk_mul_f32 v[10:11], v[34:35], v[24:25]
    v_cvt_pk_bf16_f32 v6, v10, v11
    v_lshlrev_b32 v10, 16, v6
    v_and_b32 v11, s35, v6
    v_pk_add_f32 v[8:9], v[8:9], v[10:11]
    v_cvt_pk_bf16_f32 v6, v8, v9
    v_lshlrev_b32 v8, 16, v6
    v_and_b32 v9, s35, v6
    v_pk_mul_f32 v[110:111], v[8:9], v[110:111]
    v_cvt_pk_bf16_f32 v121, v110, v108
    v_cvt_pk_bf16_f32 v137, v111, v109
    s_add_u32 s26, s77, 38400
    buffer_load_dword v73, v20, s[36:39], s26 offen
    buffer_load_dword v106, v20, s[40:43], s26 offen
    s_waitcnt vmcnt(32)
    v_lshlrev_b32 v36, 16, v57
    v_and_b32 v37, s35, v57
    v_lshlrev_b32 v108, 16, v90
    v_and_b32 v109, s35, v90
    v_pk_mul_f32 v[8:9], v[38:39], v[30:31]
    v_cvt_pk_bf16_f32 v6, v8, v9
    v_lshlrev_b32 v8, 16, v6
    v_and_b32 v9, s35, v6
    v_pk_mul_f32 v[10:11], v[32:33], v[28:29]
    v_cvt_pk_bf16_f32 v6, v10, v11
    v_lshlrev_b32 v10, 16, v6
    v_and_b32 v11, s35, v6
    v_pk_add_f32 v[8:9], v[8:9], v[10:11]
    v_cvt_pk_bf16_f32 v6, v8, v9
    v_lshlrev_b32 v8, 16, v6
    v_and_b32 v9, s35, v6
    v_pk_mul_f32 v[10:11], v[34:35], v[26:27]
    v_cvt_pk_bf16_f32 v6, v10, v11
    v_lshlrev_b32 v10, 16, v6
    v_and_b32 v11, s35, v6
    v_pk_add_f32 v[8:9], v[8:9], v[10:11]
    v_cvt_pk_bf16_f32 v6, v8, v9
    v_lshlrev_b32 v8, 16, v6
    v_and_b32 v9, s35, v6
    v_pk_mul_f32 v[10:11], v[36:37], v[24:25]
    v_cvt_pk_bf16_f32 v6, v10, v11
    v_lshlrev_b32 v10, 16, v6
    v_and_b32 v11, s35, v6
    v_pk_add_f32 v[8:9], v[8:9], v[10:11]
    v_cvt_pk_bf16_f32 v6, v8, v9
    v_lshlrev_b32 v8, 16, v6
    v_and_b32 v9, s35, v6
    v_pk_mul_f32 v[108:109], v[8:9], v[108:109]
    s_add_u32 s26, s77, 39680
    buffer_load_dword v74, v20, s[36:39], s26 offen
    buffer_load_dword v107, v20, s[40:43], s26 offen
    s_waitcnt vmcnt(32)
    v_lshlrev_b32 v38, 16, v58
    v_and_b32 v39, s35, v58
    v_lshlrev_b32 v110, 16, v91
    v_and_b32 v111, s35, v91
    v_pk_mul_f32 v[8:9], v[32:33], v[30:31]
    v_cvt_pk_bf16_f32 v6, v8, v9
    v_lshlrev_b32 v8, 16, v6
    v_and_b32 v9, s35, v6
    v_pk_mul_f32 v[10:11], v[34:35], v[28:29]
    v_cvt_pk_bf16_f32 v6, v10, v11
    v_lshlrev_b32 v10, 16, v6
    v_and_b32 v11, s35, v6
    v_pk_add_f32 v[8:9], v[8:9], v[10:11]
    v_cvt_pk_bf16_f32 v6, v8, v9
    v_lshlrev_b32 v8, 16, v6
    v_and_b32 v9, s35, v6
    v_pk_mul_f32 v[10:11], v[36:37], v[26:27]
    v_cvt_pk_bf16_f32 v6, v10, v11
    v_lshlrev_b32 v10, 16, v6
    v_and_b32 v11, s35, v6
    v_pk_add_f32 v[8:9], v[8:9], v[10:11]
    v_cvt_pk_bf16_f32 v6, v8, v9
    v_lshlrev_b32 v8, 16, v6
    v_and_b32 v9, s35, v6
    v_pk_mul_f32 v[10:11], v[38:39], v[24:25]
    v_cvt_pk_bf16_f32 v6, v10, v11
    v_lshlrev_b32 v10, 16, v6
    v_and_b32 v11, s35, v6
    v_pk_add_f32 v[8:9], v[8:9], v[10:11]
    v_cvt_pk_bf16_f32 v6, v8, v9
    v_lshlrev_b32 v8, 16, v6
    v_and_b32 v9, s35, v6
    v_pk_mul_f32 v[110:111], v[8:9], v[110:111]
    v_cvt_pk_bf16_f32 v120, v110, v108
    v_cvt_pk_bf16_f32 v136, v111, v109
    s_waitcnt vmcnt(30)
    v_lshlrev_b32 v32, 16, v59
    v_and_b32 v33, s35, v59
    v_lshlrev_b32 v108, 16, v92
    v_and_b32 v109, s35, v92
    v_pk_mul_f32 v[8:9], v[34:35], v[30:31]
    v_cvt_pk_bf16_f32 v6, v8, v9
    v_lshlrev_b32 v8, 16, v6
    v_and_b32 v9, s35, v6
    v_pk_mul_f32 v[10:11], v[36:37], v[28:29]
    v_cvt_pk_bf16_f32 v6, v10, v11
    v_lshlrev_b32 v10, 16, v6
    v_and_b32 v11, s35, v6
    v_pk_add_f32 v[8:9], v[8:9], v[10:11]
    v_cvt_pk_bf16_f32 v6, v8, v9
    v_lshlrev_b32 v8, 16, v6
    v_and_b32 v9, s35, v6
    v_pk_mul_f32 v[10:11], v[38:39], v[26:27]
    v_cvt_pk_bf16_f32 v6, v10, v11
    v_lshlrev_b32 v10, 16, v6
    v_and_b32 v11, s35, v6
    v_pk_add_f32 v[8:9], v[8:9], v[10:11]
    v_cvt_pk_bf16_f32 v6, v8, v9
    v_lshlrev_b32 v8, 16, v6
    v_and_b32 v9, s35, v6
    v_pk_mul_f32 v[10:11], v[32:33], v[24:25]
    v_cvt_pk_bf16_f32 v6, v10, v11
    v_lshlrev_b32 v10, 16, v6
    v_and_b32 v11, s35, v6
    v_pk_add_f32 v[8:9], v[8:9], v[10:11]
    v_cvt_pk_bf16_f32 v6, v8, v9
    v_lshlrev_b32 v8, 16, v6
    v_and_b32 v9, s35, v6
    v_pk_mul_f32 v[108:109], v[8:9], v[108:109]
    s_waitcnt vmcnt(28)
    v_lshlrev_b32 v34, 16, v60
    v_and_b32 v35, s35, v60
    v_lshlrev_b32 v110, 16, v93
    v_and_b32 v111, s35, v93
    v_pk_mul_f32 v[8:9], v[36:37], v[30:31]
    v_cvt_pk_bf16_f32 v6, v8, v9
    v_lshlrev_b32 v8, 16, v6
    v_and_b32 v9, s35, v6
    v_pk_mul_f32 v[10:11], v[38:39], v[28:29]
    v_cvt_pk_bf16_f32 v6, v10, v11
    v_lshlrev_b32 v10, 16, v6
    v_and_b32 v11, s35, v6
    v_pk_add_f32 v[8:9], v[8:9], v[10:11]
    v_cvt_pk_bf16_f32 v6, v8, v9
    v_lshlrev_b32 v8, 16, v6
    v_and_b32 v9, s35, v6
    v_pk_mul_f32 v[10:11], v[32:33], v[26:27]
    v_cvt_pk_bf16_f32 v6, v10, v11
    v_lshlrev_b32 v10, 16, v6
    v_and_b32 v11, s35, v6
    v_pk_add_f32 v[8:9], v[8:9], v[10:11]
    v_cvt_pk_bf16_f32 v6, v8, v9
    v_lshlrev_b32 v8, 16, v6
    v_and_b32 v9, s35, v6
    v_pk_mul_f32 v[10:11], v[34:35], v[24:25]
    v_cvt_pk_bf16_f32 v6, v10, v11
    v_lshlrev_b32 v10, 16, v6
    v_and_b32 v11, s35, v6
    v_pk_add_f32 v[8:9], v[8:9], v[10:11]
    v_cvt_pk_bf16_f32 v6, v8, v9
    v_lshlrev_b32 v8, 16, v6
    v_and_b32 v9, s35, v6
    v_pk_mul_f32 v[110:111], v[8:9], v[110:111]
    v_cvt_pk_bf16_f32 v119, v110, v108
    v_cvt_pk_bf16_f32 v135, v111, v109
    s_waitcnt vmcnt(26)
    v_lshlrev_b32 v36, 16, v61
    v_and_b32 v37, s35, v61
    v_lshlrev_b32 v108, 16, v94
    v_and_b32 v109, s35, v94
    v_pk_mul_f32 v[8:9], v[38:39], v[30:31]
    v_cvt_pk_bf16_f32 v6, v8, v9
    v_lshlrev_b32 v8, 16, v6
    v_and_b32 v9, s35, v6
    v_pk_mul_f32 v[10:11], v[32:33], v[28:29]
    v_cvt_pk_bf16_f32 v6, v10, v11
    v_lshlrev_b32 v10, 16, v6
    v_and_b32 v11, s35, v6
    v_pk_add_f32 v[8:9], v[8:9], v[10:11]
    v_cvt_pk_bf16_f32 v6, v8, v9
    v_lshlrev_b32 v8, 16, v6
    v_and_b32 v9, s35, v6
    v_pk_mul_f32 v[10:11], v[34:35], v[26:27]
    v_cvt_pk_bf16_f32 v6, v10, v11
    v_lshlrev_b32 v10, 16, v6
    v_and_b32 v11, s35, v6
    v_pk_add_f32 v[8:9], v[8:9], v[10:11]
    v_cvt_pk_bf16_f32 v6, v8, v9
    v_lshlrev_b32 v8, 16, v6
    v_and_b32 v9, s35, v6
    v_pk_mul_f32 v[10:11], v[36:37], v[24:25]
    v_cvt_pk_bf16_f32 v6, v10, v11
    v_lshlrev_b32 v10, 16, v6
    v_and_b32 v11, s35, v6
    v_pk_add_f32 v[8:9], v[8:9], v[10:11]
    v_cvt_pk_bf16_f32 v6, v8, v9
    v_lshlrev_b32 v8, 16, v6
    v_and_b32 v9, s35, v6
    v_pk_mul_f32 v[108:109], v[8:9], v[108:109]
    s_waitcnt vmcnt(24)
    v_lshlrev_b32 v38, 16, v62
    v_and_b32 v39, s35, v62
    v_lshlrev_b32 v110, 16, v95
    v_and_b32 v111, s35, v95
    v_pk_mul_f32 v[8:9], v[32:33], v[30:31]
    v_cvt_pk_bf16_f32 v6, v8, v9
    v_lshlrev_b32 v8, 16, v6
    v_and_b32 v9, s35, v6
    v_pk_mul_f32 v[10:11], v[34:35], v[28:29]
    v_cvt_pk_bf16_f32 v6, v10, v11
    v_lshlrev_b32 v10, 16, v6
    v_and_b32 v11, s35, v6
    v_pk_add_f32 v[8:9], v[8:9], v[10:11]
    v_cvt_pk_bf16_f32 v6, v8, v9
    v_lshlrev_b32 v8, 16, v6
    v_and_b32 v9, s35, v6
    v_pk_mul_f32 v[10:11], v[36:37], v[26:27]
    v_cvt_pk_bf16_f32 v6, v10, v11
    v_lshlrev_b32 v10, 16, v6
    v_and_b32 v11, s35, v6
    v_pk_add_f32 v[8:9], v[8:9], v[10:11]
    v_cvt_pk_bf16_f32 v6, v8, v9
    v_lshlrev_b32 v8, 16, v6
    v_and_b32 v9, s35, v6
    v_pk_mul_f32 v[10:11], v[38:39], v[24:25]
    v_cvt_pk_bf16_f32 v6, v10, v11
    v_lshlrev_b32 v10, 16, v6
    v_and_b32 v11, s35, v6
    v_pk_add_f32 v[8:9], v[8:9], v[10:11]
    v_cvt_pk_bf16_f32 v6, v8, v9
    v_lshlrev_b32 v8, 16, v6
    v_and_b32 v9, s35, v6
    v_pk_mul_f32 v[110:111], v[8:9], v[110:111]
    v_cvt_pk_bf16_f32 v118, v110, v108
    v_cvt_pk_bf16_f32 v134, v111, v109
    s_waitcnt vmcnt(22)
    v_lshlrev_b32 v32, 16, v63
    v_and_b32 v33, s35, v63
    v_lshlrev_b32 v108, 16, v96
    v_and_b32 v109, s35, v96
    v_pk_mul_f32 v[8:9], v[34:35], v[30:31]
    v_cvt_pk_bf16_f32 v6, v8, v9
    v_lshlrev_b32 v8, 16, v6
    v_and_b32 v9, s35, v6
    v_pk_mul_f32 v[10:11], v[36:37], v[28:29]
    v_cvt_pk_bf16_f32 v6, v10, v11
    v_lshlrev_b32 v10, 16, v6
    v_and_b32 v11, s35, v6
    v_pk_add_f32 v[8:9], v[8:9], v[10:11]
    v_cvt_pk_bf16_f32 v6, v8, v9
    v_lshlrev_b32 v8, 16, v6
    v_and_b32 v9, s35, v6
    v_pk_mul_f32 v[10:11], v[38:39], v[26:27]
    v_cvt_pk_bf16_f32 v6, v10, v11
    v_lshlrev_b32 v10, 16, v6
    v_and_b32 v11, s35, v6
    v_pk_add_f32 v[8:9], v[8:9], v[10:11]
    v_cvt_pk_bf16_f32 v6, v8, v9
    v_lshlrev_b32 v8, 16, v6
    v_and_b32 v9, s35, v6
    v_pk_mul_f32 v[10:11], v[32:33], v[24:25]
    v_cvt_pk_bf16_f32 v6, v10, v11
    v_lshlrev_b32 v10, 16, v6
    v_and_b32 v11, s35, v6
    v_pk_add_f32 v[8:9], v[8:9], v[10:11]
    v_cvt_pk_bf16_f32 v6, v8, v9
    v_lshlrev_b32 v8, 16, v6
    v_and_b32 v9, s35, v6
    v_pk_mul_f32 v[108:109], v[8:9], v[108:109]
    s_waitcnt vmcnt(20)
    v_lshlrev_b32 v34, 16, v64
    v_and_b32 v35, s35, v64
    v_lshlrev_b32 v110, 16, v97
    v_and_b32 v111, s35, v97
    v_pk_mul_f32 v[8:9], v[36:37], v[30:31]
    v_cvt_pk_bf16_f32 v6, v8, v9
    v_lshlrev_b32 v8, 16, v6
    v_and_b32 v9, s35, v6
    v_pk_mul_f32 v[10:11], v[38:39], v[28:29]
    v_cvt_pk_bf16_f32 v6, v10, v11
    v_lshlrev_b32 v10, 16, v6
    v_and_b32 v11, s35, v6
    v_pk_add_f32 v[8:9], v[8:9], v[10:11]
    v_cvt_pk_bf16_f32 v6, v8, v9
    v_lshlrev_b32 v8, 16, v6
    v_and_b32 v9, s35, v6
    v_pk_mul_f32 v[10:11], v[32:33], v[26:27]
    v_cvt_pk_bf16_f32 v6, v10, v11
    v_lshlrev_b32 v10, 16, v6
    v_and_b32 v11, s35, v6
    v_pk_add_f32 v[8:9], v[8:9], v[10:11]
    v_cvt_pk_bf16_f32 v6, v8, v9
    v_lshlrev_b32 v8, 16, v6
    v_and_b32 v9, s35, v6
    v_pk_mul_f32 v[10:11], v[34:35], v[24:25]
    v_cvt_pk_bf16_f32 v6, v10, v11
    v_lshlrev_b32 v10, 16, v6
    v_and_b32 v11, s35, v6
    v_pk_add_f32 v[8:9], v[8:9], v[10:11]
    v_cvt_pk_bf16_f32 v6, v8, v9
    v_lshlrev_b32 v8, 16, v6
    v_and_b32 v9, s35, v6
    v_pk_mul_f32 v[110:111], v[8:9], v[110:111]
    v_cvt_pk_bf16_f32 v117, v110, v108
    v_cvt_pk_bf16_f32 v133, v111, v109
    s_waitcnt vmcnt(18)
    v_lshlrev_b32 v36, 16, v65
    v_and_b32 v37, s35, v65
    v_lshlrev_b32 v108, 16, v98
    v_and_b32 v109, s35, v98
    v_pk_mul_f32 v[8:9], v[38:39], v[30:31]
    v_cvt_pk_bf16_f32 v6, v8, v9
    v_lshlrev_b32 v8, 16, v6
    v_and_b32 v9, s35, v6
    v_pk_mul_f32 v[10:11], v[32:33], v[28:29]
    v_cvt_pk_bf16_f32 v6, v10, v11
    v_lshlrev_b32 v10, 16, v6
    v_and_b32 v11, s35, v6
    v_pk_add_f32 v[8:9], v[8:9], v[10:11]
    v_cvt_pk_bf16_f32 v6, v8, v9
    v_lshlrev_b32 v8, 16, v6
    v_and_b32 v9, s35, v6
    v_pk_mul_f32 v[10:11], v[34:35], v[26:27]
    v_cvt_pk_bf16_f32 v6, v10, v11
    v_lshlrev_b32 v10, 16, v6
    v_and_b32 v11, s35, v6
    v_pk_add_f32 v[8:9], v[8:9], v[10:11]
    v_cvt_pk_bf16_f32 v6, v8, v9
    v_lshlrev_b32 v8, 16, v6
    v_and_b32 v9, s35, v6
    v_pk_mul_f32 v[10:11], v[36:37], v[24:25]
    v_cvt_pk_bf16_f32 v6, v10, v11
    v_lshlrev_b32 v10, 16, v6
    v_and_b32 v11, s35, v6
    v_pk_add_f32 v[8:9], v[8:9], v[10:11]
    v_cvt_pk_bf16_f32 v6, v8, v9
    v_lshlrev_b32 v8, 16, v6
    v_and_b32 v9, s35, v6
    v_pk_mul_f32 v[108:109], v[8:9], v[108:109]
    s_waitcnt vmcnt(16)
    v_lshlrev_b32 v38, 16, v66
    v_and_b32 v39, s35, v66
    v_lshlrev_b32 v110, 16, v99
    v_and_b32 v111, s35, v99
    v_pk_mul_f32 v[8:9], v[32:33], v[30:31]
    v_cvt_pk_bf16_f32 v6, v8, v9
    v_lshlrev_b32 v8, 16, v6
    v_and_b32 v9, s35, v6
    v_pk_mul_f32 v[10:11], v[34:35], v[28:29]
    v_cvt_pk_bf16_f32 v6, v10, v11
    v_lshlrev_b32 v10, 16, v6
    v_and_b32 v11, s35, v6
    v_pk_add_f32 v[8:9], v[8:9], v[10:11]
    v_cvt_pk_bf16_f32 v6, v8, v9
    v_lshlrev_b32 v8, 16, v6
    v_and_b32 v9, s35, v6
    v_pk_mul_f32 v[10:11], v[36:37], v[26:27]
    v_cvt_pk_bf16_f32 v6, v10, v11
    v_lshlrev_b32 v10, 16, v6
    v_and_b32 v11, s35, v6
    v_pk_add_f32 v[8:9], v[8:9], v[10:11]
    v_cvt_pk_bf16_f32 v6, v8, v9
    v_lshlrev_b32 v8, 16, v6
    v_and_b32 v9, s35, v6
    v_pk_mul_f32 v[10:11], v[38:39], v[24:25]
    v_cvt_pk_bf16_f32 v6, v10, v11
    v_lshlrev_b32 v10, 16, v6
    v_and_b32 v11, s35, v6
    v_pk_add_f32 v[8:9], v[8:9], v[10:11]
    v_cvt_pk_bf16_f32 v6, v8, v9
    v_lshlrev_b32 v8, 16, v6
    v_and_b32 v9, s35, v6
    v_pk_mul_f32 v[110:111], v[8:9], v[110:111]
    v_cvt_pk_bf16_f32 v116, v110, v108
    v_cvt_pk_bf16_f32 v132, v111, v109
    s_waitcnt vmcnt(14)
    v_lshlrev_b32 v32, 16, v67
    v_and_b32 v33, s35, v67
    v_lshlrev_b32 v108, 16, v100
    v_and_b32 v109, s35, v100
    v_pk_mul_f32 v[8:9], v[34:35], v[30:31]
    v_cvt_pk_bf16_f32 v6, v8, v9
    v_lshlrev_b32 v8, 16, v6
    v_and_b32 v9, s35, v6
    v_pk_mul_f32 v[10:11], v[36:37], v[28:29]
    v_cvt_pk_bf16_f32 v6, v10, v11
    v_lshlrev_b32 v10, 16, v6
    v_and_b32 v11, s35, v6
    v_pk_add_f32 v[8:9], v[8:9], v[10:11]
    v_cvt_pk_bf16_f32 v6, v8, v9
    v_lshlrev_b32 v8, 16, v6
    v_and_b32 v9, s35, v6
    v_pk_mul_f32 v[10:11], v[38:39], v[26:27]
    v_cvt_pk_bf16_f32 v6, v10, v11
    v_lshlrev_b32 v10, 16, v6
    v_and_b32 v11, s35, v6
    v_pk_add_f32 v[8:9], v[8:9], v[10:11]
    v_cvt_pk_bf16_f32 v6, v8, v9
    v_lshlrev_b32 v8, 16, v6
    v_and_b32 v9, s35, v6
    v_pk_mul_f32 v[10:11], v[32:33], v[24:25]
    v_cvt_pk_bf16_f32 v6, v10, v11
    v_lshlrev_b32 v10, 16, v6
    v_and_b32 v11, s35, v6
    v_pk_add_f32 v[8:9], v[8:9], v[10:11]
    v_cvt_pk_bf16_f32 v6, v8, v9
    v_lshlrev_b32 v8, 16, v6
    v_and_b32 v9, s35, v6
    v_pk_mul_f32 v[108:109], v[8:9], v[108:109]
    s_waitcnt vmcnt(12)
    v_lshlrev_b32 v34, 16, v68
    v_and_b32 v35, s35, v68
    v_lshlrev_b32 v110, 16, v101
    v_and_b32 v111, s35, v101
    v_pk_mul_f32 v[8:9], v[36:37], v[30:31]
    v_cvt_pk_bf16_f32 v6, v8, v9
    v_lshlrev_b32 v8, 16, v6
    v_and_b32 v9, s35, v6
    v_pk_mul_f32 v[10:11], v[38:39], v[28:29]
    v_cvt_pk_bf16_f32 v6, v10, v11
    v_lshlrev_b32 v10, 16, v6
    v_and_b32 v11, s35, v6
    v_pk_add_f32 v[8:9], v[8:9], v[10:11]
    v_cvt_pk_bf16_f32 v6, v8, v9
    v_lshlrev_b32 v8, 16, v6
    v_and_b32 v9, s35, v6
    v_pk_mul_f32 v[10:11], v[32:33], v[26:27]
    v_cvt_pk_bf16_f32 v6, v10, v11
    v_lshlrev_b32 v10, 16, v6
    v_and_b32 v11, s35, v6
    v_pk_add_f32 v[8:9], v[8:9], v[10:11]
    v_cvt_pk_bf16_f32 v6, v8, v9
    v_lshlrev_b32 v8, 16, v6
    v_and_b32 v9, s35, v6
    v_pk_mul_f32 v[10:11], v[34:35], v[24:25]
    v_cvt_pk_bf16_f32 v6, v10, v11
    v_lshlrev_b32 v10, 16, v6
    v_and_b32 v11, s35, v6
    v_pk_add_f32 v[8:9], v[8:9], v[10:11]
    v_cvt_pk_bf16_f32 v6, v8, v9
    v_lshlrev_b32 v8, 16, v6
    v_and_b32 v9, s35, v6
    v_pk_mul_f32 v[110:111], v[8:9], v[110:111]
    v_cvt_pk_bf16_f32 v115, v110, v108
    v_cvt_pk_bf16_f32 v131, v111, v109
    s_waitcnt vmcnt(10)
    v_lshlrev_b32 v36, 16, v69
    v_and_b32 v37, s35, v69
    v_lshlrev_b32 v108, 16, v102
    v_and_b32 v109, s35, v102
    v_pk_mul_f32 v[8:9], v[38:39], v[30:31]
    v_cvt_pk_bf16_f32 v6, v8, v9
    v_lshlrev_b32 v8, 16, v6
    v_and_b32 v9, s35, v6
    v_pk_mul_f32 v[10:11], v[32:33], v[28:29]
    v_cvt_pk_bf16_f32 v6, v10, v11
    v_lshlrev_b32 v10, 16, v6
    v_and_b32 v11, s35, v6
    v_pk_add_f32 v[8:9], v[8:9], v[10:11]
    v_cvt_pk_bf16_f32 v6, v8, v9
    v_lshlrev_b32 v8, 16, v6
    v_and_b32 v9, s35, v6
    v_pk_mul_f32 v[10:11], v[34:35], v[26:27]
    v_cvt_pk_bf16_f32 v6, v10, v11
    v_lshlrev_b32 v10, 16, v6
    v_and_b32 v11, s35, v6
    v_pk_add_f32 v[8:9], v[8:9], v[10:11]
    v_cvt_pk_bf16_f32 v6, v8, v9
    v_lshlrev_b32 v8, 16, v6
    v_and_b32 v9, s35, v6
    v_pk_mul_f32 v[10:11], v[36:37], v[24:25]
    v_cvt_pk_bf16_f32 v6, v10, v11
    v_lshlrev_b32 v10, 16, v6
    v_and_b32 v11, s35, v6
    v_pk_add_f32 v[8:9], v[8:9], v[10:11]
    v_cvt_pk_bf16_f32 v6, v8, v9
    v_lshlrev_b32 v8, 16, v6
    v_and_b32 v9, s35, v6
    v_pk_mul_f32 v[108:109], v[8:9], v[108:109]
    s_waitcnt vmcnt(8)
    v_lshlrev_b32 v38, 16, v70
    v_and_b32 v39, s35, v70
    v_lshlrev_b32 v110, 16, v103
    v_and_b32 v111, s35, v103
    v_pk_mul_f32 v[8:9], v[32:33], v[30:31]
    v_cvt_pk_bf16_f32 v6, v8, v9
    v_lshlrev_b32 v8, 16, v6
    v_and_b32 v9, s35, v6
    v_pk_mul_f32 v[10:11], v[34:35], v[28:29]
    v_cvt_pk_bf16_f32 v6, v10, v11
    v_lshlrev_b32 v10, 16, v6
    v_and_b32 v11, s35, v6
    v_pk_add_f32 v[8:9], v[8:9], v[10:11]
    v_cvt_pk_bf16_f32 v6, v8, v9
    v_lshlrev_b32 v8, 16, v6
    v_and_b32 v9, s35, v6
    v_pk_mul_f32 v[10:11], v[36:37], v[26:27]
    v_cvt_pk_bf16_f32 v6, v10, v11
    v_lshlrev_b32 v10, 16, v6
    v_and_b32 v11, s35, v6
    v_pk_add_f32 v[8:9], v[8:9], v[10:11]
    v_cvt_pk_bf16_f32 v6, v8, v9
    v_lshlrev_b32 v8, 16, v6
    v_and_b32 v9, s35, v6
    v_pk_mul_f32 v[10:11], v[38:39], v[24:25]
    v_cvt_pk_bf16_f32 v6, v10, v11
    v_lshlrev_b32 v10, 16, v6
    v_and_b32 v11, s35, v6
    v_pk_add_f32 v[8:9], v[8:9], v[10:11]
    v_cvt_pk_bf16_f32 v6, v8, v9
    v_lshlrev_b32 v8, 16, v6
    v_and_b32 v9, s35, v6
    v_pk_mul_f32 v[110:111], v[8:9], v[110:111]
    v_cvt_pk_bf16_f32 v114, v110, v108
    v_cvt_pk_bf16_f32 v130, v111, v109
    s_waitcnt vmcnt(6)
    v_lshlrev_b32 v32, 16, v71
    v_and_b32 v33, s35, v71
    v_lshlrev_b32 v108, 16, v104
    v_and_b32 v109, s35, v104
    v_pk_mul_f32 v[8:9], v[34:35], v[30:31]
    v_cvt_pk_bf16_f32 v6, v8, v9
    v_lshlrev_b32 v8, 16, v6
    v_and_b32 v9, s35, v6
    v_pk_mul_f32 v[10:11], v[36:37], v[28:29]
    v_cvt_pk_bf16_f32 v6, v10, v11
    v_lshlrev_b32 v10, 16, v6
    v_and_b32 v11, s35, v6
    v_pk_add_f32 v[8:9], v[8:9], v[10:11]
    v_cvt_pk_bf16_f32 v6, v8, v9
    v_lshlrev_b32 v8, 16, v6
    v_and_b32 v9, s35, v6
    v_pk_mul_f32 v[10:11], v[38:39], v[26:27]
    v_cvt_pk_bf16_f32 v6, v10, v11
    v_lshlrev_b32 v10, 16, v6
    v_and_b32 v11, s35, v6
    v_pk_add_f32 v[8:9], v[8:9], v[10:11]
    v_cvt_pk_bf16_f32 v6, v8, v9
    v_lshlrev_b32 v8, 16, v6
    v_and_b32 v9, s35, v6
    v_pk_mul_f32 v[10:11], v[32:33], v[24:25]
    v_cvt_pk_bf16_f32 v6, v10, v11
    v_lshlrev_b32 v10, 16, v6
    v_and_b32 v11, s35, v6
    v_pk_add_f32 v[8:9], v[8:9], v[10:11]
    v_cvt_pk_bf16_f32 v6, v8, v9
    v_lshlrev_b32 v8, 16, v6
    v_and_b32 v9, s35, v6
    v_pk_mul_f32 v[108:109], v[8:9], v[108:109]
    s_waitcnt vmcnt(4)
    v_lshlrev_b32 v34, 16, v72
    v_and_b32 v35, s35, v72
    v_lshlrev_b32 v110, 16, v105
    v_and_b32 v111, s35, v105
    v_pk_mul_f32 v[8:9], v[36:37], v[30:31]
    v_cvt_pk_bf16_f32 v6, v8, v9
    v_lshlrev_b32 v8, 16, v6
    v_and_b32 v9, s35, v6
    v_pk_mul_f32 v[10:11], v[38:39], v[28:29]
    v_cvt_pk_bf16_f32 v6, v10, v11
    v_lshlrev_b32 v10, 16, v6
    v_and_b32 v11, s35, v6
    v_pk_add_f32 v[8:9], v[8:9], v[10:11]
    v_cvt_pk_bf16_f32 v6, v8, v9
    v_lshlrev_b32 v8, 16, v6
    v_and_b32 v9, s35, v6
    v_pk_mul_f32 v[10:11], v[32:33], v[26:27]
    v_cvt_pk_bf16_f32 v6, v10, v11
    v_lshlrev_b32 v10, 16, v6
    v_and_b32 v11, s35, v6
    v_pk_add_f32 v[8:9], v[8:9], v[10:11]
    v_cvt_pk_bf16_f32 v6, v8, v9
    v_lshlrev_b32 v8, 16, v6
    v_and_b32 v9, s35, v6
    v_pk_mul_f32 v[10:11], v[34:35], v[24:25]
    v_cvt_pk_bf16_f32 v6, v10, v11
    v_lshlrev_b32 v10, 16, v6
    v_and_b32 v11, s35, v6
    v_pk_add_f32 v[8:9], v[8:9], v[10:11]
    v_cvt_pk_bf16_f32 v6, v8, v9
    v_lshlrev_b32 v8, 16, v6
    v_and_b32 v9, s35, v6
    v_pk_mul_f32 v[110:111], v[8:9], v[110:111]
    v_cvt_pk_bf16_f32 v113, v110, v108
    v_cvt_pk_bf16_f32 v129, v111, v109
    s_waitcnt vmcnt(2)
    v_lshlrev_b32 v36, 16, v73
    v_and_b32 v37, s35, v73
    v_lshlrev_b32 v108, 16, v106
    v_and_b32 v109, s35, v106
    v_pk_mul_f32 v[8:9], v[38:39], v[30:31]
    v_cvt_pk_bf16_f32 v6, v8, v9
    v_lshlrev_b32 v8, 16, v6
    v_and_b32 v9, s35, v6
    v_pk_mul_f32 v[10:11], v[32:33], v[28:29]
    v_cvt_pk_bf16_f32 v6, v10, v11
    v_lshlrev_b32 v10, 16, v6
    v_and_b32 v11, s35, v6
    v_pk_add_f32 v[8:9], v[8:9], v[10:11]
    v_cvt_pk_bf16_f32 v6, v8, v9
    v_lshlrev_b32 v8, 16, v6
    v_and_b32 v9, s35, v6
    v_pk_mul_f32 v[10:11], v[34:35], v[26:27]
    v_cvt_pk_bf16_f32 v6, v10, v11
    v_lshlrev_b32 v10, 16, v6
    v_and_b32 v11, s35, v6
    v_pk_add_f32 v[8:9], v[8:9], v[10:11]
    v_cvt_pk_bf16_f32 v6, v8, v9
    v_lshlrev_b32 v8, 16, v6
    v_and_b32 v9, s35, v6
    v_pk_mul_f32 v[10:11], v[36:37], v[24:25]
    v_cvt_pk_bf16_f32 v6, v10, v11
    v_lshlrev_b32 v10, 16, v6
    v_and_b32 v11, s35, v6
    v_pk_add_f32 v[8:9], v[8:9], v[10:11]
    v_cvt_pk_bf16_f32 v6, v8, v9
    v_lshlrev_b32 v8, 16, v6
    v_and_b32 v9, s35, v6
    v_pk_mul_f32 v[108:109], v[8:9], v[108:109]
    s_waitcnt vmcnt(0)
    v_lshlrev_b32 v38, 16, v74
    v_and_b32 v39, s35, v74
    v_lshlrev_b32 v110, 16, v107
    v_and_b32 v111, s35, v107
    v_pk_mul_f32 v[8:9], v[32:33], v[30:31]
    v_cvt_pk_bf16_f32 v6, v8, v9
    v_lshlrev_b32 v8, 16, v6
    v_and_b32 v9, s35, v6
    v_pk_mul_f32 v[10:11], v[34:35], v[28:29]
    v_cvt_pk_bf16_f32 v6, v10, v11
    v_lshlrev_b32 v10, 16, v6
    v_and_b32 v11, s35, v6
    v_pk_add_f32 v[8:9], v[8:9], v[10:11]
    v_cvt_pk_bf16_f32 v6, v8, v9
    v_lshlrev_b32 v8, 16, v6
    v_and_b32 v9, s35, v6
    v_pk_mul_f32 v[10:11], v[36:37], v[26:27]
    v_cvt_pk_bf16_f32 v6, v10, v11
    v_lshlrev_b32 v10, 16, v6
    v_and_b32 v11, s35, v6
    v_pk_add_f32 v[8:9], v[8:9], v[10:11]
    v_cvt_pk_bf16_f32 v6, v8, v9
    v_lshlrev_b32 v8, 16, v6
    v_and_b32 v9, s35, v6
    v_pk_mul_f32 v[10:11], v[38:39], v[24:25]
    v_cvt_pk_bf16_f32 v6, v10, v11
    v_lshlrev_b32 v10, 16, v6
    v_and_b32 v11, s35, v6
    v_pk_add_f32 v[8:9], v[8:9], v[10:11]
    v_cvt_pk_bf16_f32 v6, v8, v9
    v_lshlrev_b32 v8, 16, v6
    v_and_b32 v9, s35, v6
    v_pk_mul_f32 v[110:111], v[8:9], v[110:111]
    v_cvt_pk_bf16_f32 v112, v110, v108
    v_cvt_pk_bf16_f32 v128, v111, v109
    s_barrier
    ds_write_b128 v22, v[112:115] offset:0
    ds_write_b128 v22, v[116:119] offset:16
    ds_write_b128 v22, v[120:123] offset:32
    ds_write_b128 v22, v[124:127] offset:48
    ds_write_b128 v22, v[128:131] offset:272
    ds_write_b128 v22, v[132:135] offset:288
    ds_write_b128 v22, v[136:139] offset:304
    ds_write_b128 v22, v[140:143] offset:320
    s_waitcnt lgkmcnt(0)
    s_barrier
    ds_read_b128 v[112:115], v23 offset:0
    ds_read_b128 v[116:119], v23 offset:1088
    ds_read_b128 v[120:123], v23 offset:2176
    ds_read_b128 v[124:127], v23 offset:3264
    ds_read_b128 v[128:131], v23 offset:4352
    ds_read_b128 v[132:135], v23 offset:5440
    ds_read_b128 v[136:139], v23 offset:6528
    ds_read_b128 v[140:143], v23 offset:7616
    s_waitcnt lgkmcnt(7)
    buffer_store_dwordx4 v[112:115], v21, s[4:7], s78 offen sc1
    s_add_u32 s78, s78, 16384
    s_waitcnt lgkmcnt(6)
    buffer_store_dwordx4 v[116:119], v21, s[4:7], s78 offen sc1
    s_add_u32 s78, s78, 16384
    s_waitcnt lgkmcnt(5)
    buffer_store_dwordx4 v[120:123], v21, s[4:7], s78 offen sc1
    s_add_u32 s78, s78, 16384
    s_waitcnt lgkmcnt(4)
    buffer_store_dwordx4 v[124:127], v21, s[4:7], s78 offen sc1
    s_add_u32 s78, s78, 16384
    s_waitcnt lgkmcnt(3)
    buffer_store_dwordx4 v[128:131], v21, s[4:7], s78 offen sc1
    s_add_u32 s78, s78, 16384
    s_waitcnt lgkmcnt(2)
    buffer_store_dwordx4 v[132:135], v21, s[4:7], s78 offen sc1
    s_add_u32 s78, s78, 16384
    s_waitcnt lgkmcnt(1)
    buffer_store_dwordx4 v[136:139], v21, s[4:7], s78 offen sc1
    s_add_u32 s78, s78, 16384
    s_waitcnt lgkmcnt(0)
    buffer_store_dwordx4 v[140:143], v21, s[4:7], s78 offen sc1
    s_add_u32 s78, s78, 409600
    s_add_u32 s77, s77, 256
    v_add_u32 v5, 256, v5
    s_add_u32 s34, s34, 1024
    s_sub_u32 s33, s33, 1
    s_cmp_lg_u32 s33, 0
    s_cbranch_scc1 L_kv_57
    s_lshl_b32 s26, s30, 2
    s_add_u32 s26, s26, 2826752
    v_mov_b32 v4, 1
    s_waitcnt vmcnt(0)
    buffer_store_dword v4, v2, s[4:7], s26 offen sc1
    s_barrier
    v_and_b32 v4, 15, v0
    v_lshrrev_b32 v5, 4, v0
    v_add_u32 v6, 1, v4
    v_and_b32 v7, 7, v6
    v_mul_u32_u24 v7, 4160, v7
    v_lshrrev_b32 v6, 3, v6
    v_add_u32 v6, v6, v5
    v_lshl_add_u32 v20, v6, 4, v7
    s_add_u32 s26, s32, 4608
    v_add_u32 v20, s26, v20
    v_add_u32 v24, s26, v1
    v_lshlrev_b32 v6, 5, v4
    v_lshlrev_b32 v7, 4, v5
    v_sub_u32 v21, v7, v6
    v_add_u32 v21, 480, v21
    v_add_u32 v21, s32, v21
    v_lshlrev_b32 v7, 3, v5
    v_add_u32 v7, v7, v6
    v_sub_u32 v22, 504, v7
    v_add_u32 v22, s32, v22
    s_add_u32 s26, s32, 4608
    v_add_u32 v26, s26, v7
    v_add_u32 v27, s26, v1
    v_subrev_u32 v23, 32, v1
    v_subrev_u32 v25, 16, v1
    v_lshlrev_b32 v3, 2, v0
    v_mov_b32 v8, 0
    v_mov_b32 v9, 0
    v_mov_b32 v10, 0
    v_mov_b32 v11, 0
    v_min_u32 v6, 31, v0
    v_lshlrev_b32 v6, 4, v6
    v_add_u32 v6, s32, v6
    ds_write_b128 v6, v[8:11] offset:4096
    v_add_u32 v68, s32, v1
    s_mov_b64 s[44:45], s[58:59]
    s_and_b32 s45, s45, 0xffff
    s_mov_b32 s46, 4096
    s_mov_b32 s47, 0x20000
    s_lshl_b32 s26, s30, 12
    s_add_u32 s44, s44, s26
    s_addc_u32 s45, s45, 0
    s_mov_b64 s[48:49], s[60:61]
    s_and_b32 s49, s49, 0xffff
    s_mov_b32 s50, 1280
    s_mov_b32 s51, 0x20000
    s_lshl_b32 s31, s30, 1
    s_lshl_b32 s77, s30, 12
    s_add_u32 s78, s77, 58720256
    s_add_u32 s77, s77, 52428800
    s_mov_b32 s34, 0
    s_mov_b32 s26, 2826752
L_gw_58:
    s_sleep 32
    buffer_load_dword v4, v3, s[4:7], s26 offen sc1
    s_sub_u32 s23, s23, 1
    s_movk_i32 s29, 10
    s_cbranch_scc1 L_fail
    s_waitcnt vmcnt(0)
    v_cmp_ne_u32 vcc, 1, v4
    s_cbranch_vccnz L_gw_58
    s_lshl_b32 s27, s20, 7
    s_add_u32 s27, s27, 2828288
    v_mov_b32 v5, 0
    buffer_load_dword v4, v5, s[4:7], s27 offen sc1
    s_waitcnt vmcnt(0)
    v_readfirstlane_b32 s28, v4
L_q_59:
    s_cmp_ge_i32 s28, 63
    s_cbranch_scc1 L_q2_60
    s_sleep 3
    buffer_load_dword v4, v5, s[4:7], s27 offen sc1
    s_sub_u32 s23, s23, 1
    s_movk_i32 s29, 15
    s_cbranch_scc1 L_fail
    s_waitcnt vmcnt(0)
    v_readfirstlane_b32 s26, v4
    s_cmp_eq_u32 s26, s28
    s_cbranch_scc1 L_q_59
L_q2_60:
    buffer_load_dwordx4 v[28:31], v23, s[44:47], 0 offen
    buffer_load_dwordx4 v[32:35], v25, s[44:47], 0 offen
    buffer_load_dwordx4 v[36:39], v1, s[44:47], 0 offen offset:992
    buffer_load_dwordx4 v[40:43], v1, s[44:47], 0 offen offset:1008
    buffer_load_dwordx4 v[44:47], v1, s[44:47], 0 offen offset:2016
    buffer_load_dwordx4 v[48:51], v1, s[44:47], 0 offen offset:2032
    buffer_load_dwordx4 v[52:55], v1, s[44:47], 0 offen offset:3040
    buffer_load_dwordx4 v[56:59], v1, s[44:47], 0 offen offset:3056
    buffer_load_dwordx4 v[60:63], v1, s[44:47], 0 offen offset:4064
    buffer_load_dwordx4 v[64:67], v1, s[44:47], 0 offen offset:4080
    v_mov_b32 v4, 0
    buffer_load_ushort v16, v4, s[48:51], s31 offen
    s_add_u32 s31, s31, 128
    buffer_load_dwordx4 v[104:107], v1, s[4:7], s77 offen offset:0 sc1
    buffer_load_dwordx4 v[108:111], v1, s[4:7], s77 offen offset:1024 sc1
    buffer_load_dwordx4 v[112:115], v1, s[4:7], s77 offen offset:2048 sc1
    buffer_load_dwordx4 v[116:119], v1, s[4:7], s77 offen offset:3072 sc1
    s_add_u32 s77, s77, 262144
    s_add_u32 s44, s44, 262144
    s_addc_u32 s45, s45, 0
L_chan_61:
    s_waitcnt vmcnt(0)
    v_lshlrev_b32 v69, 16, v16
    ds_write_b128 v68, v[104:107] offset:0
    ds_write_b128 v68, v[108:111] offset:1024
    ds_write_b128 v68, v[112:115] offset:2048
    ds_write_b128 v68, v[116:119] offset:3072
    v_alignbit_b32 v144, v29, v28, 16
    v_alignbit_b32 v145, v30, v29, 16
    v_alignbit_b32 v146, v31, v30, 16
    v_alignbit_b32 v147, v32, v31, 16
    v_alignbit_b32 v148, v33, v32, 16
    v_alignbit_b32 v149, v34, v33, 16
    v_alignbit_b32 v150, v35, v34, 16
    v_mov_b32 v152, v29
    v_mov_b32 v153, v30
    v_mov_b32 v154, v31
    v_mov_b32 v155, v32
    v_mov_b32 v156, v33
    v_mov_b32 v157, v34
    v_mov_b32 v160, v145
    v_mov_b32 v161, v146
    v_mov_b32 v162, v147
    v_mov_b32 v163, v148
    v_mov_b32 v164, v149
    v_mov_b32 v165, v150
    ds_write_b128 v24, v[28:31] offset:0
    ds_write_b128 v24, v[144:147] offset:4160
    ds_write_b128 v24, v[152:155] offset:8320
    ds_write_b128 v24, v[160:163] offset:12480
    ds_write_b128 v24, v[30:33] offset:16640
    ds_write_b128 v24, v[146:149] offset:20800
    ds_write_b128 v24, v[154:157] offset:24960
    ds_write_b128 v24, v[162:165] offset:29120
    v_alignbit_b32 v144, v37, v36, 16
    v_alignbit_b32 v145, v38, v37, 16
    v_alignbit_b32 v146, v39, v38, 16
    v_alignbit_b32 v147, v40, v39, 16
    v_alignbit_b32 v148, v41, v40, 16
    v_alignbit_b32 v149, v42, v41, 16
    v_alignbit_b32 v150, v43, v42, 16
    v_mov_b32 v152, v37
    v_mov_b32 v153, v38
    v_mov_b32 v154, v39
    v_mov_b32 v155, v40
    v_mov_b32 v156, v41
    v_mov_b32 v157, v42
    v_mov_b32 v160, v145
    v_mov_b32 v161, v146
    v_mov_b32 v162, v147
    v_mov_b32 v163, v148
    v_mov_b32 v164, v149
    v_mov_b32 v165, v150
    ds_write_b128 v24, v[36:39] offset:1024
    ds_write_b128 v24, v[144:147] offset:5184
    ds_write_b128 v24, v[152:155] offset:9344
    ds_write_b128 v24, v[160:163] offset:13504
    ds_write_b128 v24, v[38:41] offset:17664
    ds_write_b128 v24, v[146:149] offset:21824
    ds_write_b128 v24, v[154:157] offset:25984
    ds_write_b128 v24, v[162:165] offset:30144
    v_alignbit_b32 v144, v45, v44, 16
    v_alignbit_b32 v145, v46, v45, 16
    v_alignbit_b32 v146, v47, v46, 16
    v_alignbit_b32 v147, v48, v47, 16
    v_alignbit_b32 v148, v49, v48, 16
    v_alignbit_b32 v149, v50, v49, 16
    v_alignbit_b32 v150, v51, v50, 16
    v_mov_b32 v152, v45
    v_mov_b32 v153, v46
    v_mov_b32 v154, v47
    v_mov_b32 v155, v48
    v_mov_b32 v156, v49
    v_mov_b32 v157, v50
    v_mov_b32 v160, v145
    v_mov_b32 v161, v146
    v_mov_b32 v162, v147
    v_mov_b32 v163, v148
    v_mov_b32 v164, v149
    v_mov_b32 v165, v150
    ds_write_b128 v24, v[44:47] offset:2048
    ds_write_b128 v24, v[144:147] offset:6208
    ds_write_b128 v24, v[152:155] offset:10368
    ds_write_b128 v24, v[160:163] offset:14528
    ds_write_b128 v24, v[46:49] offset:18688
    ds_write_b128 v24, v[146:149] offset:22848
    ds_write_b128 v24, v[154:157] offset:27008
    ds_write_b128 v24, v[162:165] offset:31168
    v_alignbit_b32 v144, v53, v52, 16
    v_alignbit_b32 v145, v54, v53, 16
    v_alignbit_b32 v146, v55, v54, 16
    v_alignbit_b32 v147, v56, v55, 16
    v_alignbit_b32 v148, v57, v56, 16
    v_alignbit_b32 v149, v58, v57, 16
    v_alignbit_b32 v150, v59, v58, 16
    v_mov_b32 v152, v53
    v_mov_b32 v153, v54
    v_mov_b32 v154, v55
    v_mov_b32 v155, v56
    v_mov_b32 v156, v57
    v_mov_b32 v157, v58
    v_mov_b32 v160, v145
    v_mov_b32 v161, v146
    v_mov_b32 v162, v147
    v_mov_b32 v163, v148
    v_mov_b32 v164, v149
    v_mov_b32 v165, v150
    ds_write_b128 v24, v[52:55] offset:3072
    ds_write_b128 v24, v[144:147] offset:7232
    ds_write_b128 v24, v[152:155] offset:11392
    ds_write_b128 v24, v[160:163] offset:15552
    ds_write_b128 v24, v[54:57] offset:19712
    ds_write_b128 v24, v[146:149] offset:23872
    ds_write_b128 v24, v[154:157] offset:28032
    ds_write_b128 v24, v[162:165] offset:32192
    s_mov_b64 exec, 15
    v_alignbit_b32 v144, v61, v60, 16
    v_alignbit_b32 v145, v62, v61, 16
    v_alignbit_b32 v146, v63, v62, 16
    v_alignbit_b32 v147, v64, v63, 16
    v_alignbit_b32 v148, v65, v64, 16
    v_alignbit_b32 v149, v66, v65, 16
    v_alignbit_b32 v150, v67, v66, 16
    v_mov_b32 v152, v61
    v_mov_b32 v153, v62
    v_mov_b32 v154, v63
    v_mov_b32 v155, v64
    v_mov_b32 v156, v65
    v_mov_b32 v157, v66
    v_mov_b32 v160, v145
    v_mov_b32 v161, v146
    v_mov_b32 v162, v147
    v_mov_b32 v163, v148
    v_mov_b32 v164, v149
    v_mov_b32 v165, v150
    ds_write_b128 v24, v[60:63] offset:4096
    ds_write_b128 v24, v[144:147] offset:8256
    ds_write_b128 v24, v[152:155] offset:12416
    ds_write_b128 v24, v[160:163] offset:16576
    ds_write_b128 v24, v[62:65] offset:20736
    ds_write_b128 v24, v[146:149] offset:24896
    ds_write_b128 v24, v[154:157] offset:29056
    ds_write_b128 v24, v[162:165] offset:33216
    s_mov_b64 exec, -1
    s_waitcnt lgkmcnt(0)
    s_cmp_eq_u32 s34, 9
    s_cbranch_scc1 L_nofetch_62
    buffer_load_dwordx4 v[28:31], v23, s[44:47], 0 offen
    buffer_load_dwordx4 v[32:35], v25, s[44:47], 0 offen
    buffer_load_dwordx4 v[36:39], v1, s[44:47], 0 offen offset:992
    buffer_load_dwordx4 v[40:43], v1, s[44:47], 0 offen offset:1008
    buffer_load_dwordx4 v[44:47], v1, s[44:47], 0 offen offset:2016
    buffer_load_dwordx4 v[48:51], v1, s[44:47], 0 offen offset:2032
    buffer_load_dwordx4 v[52:55], v1, s[44:47], 0 offen offset:3040
    buffer_load_dwordx4 v[56:59], v1, s[44:47], 0 offen offset:3056
    buffer_load_dwordx4 v[60:63], v1, s[44:47], 0 offen offset:4064
    buffer_load_dwordx4 v[64:67], v1, s[44:47], 0 offen offset:4080
    v_mov_b32 v4, 0
    buffer_load_ushort v16, v4, s[48:51], s31 offen
    s_add_u32 s31, s31, 128
    buffer_load_dwordx4 v[104:107], v1, s[4:7], s77 offen offset:0 sc1
    buffer_load_dwordx4 v[108:111], v1, s[4:7], s77 offen offset:1024 sc1
    buffer_load_dwordx4 v[112:115], v1, s[4:7], s77 offen offset:2048 sc1
    buffer_load_dwordx4 v[116:119], v1, s[4:7], s77 offen offset:3072 sc1
    s_add_u32 s77, s77, 262144
    s_add_u32 s44, s44, 262144
    s_addc_u32 s45, s45, 0
L_nofetch_62:
    ds_read_b128 v[152:155], v21 offset:3584
    ds_read_b128 v[120:123], v20 offset:0
    ds_read_b128 v[156:159], v21 offset:3072
    ds_read_b128 v[124:127], v20 offset:512
    ds_read_b128 v[160:163], v21 offset:2560
    ds_read_b128 v[128:131], v20 offset:1024
    ds_read_b128 v[164:167], v21 offset:2048
    ds_read_b128 v[132:135], v20 offset:1536
    ds_read_b128 v[168:171], v21 offset:1536
    ds_read_b128 v[136:139], v20 offset:2048
    ds_read_b128 v[172:175], v21 offset:1024
    ds_read_b128 v[140:143], v20 offset:2560
    ds_read_b128 v[176:179], v21 offset:512
    ds_read_b128 v[144:147], v20 offset:3072
    s_waitcnt lgkmcnt(6)
    ds_read_b128 v[180:183], v21 offset:0
    ds_read_b128 v[148:151], v20 offset:3584
    s_waitcnt lgkmcnt(0)
    v_mfma_f32_16x16x32_bf16 v[72:75], v[120:123], v[152:155], 0
    ds_read_b128 v[216:219], v21 offset:3648
    v_mfma_f32_16x16x32_bf16 v[76:79], v[120:123], v[156:159], 0
    v_mfma_f32_16x16x32_bf16 v[80:83], v[120:123], v[160:163], 0
    ds_read_b128 v[184:187], v20 offset:64
    v_mfma_f32_16x16x32_bf16 v[84:87], v[120:123], v[164:167], 0
    v_mfma_f32_16x16x32_bf16 v[88:91], v[120:123], v[168:171], 0
    ds_read_b128 v[220:223], v21 offset:3136
    v_mfma_f32_16x16x32_bf16 v[92:95], v[120:123], v[172:175], 0
    v_mfma_f32_16x16x32_bf16 v[96:99], v[120:123], v[176:179], 0
    ds_read_b128 v[188:191], v20 offset:576
    v_mfma_f32_16x16x32_bf16 v[100:103], v[120:123], v[180:183], 0
    v_mfma_f32_16x16x32_bf16 v[76:79], v[124:127], v[152:155], v[76:79]
    ds_read_b128 v[224:227], v21 offset:2624
    v_mfma_f32_16x16x32_bf16 v[80:83], v[124:127], v[156:159], v[80:83]
    v_mfma_f32_16x16x32_bf16 v[84:87], v[124:127], v[160:163], v[84:87]
    ds_read_b128 v[192:195], v20 offset:1088
    v_mfma_f32_16x16x32_bf16 v[88:91], v[124:127], v[164:167], v[88:91]
    v_mfma_f32_16x16x32_bf16 v[92:95], v[124:127], v[168:171], v[92:95]
    ds_read_b128 v[228:231], v21 offset:2112
    v_mfma_f32_16x16x32_bf16 v[96:99], v[124:127], v[172:175], v[96:99]
    v_mfma_f32_16x16x32_bf16 v[100:103], v[124:127], v[176:179], v[100:103]
    ds_read_b128 v[196:199], v20 offset:1600
    v_mfma_f32_16x16x32_bf16 v[80:83], v[128:131], v[152:155], v[80:83]
    v_mfma_f32_16x16x32_bf16 v[84:87], v[128:131], v[156:159], v[84:87]
    ds_read_b128 v[232:235], v21 offset:1600
    v_mfma_f32_16x16x32_bf16 v[88:91], v[128:131], v[160:163], v[88:91]
    v_mfma_f32_16x16x32_bf16 v[92:95], v[128:131], v[164:167], v[92:95]
    ds_read_b128 v[200:203], v20 offset:2112
    v_mfma_f32_16x16x32_bf16 v[96:99], v[128:131], v[168:171], v[96:99]
    v_mfma_f32_16x16x32_bf16 v[100:103], v[128:131], v[172:175], v[100:103]
    ds_read_b128 v[236:239], v21 offset:1088
    v_mfma_f32_16x16x32_bf16 v[84:87], v[132:135], v[152:155], v[84:87]
    v_mfma_f32_16x16x32_bf16 v[88:91], v[132:135], v[156:159], v[88:91]
    ds_read_b128 v[204:207], v20 offset:2624
    v_mfma_f32_16x16x32_bf16 v[92:95], v[132:135], v[160:163], v[92:95]
    v_mfma_f32_16x16x32_bf16 v[96:99], v[132:135], v[164:167], v[96:99]
    ds_read_b128 v[240:243], v21 offset:576
    v_mfma_f32_16x16x32_bf16 v[100:103], v[132:135], v[168:171], v[100:103]
    v_mfma_f32_16x16x32_bf16 v[88:91], v[136:139], v[152:155], v[88:91]
    ds_read_b128 v[208:211], v20 offset:3136
    v_mfma_f32_16x16x32_bf16 v[92:95], v[136:139], v[156:159], v[92:95]
    v_mfma_f32_16x16x32_bf16 v[96:99], v[136:139], v[160:163], v[96:99]
    ds_read_b128 v[244:247], v21 offset:64
    v_mfma_f32_16x16x32_bf16 v[100:103], v[136:139], v[164:167], v[100:103]
    v_mfma_f32_16x16x32_bf16 v[92:95], v[140:143], v[152:155], v[92:95]
    ds_read_b128 v[212:215], v20 offset:3648
    v_mfma_f32_16x16x32_bf16 v[96:99], v[140:143], v[156:159], v[96:99]
    v_mfma_f32_16x16x32_bf16 v[100:103], v[140:143], v[160:163], v[100:103]
    v_mfma_f32_16x16x32_bf16 v[96:99], v[144:147], v[152:155], v[96:99]
    v_mfma_f32_16x16x32_bf16 v[100:103], v[144:147], v[156:159], v[100:103]
    v_mfma_f32_16x16x32_bf16 v[100:103], v[148:151], v[152:155], v[100:103]
    s_waitcnt lgkmcnt(0)
    v_mfma_f32_16x16x32_bf16 v[72:75], v[184:187], v[216:219], v[72:75]
    ds_read_b128 v[152:155], v21 offset:3712
    v_mfma_f32_16x16x32_bf16 v[76:79], v[184:187], v[220:223], v[76:79]
    v_mfma_f32_16x16x32_bf16 v[80:83], v[184:187], v[224:227], v[80:83]
    ds_read_b128 v[120:123], v20 offset:128
    v_mfma_f32_16x16x32_bf16 v[84:87], v[184:187], v[228:231], v[84:87]
    v_mfma_f32_16x16x32_bf16 v[88:91], v[184:187], v[232:235], v[88:91]
    ds_read_b128 v[156:159], v21 offset:3200
    v_mfma_f32_16x16x32_bf16 v[92:95], v[184:187], v[236:239], v[92:95]
    v_mfma_f32_16x16x32_bf16 v[96:99], v[184:187], v[240:243], v[96:99]
    ds_read_b128 v[124:127], v20 offset:640
    v_mfma_f32_16x16x32_bf16 v[100:103], v[184:187], v[244:247], v[100:103]
    v_mfma_f32_16x16x32_bf16 v[76:79], v[188:191], v[216:219], v[76:79]
    ds_read_b128 v[160:163], v21 offset:2688
    v_mfma_f32_16x16x32_bf16 v[80:83], v[188:191], v[220:223], v[80:83]
    v_mfma_f32_16x16x32_bf16 v[84:87], v[188:191], v[224:227], v[84:87]
    ds_read_b128 v[128:131], v20 offset:1152
    v_mfma_f32_16x16x32_bf16 v[88:91], v[188:191], v[228:231], v[88:91]
    v_mfma_f32_16x16x32_bf16 v[92:95], v[188:191], v[232:235], v[92:95]
    ds_read_b128 v[164:167], v21 offset:2176
    v_mfma_f32_16x16x32_bf16 v[96:99], v[188:191], v[236:239], v[96:99]
    v_mfma_f32_16x16x32_bf16 v[100:103], v[188:191], v[240:243], v[100:103]
    ds_read_b128 v[132:135], v20 offset:1664
    v_mfma_f32_16x16x32_bf16 v[80:83], v[192:195], v[216:219], v[80:83]
    v_mfma_f32_16x16x32_bf16 v[84:87], v[192:195], v[220:223], v[84:87]
    ds_read_b128 v[168:171], v21 offset:1664
    v_mfma_f32_16x16x32_bf16 v[88:91], v[192:195], v[224:227], v[88:91]
    v_mfma_f32_16x16x32_bf16 v[92:95], v[192:195], v[228:231], v[92:95]
    ds_read_b128 v[136:139], v20 offset:2176
    v_mfma_f32_16x16x32_bf16 v[96:99], v[192:195], v[232:235], v[96:99]
    v_mfma_f32_16x16x32_bf16 v[100:103], v[192:195], v[236:239], v[100:103]
    ds_read_b128 v[172:175], v21 offset:1152
    v_mfma_f32_16x16x32_bf16 v[84:87], v[196:199], v[216:219], v[84:87]
    v_mfma_f32_16x16x32_bf16 v[88:91], v[196:199], v[220:223], v[88:91]
    ds_read_b128 v[140:143], v20 offset:2688
    v_mfma_f32_16x16x32_bf16 v[92:95], v[196:199], v[224:227], v[92:95]
    v_mfma_f32_16x16x32_bf16 v[96:99], v[196:199], v[228:231], v[96:99]
    ds_read_b128 v[176:179], v21 offset:640
    v_mfma_f32_16x16x32_bf16 v[100:103], v[196:199], v[232:235], v[100:103]
    v_mfma_f32_16x16x32_bf16 v[88:91], v[200:203], v[216:219], v[88:91]
    ds_read_b128 v[144:147], v20 offset:3200
    v_mfma_f32_16x16x32_bf16 v[92:95], v[200:203], v[220:223], v[92:95]
    v_mfma_f32_16x16x32_bf16 v[96:99], v[200:203], v[224:227], v[96:99]
    ds_read_b128 v[180:183], v21 offset:128
    v_mfma_f32_16x16x32_bf16 v[100:103], v[200:203], v[228:231], v[100:103]
    v_mfma_f32_16x16x32_bf16 v[92:95], v[204:207], v[216:219], v[92:95]
    ds_read_b128 v[148:151], v20 offset:3712
    v_mfma_f32_16x16x32_bf16 v[96:99], v[204:207], v[220:223], v[96:99]
    v_mfma_f32_16x16x32_bf16 v[100:103], v[204:207], v[224:227], v[100:103]
    v_mfma_f32_16x16x32_bf16 v[96:99], v[208:211], v[216:219], v[96:99]
    v_mfma_f32_16x16x32_bf16 v[100:103], v[208:211], v[220:223], v[100:103]
    v_mfma_f32_16x16x32_bf16 v[100:103], v[212:215], v[216:219], v[100:103]
    s_waitcnt lgkmcnt(0)
    v_mfma_f32_16x16x32_bf16 v[72:75], v[120:123], v[152:155], v[72:75]
    ds_read_b128 v[216:219], v21 offset:3776
    v_mfma_f32_16x16x32_bf16 v[76:79], v[120:123], v[156:159], v[76:79]
    v_mfma_f32_16x16x32_bf16 v[80:83], v[120:123], v[160:163], v[80:83]
    ds_read_b128 v[184:187], v20 offset:192
    v_mfma_f32_16x16x32_bf16 v[84:87], v[120:123], v[164:167], v[84:87]
    v_mfma_f32_16x16x32_bf16 v[88:91], v[120:123], v[168:171], v[88:91]
    ds_read_b128 v[220:223], v21 offset:3264
    v_mfma_f32_16x16x32_bf16 v[92:95], v[120:123], v[172:175], v[92:95]
    v_mfma_f32_16x16x32_bf16 v[96:99], v[120:123], v[176:179], v[96:99]
    ds_read_b128 v[188:191], v20 offset:704
    v_mfma_f32_16x16x32_bf16 v[100:103], v[120:123], v[180:183], v[100:103]
    v_mfma_f32_16x16x32_bf16 v[76:79], v[124:127], v[152:155], v[76:79]
    ds_read_b128 v[224:227], v21 offset:2752
    v_mfma_f32_16x16x32_bf16 v[80:83], v[124:127], v[156:159], v[80:83]
    v_mfma_f32_16x16x32_bf16 v[84:87], v[124:127], v[160:163], v[84:87]
    ds_read_b128 v[192:195], v20 offset:1216
    v_mfma_f32_16x16x32_bf16 v[88:91], v[124:127], v[164:167], v[88:91]
    v_mfma_f32_16x16x32_bf16 v[92:95], v[124:127], v[168:171], v[92:95]
    ds_read_b128 v[228:231], v21 offset:2240
    v_mfma_f32_16x16x32_bf16 v[96:99], v[124:127], v[172:175], v[96:99]
    v_mfma_f32_16x16x32_bf16 v[100:103], v[124:127], v[176:179], v[100:103]
    ds_read_b128 v[196:199], v20 offset:1728
    v_mfma_f32_16x16x32_bf16 v[80:83], v[128:131], v[152:155], v[80:83]
    v_mfma_f32_16x16x32_bf16 v[84:87], v[128:131], v[156:159], v[84:87]
    ds_read_b128 v[232:235], v21 offset:1728
    v_mfma_f32_16x16x32_bf16 v[88:91], v[128:131], v[160:163], v[88:91]
    v_mfma_f32_16x16x32_bf16 v[92:95], v[128:131], v[164:167], v[92:95]
    ds_read_b128 v[200:203], v20 offset:2240
    v_mfma_f32_16x16x32_bf16 v[96:99], v[128:131], v[168:171], v[96:99]
    v_mfma_f32_16x16x32_bf16 v[100:103], v[128:131], v[172:175], v[100:103]
    ds_read_b128 v[236:239], v21 offset:1216
    v_mfma_f32_16x16x32_bf16 v[84:87], v[132:135], v[152:155], v[84:87]
    v_mfma_f32_16x16x32_bf16 v[88:91], v[132:135], v[156:159], v[88:91]
    ds_read_b128 v[204:207], v20 offset:2752
    v_mfma_f32_16x16x32_bf16 v[92:95], v[132:135], v[160:163], v[92:95]
    v_mfma_f32_16x16x32_bf16 v[96:99], v[132:135], v[164:167], v[96:99]
    ds_read_b128 v[240:243], v21 offset:704
    v_mfma_f32_16x16x32_bf16 v[100:103], v[132:135], v[168:171], v[100:103]
    v_mfma_f32_16x16x32_bf16 v[88:91], v[136:139], v[152:155], v[88:91]
    ds_read_b128 v[208:211], v20 offset:3264
    v_mfma_f32_16x16x32_bf16 v[92:95], v[136:139], v[156:159], v[92:95]
    v_mfma_f32_16x16x32_bf16 v[96:99], v[136:139], v[160:163], v[96:99]
    ds_read_b128 v[244:247], v21 offset:192
    v_mfma_f32_16x16x32_bf16 v[100:103], v[136:139], v[164:167], v[100:103]
    v_mfma_f32_16x16x32_bf16 v[92:95], v[140:143], v[152:155], v[92:95]
    ds_read_b128 v[212:215], v20 offset:3776
    v_mfma_f32_16x16x32_bf16 v[96:99], v[140:143], v[156:159], v[96:99]
    v_mfma_f32_16x16x32_bf16 v[100:103], v[140:143], v[160:163], v[100:103]
    v_mfma_f32_16x16x32_bf16 v[96:99], v[144:147], v[152:155], v[96:99]
    v_mfma_f32_16x16x32_bf16 v[100:103], v[144:147], v[156:159], v[100:103]
    v_mfma_f32_16x16x32_bf16 v[100:103], v[148:151], v[152:155], v[100:103]
    s_waitcnt lgkmcnt(0)
    v_mfma_f32_16x16x32_bf16 v[72:75], v[184:187], v[216:219], v[72:75]
    ds_read_b128 v[152:155], v21 offset:3840
    v_mfma_f32_16x16x32_bf16 v[76:79], v[184:187], v[220:223], v[76:79]
    v_mfma_f32_16x16x32_bf16 v[80:83], v[184:187], v[224:227], v[80:83]
    ds_read_b128 v[120:123], v20 offset:256
    v_mfma_f32_16x16x32_bf16 v[84:87], v[184:187], v[228:231], v[84:87]
    v_mfma_f32_16x16x32_bf16 v[88:91], v[184:187], v[232:235], v[88:91]
    ds_read_b128 v[156:159], v21 offset:3328
    v_mfma_f32_16x16x32_bf16 v[92:95], v[184:187], v[236:239], v[92:95]
    v_mfma_f32_16x16x32_bf16 v[96:99], v[184:187], v[240:243], v[96:99]
    ds_read_b128 v[124:127], v20 offset:768
    v_mfma_f32_16x16x32_bf16 v[100:103], v[184:187], v[244:247], v[100:103]
    v_mfma_f32_16x16x32_bf16 v[76:79], v[188:191], v[216:219], v[76:79]
    ds_read_b128 v[160:163], v21 offset:2816
    v_mfma_f32_16x16x32_bf16 v[80:83], v[188:191], v[220:223], v[80:83]
    v_mfma_f32_16x16x32_bf16 v[84:87], v[188:191], v[224:227], v[84:87]
    ds_read_b128 v[128:131], v20 offset:1280
    v_mfma_f32_16x16x32_bf16 v[88:91], v[188:191], v[228:231], v[88:91]
    v_mfma_f32_16x16x32_bf16 v[92:95], v[188:191], v[232:235], v[92:95]
    ds_read_b128 v[164:167], v21 offset:2304
    v_mfma_f32_16x16x32_bf16 v[96:99], v[188:191], v[236:239], v[96:99]
    v_mfma_f32_16x16x32_bf16 v[100:103], v[188:191], v[240:243], v[100:103]
    ds_read_b128 v[132:135], v20 offset:1792
    v_mfma_f32_16x16x32_bf16 v[80:83], v[192:195], v[216:219], v[80:83]
    v_mfma_f32_16x16x32_bf16 v[84:87], v[192:195], v[220:223], v[84:87]
    ds_read_b128 v[168:171], v21 offset:1792
    v_mfma_f32_16x16x32_bf16 v[88:91], v[192:195], v[224:227], v[88:91]
    v_mfma_f32_16x16x32_bf16 v[92:95], v[192:195], v[228:231], v[92:95]
    ds_read_b128 v[136:139], v20 offset:2304
    v_mfma_f32_16x16x32_bf16 v[96:99], v[192:195], v[232:235], v[96:99]
    v_mfma_f32_16x16x32_bf16 v[100:103], v[192:195], v[236:239], v[100:103]
    ds_read_b128 v[172:175], v21 offset:1280
    v_mfma_f32_16x16x32_bf16 v[84:87], v[196:199], v[216:219], v[84:87]
    v_mfma_f32_16x16x32_bf16 v[88:91], v[196:199], v[220:223], v[88:91]
    ds_read_b128 v[140:143], v20 offset:2816
    v_mfma_f32_16x16x32_bf16 v[92:95], v[196:199], v[224:227], v[92:95]
    v_mfma_f32_16x16x32_bf16 v[96:99], v[196:199], v[228:231], v[96:99]
    ds_read_b128 v[176:179], v21 offset:768
    v_mfma_f32_16x16x32_bf16 v[100:103], v[196:199], v[232:235], v[100:103]
    v_mfma_f32_16x16x32_bf16 v[88:91], v[200:203], v[216:219], v[88:91]
    ds_read_b128 v[144:147], v20 offset:3328
    v_mfma_f32_16x16x32_bf16 v[92:95], v[200:203], v[220:223], v[92:95]
    v_mfma_f32_16x16x32_bf16 v[96:99], v[200:203], v[224:227], v[96:99]
    ds_read_b128 v[180:183], v21 offset:256
    v_mfma_f32_16x16x32_bf16 v[100:103], v[200:203], v[228:231], v[100:103]
    v_mfma_f32_16x16x32_bf16 v[92:95], v[204:207], v[216:219], v[92:95]
    ds_read_b128 v[148:151], v20 offset:3840
    v_mfma_f32_16x16x32_bf16 v[96:99], v[204:207], v[220:223], v[96:99]
    v_mfma_f32_16x16x32_bf16 v[100:103], v[204:207], v[224:227], v[100:103]
    v_mfma_f32_16x16x32_bf16 v[96:99], v[208:211], v[216:219], v[96:99]
    v_mfma_f32_16x16x32_bf16 v[100:103], v[208:211], v[220:223], v[100:103]
    v_mfma_f32_16x16x32_bf16 v[100:103], v[212:215], v[216:219], v[100:103]
    s_waitcnt lgkmcnt(0)
    v_mfma_f32_16x16x32_bf16 v[72:75], v[120:123], v[152:155], v[72:75]
    ds_read_b128 v[216:219], v21 offset:3904
    v_mfma_f32_16x16x32_bf16 v[76:79], v[120:123], v[156:159], v[76:79]
    v_mfma_f32_16x16x32_bf16 v[80:83], v[120:123], v[160:163], v[80:83]
    ds_read_b128 v[184:187], v20 offset:320
    v_mfma_f32_16x16x32_bf16 v[84:87], v[120:123], v[164:167], v[84:87]
    v_mfma_f32_16x16x32_bf16 v[88:91], v[120:123], v[168:171], v[88:91]
    ds_read_b128 v[220:223], v21 offset:3392
    v_mfma_f32_16x16x32_bf16 v[92:95], v[120:123], v[172:175], v[92:95]
    v_mfma_f32_16x16x32_bf16 v[96:99], v[120:123], v[176:179], v[96:99]
    ds_read_b128 v[188:191], v20 offset:832
    v_mfma_f32_16x16x32_bf16 v[100:103], v[120:123], v[180:183], v[100:103]
    v_mfma_f32_16x16x32_bf16 v[76:79], v[124:127], v[152:155], v[76:79]
    ds_read_b128 v[224:227], v21 offset:2880
    v_mfma_f32_16x16x32_bf16 v[80:83], v[124:127], v[156:159], v[80:83]
    v_mfma_f32_16x16x32_bf16 v[84:87], v[124:127], v[160:163], v[84:87]
    ds_read_b128 v[192:195], v20 offset:1344
    v_mfma_f32_16x16x32_bf16 v[88:91], v[124:127], v[164:167], v[88:91]
    v_mfma_f32_16x16x32_bf16 v[92:95], v[124:127], v[168:171], v[92:95]
    ds_read_b128 v[228:231], v21 offset:2368
    v_mfma_f32_16x16x32_bf16 v[96:99], v[124:127], v[172:175], v[96:99]
    v_mfma_f32_16x16x32_bf16 v[100:103], v[124:127], v[176:179], v[100:103]
    ds_read_b128 v[196:199], v20 offset:1856
    v_mfma_f32_16x16x32_bf16 v[80:83], v[128:131], v[152:155], v[80:83]
    v_mfma_f32_16x16x32_bf16 v[84:87], v[128:131], v[156:159], v[84:87]
    ds_read_b128 v[232:235], v21 offset:1856
    v_mfma_f32_16x16x32_bf16 v[88:91], v[128:131], v[160:163], v[88:91]
    v_mfma_f32_16x16x32_bf16 v[92:95], v[128:131], v[164:167], v[92:95]
    ds_read_b128 v[200:203], v20 offset:2368
    v_mfma_f32_16x16x32_bf16 v[96:99], v[128:131], v[168:171], v[96:99]
    v_mfma_f32_16x16x32_bf16 v[100:103], v[128:131], v[172:175], v[100:103]
    ds_read_b128 v[236:239], v21 offset:1344
    v_mfma_f32_16x16x32_bf16 v[84:87], v[132:135], v[152:155], v[84:87]
    v_mfma_f32_16x16x32_bf16 v[88:91], v[132:135], v[156:159], v[88:91]
    ds_read_b128 v[204:207], v20 offset:2880
    v_mfma_f32_16x16x32_bf16 v[92:95], v[132:135], v[160:163], v[92:95]
    v_mfma_f32_16x16x32_bf16 v[96:99], v[132:135], v[164:167], v[96:99]
    ds_read_b128 v[240:243], v21 offset:832
    v_mfma_f32_16x16x32_bf16 v[100:103], v[132:135], v[168:171], v[100:103]
    v_mfma_f32_16x16x32_bf16 v[88:91], v[136:139], v[152:155], v[88:91]
    ds_read_b128 v[208:211], v20 offset:3392
    v_mfma_f32_16x16x32_bf16 v[92:95], v[136:139], v[156:159], v[92:95]
    v_mfma_f32_16x16x32_bf16 v[96:99], v[136:139], v[160:163], v[96:99]
    ds_read_b128 v[244:247], v21 offset:320
    v_mfma_f32_16x16x32_bf16 v[100:103], v[136:139], v[164:167], v[100:103]
    v_mfma_f32_16x16x32_bf16 v[92:95], v[140:143], v[152:155], v[92:95]
    ds_read_b128 v[212:215], v20 offset:3904
    v_mfma_f32_16x16x32_bf16 v[96:99], v[140:143], v[156:159], v[96:99]
    v_mfma_f32_16x16x32_bf16 v[100:103], v[140:143], v[160:163], v[100:103]
    v_mfma_f32_16x16x32_bf16 v[96:99], v[144:147], v[152:155], v[96:99]
    v_mfma_f32_16x16x32_bf16 v[100:103], v[144:147], v[156:159], v[100:103]
    v_mfma_f32_16x16x32_bf16 v[100:103], v[148:151], v[152:155], v[100:103]
    s_waitcnt lgkmcnt(0)
    v_mfma_f32_16x16x32_bf16 v[72:75], v[184:187], v[216:219], v[72:75]
    ds_read_b128 v[152:155], v21 offset:3968
    v_mfma_f32_16x16x32_bf16 v[76:79], v[184:187], v[220:223], v[76:79]
    v_mfma_f32_16x16x32_bf16 v[80:83], v[184:187], v[224:227], v[80:83]
    ds_read_b128 v[120:123], v20 offset:384
    v_mfma_f32_16x16x32_bf16 v[84:87], v[184:187], v[228:231], v[84:87]
    v_mfma_f32_16x16x32_bf16 v[88:91], v[184:187], v[232:235], v[88:91]
    ds_read_b128 v[156:159], v21 offset:3456
    v_mfma_f32_16x16x32_bf16 v[92:95], v[184:187], v[236:239], v[92:95]
    v_mfma_f32_16x16x32_bf16 v[96:99], v[184:187], v[240:243], v[96:99]
    ds_read_b128 v[124:127], v20 offset:896
    v_mfma_f32_16x16x32_bf16 v[100:103], v[184:187], v[244:247], v[100:103]
    v_mfma_f32_16x16x32_bf16 v[76:79], v[188:191], v[216:219], v[76:79]
    ds_read_b128 v[160:163], v21 offset:2944
    v_mfma_f32_16x16x32_bf16 v[80:83], v[188:191], v[220:223], v[80:83]
    v_mfma_f32_16x16x32_bf16 v[84:87], v[188:191], v[224:227], v[84:87]
    ds_read_b128 v[128:131], v20 offset:1408
    v_mfma_f32_16x16x32_bf16 v[88:91], v[188:191], v[228:231], v[88:91]
    v_mfma_f32_16x16x32_bf16 v[92:95], v[188:191], v[232:235], v[92:95]
    ds_read_b128 v[164:167], v21 offset:2432
    v_mfma_f32_16x16x32_bf16 v[96:99], v[188:191], v[236:239], v[96:99]
    v_mfma_f32_16x16x32_bf16 v[100:103], v[188:191], v[240:243], v[100:103]
    ds_read_b128 v[132:135], v20 offset:1920
    v_mfma_f32_16x16x32_bf16 v[80:83], v[192:195], v[216:219], v[80:83]
    v_mfma_f32_16x16x32_bf16 v[84:87], v[192:195], v[220:223], v[84:87]
    ds_read_b128 v[168:171], v21 offset:1920
    v_mfma_f32_16x16x32_bf16 v[88:91], v[192:195], v[224:227], v[88:91]
    v_mfma_f32_16x16x32_bf16 v[92:95], v[192:195], v[228:231], v[92:95]
    ds_read_b128 v[136:139], v20 offset:2432
    v_mfma_f32_16x16x32_bf16 v[96:99], v[192:195], v[232:235], v[96:99]
    v_mfma_f32_16x16x32_bf16 v[100:103], v[192:195], v[236:239], v[100:103]
    ds_read_b128 v[172:175], v21 offset:1408
    v_mfma_f32_16x16x32_bf16 v[84:87], v[196:199], v[216:219], v[84:87]
    v_mfma_f32_16x16x32_bf16 v[88:91], v[196:199], v[220:223], v[88:91]
    ds_read_b128 v[140:143], v20 offset:2944
    v_mfma_f32_16x16x32_bf16 v[92:95], v[196:199], v[224:227], v[92:95]
    v_mfma_f32_16x16x32_bf16 v[96:99], v[196:199], v[228:231], v[96:99]
    ds_read_b128 v[176:179], v21 offset:896
    v_mfma_f32_16x16x32_bf16 v[100:103], v[196:199], v[232:235], v[100:103]
    v_mfma_f32_16x16x32_bf16 v[88:91], v[200:203], v[216:219], v[88:91]
    ds_read_b128 v[144:147], v20 offset:3456
    v_mfma_f32_16x16x32_bf16 v[92:95], v[200:203], v[220:223], v[92:95]
    v_mfma_f32_16x16x32_bf16 v[96:99], v[200:203], v[224:227], v[96:99]
    ds_read_b128 v[180:183], v21 offset:384
    v_mfma_f32_16x16x32_bf16 v[100:103], v[200:203], v[228:231], v[100:103]
    v_mfma_f32_16x16x32_bf16 v[92:95], v[204:207], v[216:219], v[92:95]
    ds_read_b128 v[148:151], v20 offset:3968
    v_mfma_f32_16x16x32_bf16 v[96:99], v[204:207], v[220:223], v[96:99]
    v_mfma_f32_16x16x32_bf16 v[100:103], v[204:207], v[224:227], v[100:103]
    v_mfma_f32_16x16x32_bf16 v[96:99], v[208:211], v[216:219], v[96:99]
    v_mfma_f32_16x16x32_bf16 v[100:103], v[208:211], v[220:223], v[100:103]
    v_mfma_f32_16x16x32_bf16 v[100:103], v[212:215], v[216:219], v[100:103]
    s_waitcnt lgkmcnt(0)
    v_mfma_f32_16x16x32_bf16 v[72:75], v[120:123], v[152:155], v[72:75]
    ds_read_b128 v[216:219], v21 offset:4032
    v_mfma_f32_16x16x32_bf16 v[76:79], v[120:123], v[156:159], v[76:79]
    v_mfma_f32_16x16x32_bf16 v[80:83], v[120:123], v[160:163], v[80:83]
    ds_read_b128 v[184:187], v20 offset:448
    v_mfma_f32_16x16x32_bf16 v[84:87], v[120:123], v[164:167], v[84:87]
    v_mfma_f32_16x16x32_bf16 v[88:91], v[120:123], v[168:171], v[88:91]
    ds_read_b128 v[220:223], v21 offset:3520
    v_mfma_f32_16x16x32_bf16 v[92:95], v[120:123], v[172:175], v[92:95]
    v_mfma_f32_16x16x32_bf16 v[96:99], v[120:123], v[176:179], v[96:99]
    ds_read_b128 v[188:191], v20 offset:960
    v_mfma_f32_16x16x32_bf16 v[100:103], v[120:123], v[180:183], v[100:103]
    v_mfma_f32_16x16x32_bf16 v[76:79], v[124:127], v[152:155], v[76:79]
    ds_read_b128 v[224:227], v21 offset:3008
    v_mfma_f32_16x16x32_bf16 v[80:83], v[124:127], v[156:159], v[80:83]
    v_mfma_f32_16x16x32_bf16 v[84:87], v[124:127], v[160:163], v[84:87]
    ds_read_b128 v[192:195], v20 offset:1472
    v_mfma_f32_16x16x32_bf16 v[88:91], v[124:127], v[164:167], v[88:91]
    v_mfma_f32_16x16x32_bf16 v[92:95], v[124:127], v[168:171], v[92:95]
    ds_read_b128 v[228:231], v21 offset:2496
    v_mfma_f32_16x16x32_bf16 v[96:99], v[124:127], v[172:175], v[96:99]
    v_mfma_f32_16x16x32_bf16 v[100:103], v[124:127], v[176:179], v[100:103]
    ds_read_b128 v[196:199], v20 offset:1984
    v_mfma_f32_16x16x32_bf16 v[80:83], v[128:131], v[152:155], v[80:83]
    v_mfma_f32_16x16x32_bf16 v[84:87], v[128:131], v[156:159], v[84:87]
    ds_read_b128 v[232:235], v21 offset:1984
    v_mfma_f32_16x16x32_bf16 v[88:91], v[128:131], v[160:163], v[88:91]
    v_mfma_f32_16x16x32_bf16 v[92:95], v[128:131], v[164:167], v[92:95]
    ds_read_b128 v[200:203], v20 offset:2496
    v_mfma_f32_16x16x32_bf16 v[96:99], v[128:131], v[168:171], v[96:99]
    v_mfma_f32_16x16x32_bf16 v[100:103], v[128:131], v[172:175], v[100:103]
    ds_read_b128 v[236:239], v21 offset:1472
    v_mfma_f32_16x16x32_bf16 v[84:87], v[132:135], v[152:155], v[84:87]
    v_mfma_f32_16x16x32_bf16 v[88:91], v[132:135], v[156:159], v[88:91]
    ds_read_b128 v[204:207], v20 offset:3008
    v_mfma_f32_16x16x32_bf16 v[92:95], v[132:135], v[160:163], v[92:95]
    v_mfma_f32_16x16x32_bf16 v[96:99], v[132:135], v[164:167], v[96:99]
    ds_read_b128 v[240:243], v21 offset:960
    v_mfma_f32_16x16x32_bf16 v[100:103], v[132:135], v[168:171], v[100:103]
    v_mfma_f32_16x16x32_bf16 v[88:91], v[136:139], v[152:155], v[88:91]
    ds_read_b128 v[208:211], v20 offset:3520
    v_mfma_f32_16x16x32_bf16 v[92:95], v[136:139], v[156:159], v[92:95]
    v_mfma_f32_16x16x32_bf16 v[96:99], v[136:139], v[160:163], v[96:99]
    ds_read_b128 v[244:247], v21 offset:448
    v_mfma_f32_16x16x32_bf16 v[100:103], v[136:139], v[164:167], v[100:103]
    v_mfma_f32_16x16x32_bf16 v[92:95], v[140:143], v[152:155], v[92:95]
    ds_read_b128 v[212:215], v20 offset:4032
    v_mfma_f32_16x16x32_bf16 v[96:99], v[140:143], v[156:159], v[96:99]
    v_mfma_f32_16x16x32_bf16 v[100:103], v[140:143], v[160:163], v[100:103]
    v_mfma_f32_16x16x32_bf16 v[96:99], v[144:147], v[152:155], v[96:99]
    v_mfma_f32_16x16x32_bf16 v[100:103], v[144:147], v[156:159], v[100:103]
    v_mfma_f32_16x16x32_bf16 v[100:103], v[148:151], v[152:155], v[100:103]
    s_waitcnt lgkmcnt(0)
    v_mfma_f32_16x16x32_bf16 v[72:75], v[184:187], v[216:219], v[72:75]
    v_mfma_f32_16x16x32_bf16 v[76:79], v[184:187], v[220:223], v[76:79]
    v_mfma_f32_16x16x32_bf16 v[80:83], v[184:187], v[224:227], v[80:83]
    v_mfma_f32_16x16x32_bf16 v[84:87], v[184:187], v[228:231], v[84:87]
    v_mfma_f32_16x16x32_bf16 v[88:91], v[184:187], v[232:235], v[88:91]
    v_mfma_f32_16x16x32_bf16 v[92:95], v[184:187], v[236:239], v[92:95]
    v_mfma_f32_16x16x32_bf16 v[96:99], v[184:187], v[240:243], v[96:99]
    v_mfma_f32_16x16x32_bf16 v[100:103], v[184:187], v[244:247], v[100:103]
    v_mfma_f32_16x16x32_bf16 v[76:79], v[188:191], v[216:219], v[76:79]
    v_mfma_f32_16x16x32_bf16 v[80:83], v[188:191], v[220:223], v[80:83]
    v_mfma_f32_16x16x32_bf16 v[84:87], v[188:191], v[224:227], v[84:87]
    v_mfma_f32_16x16x32_bf16 v[88:91], v[188:191], v[228:231], v[88:91]
    v_mfma_f32_16x16x32_bf16 v[92:95], v[188:191], v[232:235], v[92:95]
    v_mfma_f32_16x16x32_bf16 v[96:99], v[188:191], v[236:239], v[96:99]
    v_mfma_f32_16x16x32_bf16 v[100:103], v[188:191], v[240:243], v[100:103]
    v_mfma_f32_16x16x32_bf16 v[80:83], v[192:195], v[216:219], v[80:83]
    v_mfma_f32_16x16x32_bf16 v[84:87], v[192:195], v[220:223], v[84:87]
    v_mfma_f32_16x16x32_bf16 v[88:91], v[192:195], v[224:227], v[88:91]
    v_mfma_f32_16x16x32_bf16 v[92:95], v[192:195], v[228:231], v[92:95]
    v_mfma_f32_16x16x32_bf16 v[96:99], v[192:195], v[232:235], v[96:99]
    v_mfma_f32_16x16x32_bf16 v[100:103], v[192:195], v[236:239], v[100:103]
    v_mfma_f32_16x16x32_bf16 v[84:87], v[196:199], v[216:219], v[84:87]
    v_mfma_f32_16x16x32_bf16 v[88:91], v[196:199], v[220:223], v[88:91]
    v_mfma_f32_16x16x32_bf16 v[92:95], v[196:199], v[224:227], v[92:95]
    v_mfma_f32_16x16x32_bf16 v[96:99], v[196:199], v[228:231], v[96:99]
    v_mfma_f32_16x16x32_bf16 v[100:103], v[196:199], v[232:235], v[100:103]
    v_mfma_f32_16x16x32_bf16 v[88:91], v[200:203], v[216:219], v[88:91]
    v_mfma_f32_16x16x32_bf16 v[92:95], v[200:203], v[220:223], v[92:95]
    v_mfma_f32_16x16x32_bf16 v[96:99], v[200:203], v[224:227], v[96:99]
    v_mfma_f32_16x16x32_bf16 v[100:103], v[200:203], v[228:231], v[100:103]
    v_mfma_f32_16x16x32_bf16 v[92:95], v[204:207], v[216:219], v[92:95]
    v_mfma_f32_16x16x32_bf16 v[96:99], v[204:207], v[220:223], v[96:99]
    v_mfma_f32_16x16x32_bf16 v[100:103], v[204:207], v[224:227], v[100:103]
    v_mfma_f32_16x16x32_bf16 v[96:99], v[208:211], v[216:219], v[96:99]
    v_mfma_f32_16x16x32_bf16 v[100:103], v[208:211], v[220:223], v[100:103]
    v_mfma_f32_16x16x32_bf16 v[100:103], v[212:215], v[216:219], v[100:103]
    ds_read_b64 v[120:121], v22 offset:3584
    ds_read_b64 v[122:123], v22 offset:3072
    ds_read_b64 v[124:125], v22 offset:2560
    ds_read_b64 v[126:127], v22 offset:2048
    ds_read_b64 v[128:129], v22 offset:1536
    ds_read_b64 v[130:131], v22 offset:1024
    ds_read_b64 v[132:133], v22 offset:512
    ds_read_b64 v[134:135], v22 offset:0
    s_waitcnt lgkmcnt(0)
    v_cvt_pk_bf16_f32 v6, v72, v73
    v_lshlrev_b32 v72, 16, v6
    v_and_b32 v73, s35, v6
    v_cvt_pk_bf16_f32 v6, v74, v75
    v_lshlrev_b32 v74, 16, v6
    v_and_b32 v75, s35, v6
    v_and_b32 v8, s35, v121
    v_lshlrev_b32 v9, 16, v121
    v_and_b32 v10, s35, v120
    v_lshlrev_b32 v11, 16, v120
    v_mul_f32 v8, v69, v8
    v_mul_f32 v9, v69, v9
    v_mul_f32 v10, v69, v10
    v_mul_f32 v11, v69, v11
    v_cvt_pk_bf16_f32 v6, v8, v9
    v_lshlrev_b32 v8, 16, v6
    v_and_b32 v9, s35, v6
    v_cvt_pk_bf16_f32 v6, v10, v11
    v_lshlrev_b32 v10, 16, v6
    v_and_b32 v11, s35, v6
    v_pk_add_f32 v[72:73], v[72:73], v[8:9]
    v_pk_add_f32 v[74:75], v[74:75], v[10:11]
    v_cvt_pk_bf16_f32 v12, v72, v73
    v_cvt_pk_bf16_f32 v13, v74, v75
    ds_write_b64 v26, v[12:13] offset:0
    v_cvt_pk_bf16_f32 v6, v76, v77
    v_lshlrev_b32 v76, 16, v6
    v_and_b32 v77, s35, v6
    v_cvt_pk_bf16_f32 v6, v78, v79
    v_lshlrev_b32 v78, 16, v6
    v_and_b32 v79, s35, v6
    v_and_b32 v8, s35, v123
    v_lshlrev_b32 v9, 16, v123
    v_and_b32 v10, s35, v122
    v_lshlrev_b32 v11, 16, v122
    v_mul_f32 v8, v69, v8
    v_mul_f32 v9, v69, v9
    v_mul_f32 v10, v69, v10
    v_mul_f32 v11, v69, v11
    v_cvt_pk_bf16_f32 v6, v8, v9
    v_lshlrev_b32 v8, 16, v6
    v_and_b32 v9, s35, v6
    v_cvt_pk_bf16_f32 v6, v10, v11
    v_lshlrev_b32 v10, 16, v6
    v_and_b32 v11, s35, v6
    v_pk_add_f32 v[76:77], v[76:77], v[8:9]
    v_pk_add_f32 v[78:79], v[78:79], v[10:11]
    v_cvt_pk_bf16_f32 v12, v76, v77
    v_cvt_pk_bf16_f32 v13, v78, v79
    ds_write_b64 v26, v[12:13] offset:512
    v_cvt_pk_bf16_f32 v6, v80, v81
    v_lshlrev_b32 v80, 16, v6
    v_and_b32 v81, s35, v6
    v_cvt_pk_bf16_f32 v6, v82, v83
    v_lshlrev_b32 v82, 16, v6
    v_and_b32 v83, s35, v6
    v_and_b32 v8, s35, v125
    v_lshlrev_b32 v9, 16, v125
    v_and_b32 v10, s35, v124
    v_lshlrev_b32 v11, 16, v124
    v_mul_f32 v8, v69, v8
    v_mul_f32 v9, v69, v9
    v_mul_f32 v10, v69, v10
    v_mul_f32 v11, v69, v11
    v_cvt_pk_bf16_f32 v6, v8, v9
    v_lshlrev_b32 v8, 16, v6
    v_and_b32 v9, s35, v6
    v_cvt_pk_bf16_f32 v6, v10, v11
    v_lshlrev_b32 v10, 16, v6
    v_and_b32 v11, s35, v6
    v_pk_add_f32 v[80:81], v[80:81], v[8:9]
    v_pk_add_f32 v[82:83], v[82:83], v[10:11]
    v_cvt_pk_bf16_f32 v12, v80, v81
    v_cvt_pk_bf16_f32 v13, v82, v83
    ds_write_b64 v26, v[12:13] offset:1024
    v_cvt_pk_bf16_f32 v6, v84, v85
    v_lshlrev_b32 v84, 16, v6
    v_and_b32 v85, s35, v6
    v_cvt_pk_bf16_f32 v6, v86, v87
    v_lshlrev_b32 v86, 16, v6
    v_and_b32 v87, s35, v6
    v_and_b32 v8, s35, v127
    v_lshlrev_b32 v9, 16, v127
    v_and_b32 v10, s35, v126
    v_lshlrev_b32 v11, 16, v126
    v_mul_f32 v8, v69, v8
    v_mul_f32 v9, v69, v9
    v_mul_f32 v10, v69, v10
    v_mul_f32 v11, v69, v11
    v_cvt_pk_bf16_f32 v6, v8, v9
    v_lshlrev_b32 v8, 16, v6
    v_and_b32 v9, s35, v6
    v_cvt_pk_bf16_f32 v6, v10, v11
    v_lshlrev_b32 v10, 16, v6
    v_and_b32 v11, s35, v6
    v_pk_add_f32 v[84:85], v[84:85], v[8:9]
    v_pk_add_f32 v[86:87], v[86:87], v[10:11]
    v_cvt_pk_bf16_f32 v12, v84, v85
    v_cvt_pk_bf16_f32 v13, v86, v87
    ds_write_b64 v26, v[12:13] offset:1536
    v_cvt_pk_bf16_f32 v6, v88, v89
    v_lshlrev_b32 v88, 16, v6
    v_and_b32 v89, s35, v6
    v_cvt_pk_bf16_f32 v6, v90, v91
    v_lshlrev_b32 v90, 16, v6
    v_and_b32 v91, s35, v6
    v_and_b32 v8, s35, v129
    v_lshlrev_b32 v9, 16, v129
    v_and_b32 v10, s35, v128
    v_lshlrev_b32 v11, 16, v128
    v_mul_f32 v8, v69, v8
    v_mul_f32 v9, v69, v9
    v_mul_f32 v10, v69, v10
    v_mul_f32 v11, v69, v11
    v_cvt_pk_bf16_f32 v6, v8, v9
    v_lshlrev_b32 v8, 16, v6
    v_and_b32 v9, s35, v6
    v_cvt_pk_bf16_f32 v6, v10, v11
    v_lshlrev_b32 v10, 16, v6
    v_and_b32 v11, s35, v6
    v_pk_add_f32 v[88:89], v[88:89], v[8:9]
    v_pk_add_f32 v[90:91], v[90:91], v[10:11]
    v_cvt_pk_bf16_f32 v12, v88, v89
    v_cvt_pk_bf16_f32 v13, v90, v91
    ds_write_b64 v26, v[12:13] offset:2048
    v_cvt_pk_bf16_f32 v6, v92, v93
    v_lshlrev_b32 v92, 16, v6
    v_and_b32 v93, s35, v6
    v_cvt_pk_bf16_f32 v6, v94, v95
    v_lshlrev_b32 v94, 16, v6
    v_and_b32 v95, s35, v6
    v_and_b32 v8, s35, v131
    v_lshlrev_b32 v9, 16, v131
    v_and_b32 v10, s35, v130
    v_lshlrev_b32 v11, 16, v130
    v_mul_f32 v8, v69, v8
    v_mul_f32 v9, v69, v9
    v_mul_f32 v10, v69, v10
    v_mul_f32 v11, v69, v11
    v_cvt_pk_bf16_f32 v6, v8, v9
    v_lshlrev_b32 v8, 16, v6
    v_and_b32 v9, s35, v6
    v_cvt_pk_bf16_f32 v6, v10, v11
    v_lshlrev_b32 v10, 16, v6
    v_and_b32 v11, s35, v6
    v_pk_add_f32 v[92:93], v[92:93], v[8:9]
    v_pk_add_f32 v[94:95], v[94:95], v[10:11]
    v_cvt_pk_bf16_f32 v12, v92, v93
    v_cvt_pk_bf16_f32 v13, v94, v95
    ds_write_b64 v26, v[12:13] offset:2560
    v_cvt_pk_bf16_f32 v6, v96, v97
    v_lshlrev_b32 v96, 16, v6
    v_and_b32 v97, s35, v6
    v_cvt_pk_bf16_f32 v6, v98, v99
    v_lshlrev_b32 v98, 16, v6
    v_and_b32 v99, s35, v6
    v_and_b32 v8, s35, v133
    v_lshlrev_b32 v9, 16, v133
    v_and_b32 v10, s35, v132
    v_lshlrev_b32 v11, 16, v132
    v_mul_f32 v8, v69, v8
    v_mul_f32 v9, v69, v9
    v_mul_f32 v10, v69, v10
    v_mul_f32 v11, v69, v11
    v_cvt_pk_bf16_f32 v6, v8, v9
    v_lshlrev_b32 v8, 16, v6
    v_and_b32 v9, s35, v6
    v_cvt_pk_bf16_f32 v6, v10, v11
    v_lshlrev_b32 v10, 16, v6
    v_and_b32 v11, s35, v6
    v_pk_add_f32 v[96:97], v[96:97], v[8:9]
    v_pk_add_f32 v[98:99], v[98:99], v[10:11]
    v_cvt_pk_bf16_f32 v12, v96, v97
    v_cvt_pk_bf16_f32 v13, v98, v99
    ds_write_b64 v26, v[12:13] offset:3072
    v_cvt_pk_bf16_f32 v6, v100, v101
    v_lshlrev_b32 v100, 16, v6
    v_and_b32 v101, s35, v6
    v_cvt_pk_bf16_f32 v6, v102, v103
    v_lshlrev_b32 v102, 16, v6
    v_and_b32 v103, s35, v6
    v_and_b32 v8, s35, v135
    v_lshlrev_b32 v9, 16, v135
    v_and_b32 v10, s35, v134
    v_lshlrev_b32 v11, 16, v134
    v_mul_f32 v8, v69, v8
    v_mul_f32 v9, v69, v9
    v_mul_f32 v10, v69, v10
    v_mul_f32 v11, v69, v11
    v_cvt_pk_bf16_f32 v6, v8, v9
    v_lshlrev_b32 v8, 16, v6
    v_and_b32 v9, s35, v6
    v_cvt_pk_bf16_f32 v6, v10, v11
    v_lshlrev_b32 v10, 16, v6
    v_and_b32 v11, s35, v6
    v_pk_add_f32 v[100:101], v[100:101], v[8:9]
    v_pk_add_f32 v[102:103], v[102:103], v[10:11]
    v_cvt_pk_bf16_f32 v12, v100, v101
    v_cvt_pk_bf16_f32 v13, v102, v103
    ds_write_b64 v26, v[12:13] offset:3584
    s_waitcnt lgkmcnt(0)
    ds_read_b128 v[120:123], v27 offset:0
    ds_read_b128 v[124:127], v27 offset:1024
    ds_read_b128 v[128:131], v27 offset:2048
    ds_read_b128 v[132:135], v27 offset:3072
    s_waitcnt lgkmcnt(3)
    buffer_store_dwordx4 v[120:123], v1, s[4:7], s78 offen offset:0 sc1
    s_waitcnt lgkmcnt(2)
    buffer_store_dwordx4 v[124:127], v1, s[4:7], s78 offen offset:1024 sc1
    s_waitcnt lgkmcnt(1)
    buffer_store_dwordx4 v[128:131], v1, s[4:7], s78 offen offset:2048 sc1
    s_waitcnt lgkmcnt(0)
    buffer_store_dwordx4 v[132:135], v1, s[4:7], s78 offen offset:3072 sc1
    s_add_u32 s78, s78, 262144
    s_add_u32 s34, s34, 1
    s_lshl_b32 s26, s30, 2
    s_add_u32 s26, s26, 2826240
    v_mov_b32 v4, s34
    s_waitcnt vmcnt(0)
    buffer_store_dword v4, v2, s[4:7], s26 offen sc1
    s_cmp_lg_u32 s34, 10
    s_cbranch_scc1 L_chan_61
    s_mov_b32 s74, s30
    s_mov_b32 s79, 1200
L_mixent:
    s_load_dwordx2 s[48:49], s[0:1], 112
    s_mov_b32 s35, 0xffff0000
    v_lshlrev_b32 v1, 4, v0
    v_lshlrev_b32 v3, 2, v0
    v_mov_b32 v2, 0
    v_lshrrev_b32 v4, 2, v0
    v_and_b32 v5, 3, v0
    v_lshlrev_b32 v6, 12, v4
    v_lshl_add_u32 v20, v5, 4, v6
    v_mul_u32_u24 v6, 1280, v4
    v_lshl_add_u32 v21, v5, 4, v6
    v_lshlrev_b32 v4, 6, v4
    v_lshl_add_u32 v4, v5, 3, v4
    v_add_u32 v22, s32, v4
    v_and_b32 v4, 15, v0
    v_lshrrev_b32 v5, 4, v0
    v_lshlrev_b32 v24, 2, v4
    v_lshlrev_b32 v6, 6, v4
    v_lshl_add_u32 v6, v5, 3, v6
    s_add_u32 s26, s32, 2048
    v_add_u32 v23, s26, v6
    v_add_u32 v27, s26, v1
    v_and_b32 v26, 31, v0
    v_lshlrev_b32 v26, 2, v26
    v_and_b32 v6, 1, v0
    v_lshlrev_b32 v6, 4, v6
    v_mov_b32 v7, 0x3f80
    v_lshlrev_b32 v6, v6, v7
    v_lshrrev_b32 v7, 2, v4
    v_cmp_eq_u32 vcc, v7, v5
    v_bfe_u32 v7, v0, 1, 1
    s_nop 0
    v_cndmask_b32 v6, 0, v6, vcc
    v_cmp_eq_u32 vcc, 0, v7
    v_mov_b32 v130, 0
    v_mov_b32 v131, 0
    v_mov_b32 v132, 0
    v_mov_b32 v133, 0
    v_cndmask_b32 v128, 0, v6, vcc
    v_cndmask_b32 v129, v6, 0, vcc
    v_mov_b32 v134, v128
    v_mov_b32 v135, v129
    s_waitcnt lgkmcnt(0)
    s_and_b32 s49, s49, 0xffff
    s_mov_b32 s50, 2621440
    s_mov_b32 s51, 0x20000
L_mix_63:
    s_mul_i32 s75, s74, 3277
    s_lshr_b32 s75, s75, 16
    s_mul_i32 s26, s75, 20
    s_sub_u32 s76, s74, s26
    s_lshr_b32 s34, s76, 1
    s_mov_b32 s28, 2826240
L_mc_64:
    buffer_load_dword v6, v3, s[4:7], s28 offen sc1
    s_sub_u32 s23, s23, 1
    s_movk_i32 s29, 10
    s_cbranch_scc1 L_fail
    s_waitcnt vmcnt(0)
    v_cmp_ge_u32 vcc, s34, v6
    s_cbranch_vccz L_mcok_65
    s_sleep 32
    s_branch L_mc_64
L_mcok_65:
    s_lshl_b32 s26, s76, 17
    s_lshl_b32 s27, s75, 6
    s_add_u32 s26, s26, s27
    s_mov_b32 m0, s32
    s_add_u32 s26, s26, 58720256
    buffer_load_dwordx4 v20, s[4:7], s26 offen sc1 lds
    s_add_u32 m0, m0, 1024
    s_add_u32 s26, s26, 65536
    buffer_load_dwordx4 v20, s[4:7], s26 offen sc1 lds
    s_add_u32 m0, m0, 1024
    s_mul_i32 s78, s75, 40960
    s_lshl_b32 s27, s76, 6
    s_add_u32 s78, s78, s27
    buffer_load_dwordx4 v21, s[8:11], s78 offen lds
    s_add_u32 m0, m0, 1024
    s_add_u32 s27, s78, 20480
    buffer_load_dwordx4 v21, s[8:11], s27 offen lds
    s_lshl_b32 s28, s75, 7
    s_add_u32 s28, s28, 55574528
    buffer_load_dword v124, v24, s[4:7], s28 offen sc1
    buffer_load_dword v125, v24, s[4:7], s28 offen offset:64 sc1
    s_mul_i32 s77, s75, 327680
    s_lshl_b32 s26, s34, 15
    s_add_u32 s77, s77, s26
    s_and_b32 s26, s76, 1
    s_lshl_b32 s26, s26, 11
    s_add_u32 s77, s77, s26
    s_add_u32 s77, s77, 9437184
    s_waitcnt vmcnt(0)
    ds_read_b64_tr_b16 v[108:109], v22 offset:0
    ds_read_b64 v[116:117], v23 offset:0
    ds_read_b64_tr_b16 v[110:111], v22 offset:1024
    ds_read_b64 v[118:119], v23 offset:32
    ds_read_b64_tr_b16 v[112:113], v22 offset:32
    ds_read_b64 v[120:121], v23 offset:1024
    ds_read_b64_tr_b16 v[114:115], v22 offset:1056
    ds_read_b64 v[122:123], v23 offset:1056
    v_sub_f32 v126, 1.0, v124
    v_sub_f32 v127, 1.0, v125
    v_cvt_pk_bf16_f32 v6, v126, v127
    v_lshlrev_b32 v126, 16, v6
    v_and_b32 v127, s35, v6
    s_waitcnt lgkmcnt(0)
    v_lshlrev_b32 v8, 16, v108
    v_and_b32 v9, s35, v108
    v_lshlrev_b32 v10, 16, v116
    v_and_b32 v11, s35, v116
    v_pk_mul_f32 v[8:9], v[8:9], v[10:11]
    v_cvt_pk_bf16_f32 v6, v8, v9
    v_lshlrev_b32 v8, 16, v6
    v_and_b32 v9, s35, v6
    v_mul_f32 v8, v126, v8
    v_mul_f32 v9, v126, v9
    v_cvt_pk_bf16_f32 v108, v8, v9
    v_lshlrev_b32 v8, 16, v109
    v_and_b32 v9, s35, v109
    v_lshlrev_b32 v10, 16, v117
    v_and_b32 v11, s35, v117
    v_pk_mul_f32 v[8:9], v[8:9], v[10:11]
    v_cvt_pk_bf16_f32 v6, v8, v9
    v_lshlrev_b32 v8, 16, v6
    v_and_b32 v9, s35, v6
    v_mul_f32 v8, v126, v8
    v_mul_f32 v9, v126, v9
    v_cvt_pk_bf16_f32 v109, v8, v9
    v_lshlrev_b32 v8, 16, v110
    v_and_b32 v9, s35, v110
    v_lshlrev_b32 v10, 16, v118
    v_and_b32 v11, s35, v118
    v_pk_mul_f32 v[8:9], v[8:9], v[10:11]
    v_cvt_pk_bf16_f32 v6, v8, v9
    v_lshlrev_b32 v8, 16, v6
    v_and_b32 v9, s35, v6
    v_mul_f32 v8, v126, v8
    v_mul_f32 v9, v126, v9
    v_cvt_pk_bf16_f32 v110, v8, v9
    v_lshlrev_b32 v8, 16, v111
    v_and_b32 v9, s35, v111
    v_lshlrev_b32 v10, 16, v119
    v_and_b32 v11, s35, v119
    v_pk_mul_f32 v[8:9], v[8:9], v[10:11]
    v_cvt_pk_bf16_f32 v6, v8, v9
    v_lshlrev_b32 v8, 16, v6
    v_and_b32 v9, s35, v6
    v_mul_f32 v8, v126, v8
    v_mul_f32 v9, v126, v9
    v_cvt_pk_bf16_f32 v111, v8, v9
    v_lshlrev_b32 v8, 16, v112
    v_and_b32 v9, s35, v112
    v_lshlrev_b32 v10, 16, v120
    v_and_b32 v11, s35, v120
    v_pk_mul_f32 v[8:9], v[8:9], v[10:11]
    v_cvt_pk_bf16_f32 v6, v8, v9
    v_lshlrev_b32 v8, 16, v6
    v_and_b32 v9, s35, v6
    v_mul_f32 v8, v127, v8
    v_mul_f32 v9, v127, v9
    v_cvt_pk_bf16_f32 v112, v8, v9
    v_lshlrev_b32 v8, 16, v113
    v_and_b32 v9, s35, v113
    v_lshlrev_b32 v10, 16, v121
    v_and_b32 v11, s35, v121
    v_pk_mul_f32 v[8:9], v[8:9], v[10:11]
    v_cvt_pk_bf16_f32 v6, v8, v9
    v_lshlrev_b32 v8, 16, v6
    v_and_b32 v9, s35, v6
    v_mul_f32 v8, v127, v8
    v_mul_f32 v9, v127, v9
    v_cvt_pk_bf16_f32 v113, v8, v9
    v_lshlrev_b32 v8, 16, v114
    v_and_b32 v9, s35, v114
    v_lshlrev_b32 v10, 16, v122
    v_and_b32 v11, s35, v122
    v_pk_mul_f32 v[8:9], v[8:9], v[10:11]
    v_cvt_pk_bf16_f32 v6, v8, v9
    v_lshlrev_b32 v8, 16, v6
    v_and_b32 v9, s35, v6
    v_mul_f32 v8, v127, v8
    v_mul_f32 v9, v127, v9
    v_cvt_pk_bf16_f32 v114, v8, v9
    v_lshlrev_b32 v8, 16, v115
    v_and_b32 v9, s35, v115
    v_lshlrev_b32 v10, 16, v123
    v_and_b32 v11, s35, v123
    v_pk_mul_f32 v[8:9], v[8:9], v[10:11]
    v_cvt_pk_bf16_f32 v6, v8, v9
    v_lshlrev_b32 v8, 16, v6
    v_and_b32 v9, s35, v6
    v_mul_f32 v8, v127, v8
    v_mul_f32 v9, v127, v9
    v_cvt_pk_bf16_f32 v115, v8, v9
    s_lshl_b32 s27, s34, 7
    s_add_u32 s27, s27, 2822144
    s_lshl_b32 s26, s20, 7
    s_add_u32 s26, s26, 2828288
    s_add_u32 s33, s75, 4
    s_cmp_ge_u32 s75, 60
    s_cselect_b32 s27, s27, s26
    s_cselect_b32 s33, s75, s33
    s_cselect_b32 s26, -1, 0
    v_and_b32 v7, s26, v26
L_mw_66:
    buffer_load_dword v25, v7, s[4:7], s27 offen sc1
    s_sub_u32 s23, s23, 1
    s_movk_i32 s29, 11
    s_cbranch_scc1 L_fail
    s_waitcnt vmcnt(0)
    v_cmp_ge_i32 vcc, s33, v25
    s_cbranch_vccz L_mgo_67
    s_cmp_ge_u32 s75, 60
    s_cbranch_scc1 L_mw_66
    s_sleep 16
    s_branch L_mw_66
L_mgo_67:
    s_cmp_ge_u32 s75, 60
    s_cbranch_scc1 L_mq2_69
    v_readfirstlane_b32 s28, v25
    s_add_u32 s26, s75, 12
    s_cmp_ge_u32 s28, s26
    s_cselect_b32 s26, s74, 0
    s_bitcmp1_b32 s26, 6
    s_cbranch_scc1 L_mq2_69
L_mq_68:
    s_cmp_ge_u32 s28, 63
    s_cbranch_scc1 L_mq2_69
    s_sleep 3
    buffer_load_dword v6, v2, s[4:7], s27 offen sc1
    s_sub_u32 s23, s23, 1
    s_movk_i32 s29, 15
    s_cbranch_scc1 L_fail
    s_waitcnt vmcnt(0)
    v_readfirstlane_b32 s26, v6
    s_cmp_eq_u32 s26, s28
    s_cbranch_scc1 L_mq_68
L_mq2_69:
    buffer_load_dwordx4 v[28:31], v1, s[4:7], s77 offen offset:0 sc1
    buffer_load_dwordx4 v[32:35], v1, s[4:7], s77 offen offset:1024 sc1
    s_add_u32 s77, s77, 4096
    buffer_load_dwordx4 v[36:39], v1, s[4:7], s77 offen offset:0 sc1
    buffer_load_dwordx4 v[40:43], v1, s[4:7], s77 offen offset:1024 sc1
    s_add_u32 s77, s77, 4096
    buffer_load_dwordx4 v[44:47], v1, s[4:7], s77 offen offset:0 sc1
    buffer_load_dwordx4 v[48:51], v1, s[4:7], s77 offen offset:1024 sc1
    s_add_u32 s77, s77, 4096
    buffer_load_dwordx4 v[52:55], v1, s[4:7], s77 offen offset:0 sc1
    buffer_load_dwordx4 v[56:59], v1, s[4:7], s77 offen offset:1024 sc1
    s_add_u32 s77, s77, 4096
    buffer_load_dwordx4 v[60:63], v1, s[4:7], s77 offen offset:0 sc1
    buffer_load_dwordx4 v[64:67], v1, s[4:7], s77 offen offset:1024 sc1
    s_add_u32 s77, s77, 4096
    buffer_load_dwordx4 v[68:71], v1, s[4:7], s77 offen offset:0 sc1
    buffer_load_dwordx4 v[72:75], v1, s[4:7], s77 offen offset:1024 sc1
    s_add_u32 s77, s77, 4096
    buffer_load_dwordx4 v[76:79], v1, s[4:7], s77 offen offset:0 sc1
    buffer_load_dwordx4 v[80:83], v1, s[4:7], s77 offen offset:1024 sc1
    s_add_u32 s77, s77, 4096
    buffer_load_dwordx4 v[84:87], v1, s[4:7], s77 offen offset:0 sc1
    buffer_load_dwordx4 v[88:91], v1, s[4:7], s77 offen offset:1024 sc1
    s_waitcnt vmcnt(15)
    v_mfma_f32_16x16x32_bf16 v[92:95], v[128:131], v[28:31], 0
    v_mfma_f32_16x16x32_bf16 v[100:103], v[132:135], v[28:31], 0
    s_waitcnt vmcnt(14)
    v_mfma_f32_16x16x32_bf16 v[96:99], v[128:131], v[32:35], 0
    v_mfma_f32_16x16x32_bf16 v[104:107], v[132:135], v[32:35], 0
    s_waitcnt vmcnt(13)
    v_mfma_f32_16x16x32_bf16 v[92:95], v[128:131], v[36:39], v[92:95]
    v_mfma_f32_16x16x32_bf16 v[100:103], v[132:135], v[36:39], v[100:103]
    s_waitcnt vmcnt(12)
    v_mfma_f32_16x16x32_bf16 v[96:99], v[128:131], v[40:43], v[96:99]
    v_mfma_f32_16x16x32_bf16 v[104:107], v[132:135], v[40:43], v[104:107]
    s_waitcnt vmcnt(11)
    v_mfma_f32_16x16x32_bf16 v[92:95], v[128:131], v[44:47], v[92:95]
    v_mfma_f32_16x16x32_bf16 v[100:103], v[132:135], v[44:47], v[100:103]
    s_waitcnt vmcnt(10)
    v_mfma_f32_16x16x32_bf16 v[96:99], v[128:131], v[48:51], v[96:99]
    v_mfma_f32_16x16x32_bf16 v[104:107], v[132:135], v[48:51], v[104:107]
    s_waitcnt vmcnt(9)
    v_mfma_f32_16x16x32_bf16 v[92:95], v[128:131], v[52:55], v[92:95]
    v_mfma_f32_16x16x32_bf16 v[100:103], v[132:135], v[52:55], v[100:103]
    s_waitcnt vmcnt(8)
    v_mfma_f32_16x16x32_bf16 v[96:99], v[128:131], v[56:59], v[96:99]
    v_mfma_f32_16x16x32_bf16 v[104:107], v[132:135], v[56:59], v[104:107]
    s_waitcnt vmcnt(7)
    v_mfma_f32_16x16x32_bf16 v[92:95], v[128:131], v[60:63], v[92:95]
    v_mfma_f32_16x16x32_bf16 v[100:103], v[132:135], v[60:63], v[100:103]
    s_waitcnt vmcnt(6)
    v_mfma_f32_16x16x32_bf16 v[96:99], v[128:131], v[64:67], v[96:99]
    v_mfma_f32_16x16x32_bf16 v[104:107], v[132:135], v[64:67], v[104:107]
    s_waitcnt vmcnt(5)
    v_mfma_f32_16x16x32_bf16 v[92:95], v[128:131], v[68:71], v[92:95]
    v_mfma_f32_16x16x32_bf16 v[100:103], v[132:135], v[68:71], v[100:103]
    s_waitcnt vmcnt(4)
    v_mfma_f32_16x16x32_bf16 v[96:99], v[128:131], v[72:75], v[96:99]
    v_mfma_f32_16x16x32_bf16 v[104:107], v[132:135], v[72:75], v[104:107]
    s_waitcnt vmcnt(3)
    v_mfma_f32_16x16x32_bf16 v[92:95], v[128:131], v[76:79], v[92:95]
    v_mfma_f32_16x16x32_bf16 v[100:103], v[132:135], v[76:79], v[100:103]
    s_waitcnt vmcnt(2)
    v_mfma_f32_16x16x32_bf16 v[96:99], v[128:131], v[80:83], v[96:99]
    v_mfma_f32_16x16x32_bf16 v[104:107], v[132:135], v[80:83], v[104:107]
    s_waitcnt vmcnt(1)
    v_mfma_f32_16x16x32_bf16 v[92:95], v[128:131], v[84:87], v[92:95]
    v_mfma_f32_16x16x32_bf16 v[100:103], v[132:135], v[84:87], v[100:103]
    s_waitcnt vmcnt(0)
    v_mfma_f32_16x16x32_bf16 v[96:99], v[128:131], v[88:91], v[96:99]
    v_mfma_f32_16x16x32_bf16 v[104:107], v[132:135], v[88:91], v[104:107]
    s_nop 5
    v_cvt_pk_bf16_f32 v6, v92, v93
    v_lshlrev_b32 v92, 16, v6
    v_and_b32 v93, s35, v6
    v_mul_f32 v92, v124, v92
    v_mul_f32 v93, v124, v93
    v_cvt_pk_bf16_f32 v6, v92, v93
    v_lshlrev_b32 v92, 16, v6
    v_and_b32 v93, s35, v6
    v_lshlrev_b32 v8, 16, v108
    v_and_b32 v9, s35, v108
    v_pk_add_f32 v[92:93], v[92:93], v[8:9]
    v_cvt_pk_bf16_f32 v116, v92, v93
    v_cvt_pk_bf16_f32 v6, v94, v95
    v_lshlrev_b32 v94, 16, v6
    v_and_b32 v95, s35, v6
    v_mul_f32 v94, v124, v94
    v_mul_f32 v95, v124, v95
    v_cvt_pk_bf16_f32 v6, v94, v95
    v_lshlrev_b32 v94, 16, v6
    v_and_b32 v95, s35, v6
    v_lshlrev_b32 v8, 16, v109
    v_and_b32 v9, s35, v109
    v_pk_add_f32 v[94:95], v[94:95], v[8:9]
    v_cvt_pk_bf16_f32 v117, v94, v95
    ds_write_b64 v23, v[116:117] offset:0
    v_cvt_pk_bf16_f32 v6, v96, v97
    v_lshlrev_b32 v96, 16, v6
    v_and_b32 v97, s35, v6
    v_mul_f32 v96, v124, v96
    v_mul_f32 v97, v124, v97
    v_cvt_pk_bf16_f32 v6, v96, v97
    v_lshlrev_b32 v96, 16, v6
    v_and_b32 v97, s35, v6
    v_lshlrev_b32 v8, 16, v110
    v_and_b32 v9, s35, v110
    v_pk_add_f32 v[96:97], v[96:97], v[8:9]
    v_cvt_pk_bf16_f32 v118, v96, v97
    v_cvt_pk_bf16_f32 v6, v98, v99
    v_lshlrev_b32 v98, 16, v6
    v_and_b32 v99, s35, v6
    v_mul_f32 v98, v124, v98
    v_mul_f32 v99, v124, v99
    v_cvt_pk_bf16_f32 v6, v98, v99
    v_lshlrev_b32 v98, 16, v6
    v_and_b32 v99, s35, v6
    v_lshlrev_b32 v8, 16, v111
    v_and_b32 v9, s35, v111
    v_pk_add_f32 v[98:99], v[98:99], v[8:9]
    v_cvt_pk_bf16_f32 v119, v98, v99
    ds_write_b64 v23, v[118:119] offset:32
    v_cvt_pk_bf16_f32 v6, v100, v101
    v_lshlrev_b32 v100, 16, v6
    v_and_b32 v101, s35, v6
    v_mul_f32 v100, v125, v100
    v_mul_f32 v101, v125, v101
    v_cvt_pk_bf16_f32 v6, v100, v101
    v_lshlrev_b32 v100, 16, v6
    v_and_b32 v101, s35, v6
    v_lshlrev_b32 v8, 16, v112
    v_and_b32 v9, s35, v112
    v_pk_add_f32 v[100:101], v[100:101], v[8:9]
    v_cvt_pk_bf16_f32 v120, v100, v101
    v_cvt_pk_bf16_f32 v6, v102, v103
    v_lshlrev_b32 v102, 16, v6
    v_and_b32 v103, s35, v6
    v_mul_f32 v102, v125, v102
    v_mul_f32 v103, v125, v103
    v_cvt_pk_bf16_f32 v6, v102, v103
    v_lshlrev_b32 v102, 16, v6
    v_and_b32 v103, s35, v6
    v_lshlrev_b32 v8, 16, v113
    v_and_b32 v9, s35, v113
    v_pk_add_f32 v[102:103], v[102:103], v[8:9]
    v_cvt_pk_bf16_f32 v121, v102, v103
    ds_write_b64 v23, v[120:121] offset:1024
    v_cvt_pk_bf16_f32 v6, v104, v105
    v_lshlrev_b32 v104, 16, v6
    v_and_b32 v105, s35, v6
    v_mul_f32 v104, v125, v104
    v_mul_f32 v105, v125, v105
    v_cvt_pk_bf16_f32 v6, v104, v105
    v_lshlrev_b32 v104, 16, v6
    v_and_b32 v105, s35, v6
    v_lshlrev_b32 v8, 16, v114
    v_and_b32 v9, s35, v114
    v_pk_add_f32 v[104:105], v[104:105], v[8:9]
    v_cvt_pk_bf16_f32 v122, v104, v105
    v_cvt_pk_bf16_f32 v6, v106, v107
    v_lshlrev_b32 v106, 16, v6
    v_and_b32 v107, s35, v6
    v_mul_f32 v106, v125, v106
    v_mul_f32 v107, v125, v107
    v_cvt_pk_bf16_f32 v6, v106, v107
    v_lshlrev_b32 v106, 16, v6
    v_and_b32 v107, s35, v6
    v_lshlrev_b32 v8, 16, v115
    v_and_b32 v9, s35, v115
    v_pk_add_f32 v[106:107], v[106:107], v[8:9]
    v_cvt_pk_bf16_f32 v123, v106, v107
    ds_write_b64 v23, v[122:123] offset:1056
    s_waitcnt lgkmcnt(0)
    ds_read_b128 v[108:111], v27 offset:0
    ds_read_b128 v[112:115], v27 offset:1024
    s_add_u32 s27, s78, 20480
    s_waitcnt lgkmcnt(1)
    buffer_store_dwordx4 v[108:111], v21, s[48:51], s78 offen
    s_waitcnt lgkmcnt(0)
    buffer_store_dwordx4 v[112:115], v21, s[48:51], s27 offen
    s_add_u32 s74, s74, 64
    s_cmp_lt_u32 s74, s79
    s_cbranch_scc1 L_mix_63
    s_endpgm
L_code_end:
.section .rodata,"a"
.p2align 6
.amdhsa_kernel gated_mix__memory_aug_recurrent_mem_tr__ssm_conv_h3__prompt_kernel
  .amdhsa_next_free_vgpr 512
  .amdhsa_next_free_sgpr 96
  .amdhsa_accum_offset 256
  .amdhsa_group_segment_fixed_size 0
  .amdhsa_kernarg_size 136
  .amdhsa_user_sgpr_count 2
  .amdhsa_user_sgpr_kernarg_segment_ptr 1
  .amdhsa_system_sgpr_workgroup_id_x 1
  .amdhsa_float_denorm_mode_32 3
.end_amdhsa_kernel
```
